```python
import torch

def _softmax(x, axis=-1):
    return torch.softmax(x, dim=axis)
def _gelu(x):
    return torch.nn.functional.gelu(x, approximate="tanh")
def _silu(x):
    return torch.nn.functional.silu(x)
def _sigmoid(x):
    return torch.sigmoid(x)
def _layernorm(x, axis=-1, eps=1e-5):
    m = x.mean(dim=axis, keepdim=True)
    v = x.var(dim=axis, keepdim=True, unbiased=False)
    return (x - m) / torch.sqrt(v + eps)
def _scatter_add(tgt, idx, src, axis=0):
    return tgt.clone().index_add_(axis, idx, src)
def _segment_sum(src, seg, n):
    out = torch.zeros((n,) + src.shape[1:], dtype=src.dtype)
    return out.index_add_(0, seg, src)
def _pad(x, pw):
    flat = tuple(v for pair in reversed(pw) for v in pair)
    return torch.nn.functional.pad(x, flat)

kernel_name = 'gated_mix__mha_block__geglu_ffn__prompt'

def setup_inputs():

    _w = (lambda a: (lambda t: t.to(torch.bfloat16) if t.is_floating_point() else t)(torch.as_tensor(a)))
    def _A_setup():
        B, S, D, H = 1, 2048, 640, 32
        return {
            "x": _w((lambda *s: torch.randn(*s, dtype=torch.bfloat16) * 0.05)(B, S, D)),
            "wqkv": _w((lambda *s: torch.randn(*s, dtype=torch.bfloat16) * 0.8)(D, 3 * D)),
            "wo": _w((lambda *s: torch.randn(*s, dtype=torch.bfloat16) * 0.05)(D, D)),
        }
    _A_in = _A_setup()

    def _B_setup():
        B, S, D, F = 1, 2048, 640, 1536
        return {
            "x": _w((lambda *s: torch.randn(*s, dtype=torch.bfloat16) * 0.05)(B, S, D)),
            "w_gate": _w((lambda *s: torch.randn(*s, dtype=torch.bfloat16) * 0.1)(D, F)),
            "w_up": _w((lambda *s: torch.randn(*s, dtype=torch.bfloat16) * 0.1)(D, F)),
            "w_down": _w((lambda *s: torch.randn(*s, dtype=torch.bfloat16) * 0.1)(F, D)),
        }
    _B_in = _B_setup()

    return {
        "A_x": _A_in["x"],
        "A_wqkv": _A_in["wqkv"],
        "A_wo": _A_in["wo"],
        "B_x": _B_in["x"],
        "B_w_gate": _B_in["w_gate"],
        "B_w_up": _B_in["w_up"],
        "B_w_down": _B_in["w_down"],
        "gate_w": _w((lambda *s: torch.randn(*s, dtype=torch.bfloat16) * 0.05)(640) * 16.0),
    }

def reference(A_x, A_wqkv, A_wo, B_x, B_w_gate, B_w_up, B_w_down, gate_w):
    def _A_ref(x, wqkv, wo):
        B, S, D = x.shape
        H = 32
        Dh = D // H
        qkv = (lambda x, *d: x.permute(*d))((x @ wqkv).reshape(B, S, 3, H, Dh), 2, 0, 3, 1, 4)
        q, k, v = qkv[0], qkv[1], qkv[2]
        scores = torch.einsum("bhqd,bhkd->bhqk", q, k) * (Dh ** -0.5)
        p = _softmax(scores, axis=-1)
        o = torch.einsum("bhqk,bhkd->bhqd", p, v)
        return (lambda x, *d: x.permute(*d))(o, 0, 2, 1, 3).reshape(B, S, D) @ wo

    def _B_ref(x, w_gate, w_up, w_down):
        return (_gelu(x @ w_gate) * (x @ w_up)) @ w_down

    x = A_x
    g = _sigmoid((x * gate_w).sum(-1, keepdims=True))
    a = _A_ref(x, A_wqkv, A_wo)
    b = _B_ref(x, B_w_gate, B_w_up, B_w_down)
    return g * a + (1 - g) * b
```

```asm
; @launch grid=(256,1,1) block=(768,1,1) lds=163840
.amdgcn_target "amdgcn-amd-amdhsa--gfx950"
.text
.p2align 12
.globl gated_mix__mha_block__geglu_ffn__prompt_kernel
.p2align 8
.type gated_mix__mha_block__geglu_ffn__prompt_kernel,@function
gated_mix__mha_block__geglu_ffn__prompt_kernel:
    s_cmp_ge_u32 s2, 256
    s_cbranch_scc1 L_end2
    s_load_dwordx2 s[70:71], s[0:1], 16
    s_load_dwordx2 s[72:73], s[0:1], 48
    s_load_dwordx4 s[76:79], s[0:1], 64
    s_load_dwordx4 s[4:7], s[0:1], 0
    s_load_dwordx4 s[8:11], s[0:1], 32
    s_load_dwordx2 s[12:13], s[0:1], 56
    s_load_dwordx2 s[14:15], s[0:1], 80
    v_and_b32 v1, 63, v0
    v_lshrrev_b32 v2, 6, v0
    s_and_b32 s33, s2, 1
    v_readfirstlane_b32 s36, v2
    s_lshr_b32 s34, s2, 3
    s_bfe_u32 s35, s2, 0x20001
    s_mul_i32 s42, s35, 12
    s_add_u32 s42, s42, s34
    s_and_b32 s40, s42, 7
    s_lshl_b32 s41, s33, 3
    s_add_u32 s40, s40, s41
    s_lshr_b32 s42, s42, 3
    s_and_b32 s41, s42, 1
    s_sub_u32 s44, s34, 12
    s_cmp_eq_u32 s33, 0
    s_cselect_b32 s45, 37, 43
    s_cselect_b32 s46, 7, 6
    s_cselect_b32 s39, 0, 7
    s_mul_i32 s38, s44, s45
    s_lshr_b32 s38, s38, 8
    s_mul_i32 s46, s46, s38
    s_add_u32 s39, s39, s44
    s_sub_u32 s39, s39, s46
    s_cmp_eq_u32 s38, 3
    s_cselect_b32 s39, 6, s39
    s_cselect_b32 s38, 2, s38
    s_mul_i32 s46, s35, 3
    s_add_u32 s38, s38, s46
    s_lshl_b32 s46, s33, 5
    s_add_u32 s46, s46, s34
    s_lshr_b32 s33, s42, 1
    s_cmp_lt_u32 s34, 12
    s_cselect_b32 s33, s33, 3
    s_cmp_eq_u32 s46, 63
    s_cselect_b32 s33, 4, s33
    s_mul_i32 s43, s42, 640
    s_lshl_b32 s44, s38, 8
    s_lshl_b32 s45, s40, 7
    s_mul_i32 s46, s39, 160
    s_and_b32 s37, s36, 3
    s_cmp_lt_u32 s33, 3
    s_cselect_b32 s43, s43, s44
    s_cselect_b32 s45, s45, s46
    s_movk_i32 s47, 3840
    s_cselect_b32 s47, s47, 3072
    s_cmp_lt_u32 s36, 8
    s_cbranch_scc1 L_cons
    s_cmp_lt_u32 s33, 3
    s_cbranch_scc1 L_k1_ld_qkv
    s_cmp_eq_u32 s33, 4
    s_cbranch_scc1 L_spare
    s_setprio 3
    v_lshrrev_b32 v2, 3, v1
    v_and_b32 v3, 7, v1
    v_lshrrev_b32 v4, 4, v1
    s_mul_i32 s48, s37, 40
    s_add_u32 s48, s48, s45
    s_movk_i32 s49, 1280
    v_add_u32 v5, s48, v2
    v_mul_lo_u32 v5, v5, s49
    s_mul_i32 s50, s37, 20
    v_add_u32 v6, s50, v4
    v_and_b32 v6, 7, v6
    v_xor_b32 v6, v6, v3
    v_lshl_add_u32 v10, v6, 4, v5
    v_xor_b32 v6, 4, v6
    v_lshl_add_u32 v11, v6, 4, v5
    v_add_u32 v11, 10240, v11
    s_mul_i32 s52, s37, 5120
    s_add_u32 s52, s52, 98304
    s_mov_b32 s54, 0
    v_add_u32 v12, 20480, v10
    v_add_u32 v13, 20480, v11
    v_add_u32 v14, 20480, v12
    s_lshl_b32 s48, s37, 3
    v_add_u32 v5, s48, v2
    v_mul_lo_u32 v5, v5, s47
    v_add_u32 v5, s43, v5
    v_and_b32 v6, 1, v4
    v_lshlrev_b32 v6, 0, v6
    s_and_b32 s48, s37, 1
    s_lshl_b32 s48, s48, 2
    v_xor_b32 v6, s48, v6
    v_xor_b32 v6, v6, v3
    v_lshl_add_u32 v8, v6, 4, v5
    s_lshl_b32 s53, s37, 10
    s_mov_b32 s55, 0
    s_lshl_b32 s56, s47, 5
    s_mov_b32 s18, 2621440
    s_mov_b32 s19, 0x00020000
    s_mov_b32 s22, 1966080
    s_mov_b32 s23, 0x00020000
    s_mov_b32 s26, 1966080
    s_mov_b32 s27, 0x00020000
    s_waitcnt lgkmcnt(0)
    s_mov_b64 s[16:17], s[4:5]
    s_add_u32 m0, s52, 0
    s_nop 0
    buffer_load_dwordx4 v10, s[16:19], s54 offen lds
    s_add_u32 m0, s52, 1024
    s_nop 0
    buffer_load_dwordx4 v11, s[16:19], s54 offen lds
    s_add_u32 m0, s52, 2048
    s_nop 0
    buffer_load_dwordx4 v12, s[16:19], s54 offen lds
    s_add_u32 m0, s52, 3072
    s_nop 0
    buffer_load_dwordx4 v13, s[16:19], s54 offen lds
    s_add_u32 m0, s52, 4096
    s_nop 0
    buffer_load_dwordx4 v14, s[16:19], s54 offen lds
    s_add_u32 s54, s54, 128
    s_mov_b64 s[20:21], s[8:9]
    s_mov_b64 s[24:25], s[10:11]
    s_add_u32 m0, s53, 0
    s_nop 0
    buffer_load_dwordx4 v8, s[20:23], s55 offen offset:0 lds
    s_add_u32 m0, s53, 3968
    s_nop 0
    buffer_load_dwordx4 v8, s[20:23], s55 offen offset:128 lds
    s_add_u32 m0, s53, 8192
    s_nop 0
    buffer_load_dwordx4 v8, s[24:27], s55 offen offset:0 lds
    s_add_u32 m0, s53, 12160
    s_nop 0
    buffer_load_dwordx4 v8, s[24:27], s55 offen offset:128 lds
    s_add_u32 s55, s55, s56
    s_add_u32 m0, s53, 16384
    s_nop 0
    buffer_load_dwordx4 v8, s[20:23], s55 offen offset:0 lds
    s_add_u32 m0, s53, 20352
    s_nop 0
    buffer_load_dwordx4 v8, s[20:23], s55 offen offset:128 lds
    s_add_u32 m0, s53, 24576
    s_nop 0
    buffer_load_dwordx4 v8, s[24:27], s55 offen offset:0 lds
    s_add_u32 m0, s53, 28544
    s_nop 0
    buffer_load_dwordx4 v8, s[24:27], s55 offen offset:128 lds
    s_add_u32 s55, s55, s56
    s_add_u32 m0, s52, 20480
    s_nop 0
    buffer_load_dwordx4 v10, s[16:19], s54 offen lds
    s_mov_b32 s28, s14
    s_mov_b32 s29, s15
    s_mov_b32 s30, 22020096
    s_mov_b32 s31, 0x00020000
    s_mov_b32 s74, s76
    s_mov_b32 s75, s77
    s_mov_b32 s76, s78
    s_mov_b32 s77, s79
    s_mov_b32 s78, 256
    s_mov_b32 s79, 0x00020000
    v_mov_b32 v24, 0
    v_mov_b32 v25, 0
    v_mov_b32 v26, 0
    v_mov_b32 v27, 0
    v_mov_b32 v28, 161024
    ds_write_b128 v28, v[24:27]
    ds_write_b128 v28, v[24:27] offset:16
    s_sub_u32 s60, s34, 12
    s_min_u32 s60, s60, 16
    s_cmp_lt_u32 s60, 12
    s_cselect_b32 s64, s72, s70
    s_cselect_b32 s65, s73, s71
    s_mov_b32 s66, 819200
    s_cselect_b32 s66, 1966080, s66
    s_mov_b32 s67, 0x00020000
    s_cselect_b32 s61, 0, 4
    s_movk_i32 s62, 160
    s_cselect_b32 s62, 384, s62
    s_cselect_b32 s63, 32, 40
    s_cselect_b32 s58, 0, 12
    s_sub_u32 s58, s60, s58
    s_mul_i32 s58, s58, s63
    s_cmp_eq_u32 s60, 16
    s_cselect_b32 s61, 16, s61
    s_cselect_b32 s63, 2, 4
    s_cselect_b32 s58, 16, s58
    s_bfe_u32 s59, s2, 0x20001
    s_mul_i32 s62, s62, s59
    s_add_u32 s58, s58, s62
    s_mul_i32 s58, s58, 1280
    s_and_b32 s62, s2, 1
    s_lshl_b32 s62, s62, 2
    s_add_u32 s62, s62, s37
    s_mul_i32 s62, s62, 160
    s_add_u32 s58, s58, s62
    s_movk_i32 s62, 1280
    s_mul_i32 s59, s37, 5120
    s_add_u32 s59, s59, 32768
    v_add_u32 v52, 0, v1
    v_mul_u32_u24 v40, 205, v52
    v_lshrrev_b32 v40, 11, v40
    v_mul_u32_u24 v41, 10, v40
    v_sub_u32 v52, v52, v41
    v_lshlrev_b32 v52, 4, v52
    v_lshrrev_b32 v41, s63, v40
    v_mad_u32_u24 v40, v41, s61, v40
    v_mad_u32_u24 v52, v40, s62, v52
    v_add_u32 v53, 64, v1
    v_mul_u32_u24 v40, 205, v53
    v_lshrrev_b32 v40, 11, v40
    v_mul_u32_u24 v41, 10, v40
    v_sub_u32 v53, v53, v41
    v_lshlrev_b32 v53, 4, v53
    v_lshrrev_b32 v41, s63, v40
    v_mad_u32_u24 v40, v41, s61, v40
    v_mad_u32_u24 v53, v40, s62, v53
    v_add_u32 v54, 128, v1
    v_mul_u32_u24 v40, 205, v54
    v_lshrrev_b32 v40, 11, v40
    v_mul_u32_u24 v41, 10, v40
    v_sub_u32 v54, v54, v41
    v_lshlrev_b32 v54, 4, v54
    v_lshrrev_b32 v41, s63, v40
    v_mad_u32_u24 v40, v41, s61, v40
    v_mad_u32_u24 v54, v40, s62, v54
    v_add_u32 v55, 192, v1
    v_mul_u32_u24 v40, 205, v55
    v_lshrrev_b32 v40, 11, v40
    v_mul_u32_u24 v41, 10, v40
    v_sub_u32 v55, v55, v41
    v_lshlrev_b32 v55, 4, v55
    v_lshrrev_b32 v41, s63, v40
    v_mad_u32_u24 v40, v41, s61, v40
    v_mad_u32_u24 v55, v40, s62, v55
    v_add_u32 v56, 256, v1
    v_mul_u32_u24 v40, 205, v56
    v_lshrrev_b32 v40, 11, v40
    v_mul_u32_u24 v41, 10, v40
    v_sub_u32 v56, v56, v41
    v_lshlrev_b32 v56, 4, v56
    v_lshrrev_b32 v41, s63, v40
    v_mad_u32_u24 v40, v41, s61, v40
    v_mad_u32_u24 v56, v40, s62, v56
    s_sub_u32 s60, s34, 12
    s_and_b32 s69, s2, 1
    s_lshl_b32 s69, s69, 2
    s_add_u32 s69, s69, s37
    s_lshl_b32 s69, s69, 2
    s_bfe_u32 s61, s2, 0x20001
    s_add_u32 s69, s69, s61
    s_mul_i32 s69, s69, 17
    v_lshl_add_u32 v47, v1, 4, s59
    v_and_b32 v9, 15, v1
    v_lshrrev_b32 v48, 4, v1
    v_lshrrev_b32 v49, 1, v48
    v_lshlrev_b32 v49, 4, v49
    v_and_b32 v50, 1, v48
    v_lshl_add_u32 v49, v50, 2, v49
    v_lshrrev_b32 v50, 2, v9
    v_add_u32 v49, v49, v50
    v_mul_u32_u24 v49, 160, v49
    v_and_b32 v50, 3, v9
    v_mul_u32_u24 v50, 40, v50
    s_bfe_u32 s61, s2, 0x10002
    s_mul_i32 s62, s61, 24
    s_add_u32 s62, s62, s59
    v_add3_u32 v48, v50, v49, s62
    s_mul_i32 s62, s61, 40
    s_sub_u32 s62, 16, s62
    v_add_u32 v49, s62, v48
    s_min_u32 s62, s60, 16
    s_add_u32 s69, s69, s62
    s_mul_i32 s69, s69, 5120
    s_add_u32 s69, s69, 18874368
    s_add_u32 s68, s69, 4096
    s_mul_i32 s48, s39, 10
    s_mul_i32 s49, s38, 14
    s_add_u32 s49, s49, s45
    s_mul_i32 s50, s39, 12
    s_add_u32 s50, s50, s38
    s_mul_i32 s50, s50, 3840
    s_cmp_eq_u32 s37, 0
    s_cselect_b64 s[12:13], s[16:17], s[20:21]
    s_cselect_b32 s14, s18, s22
    s_cselect_b32 s48, s49, s48
    s_cselect_b32 s49, 1280, s47
    s_cselect_b32 s51, 28, 20
    s_cselect_b32 s4, 0, s43
    s_mov_b32 s5, 393216
    s_cselect_b32 s5, 256, s5
    s_mov_b32 s15, 0x00020000
    s_cmp_eq_u32 s37, 2
    s_cselect_b64 s[12:13], s[24:25], s[12:13]
    s_cmp_eq_u32 s37, 3
    s_cselect_b64 s[12:13], s[6:7], s[12:13]
    s_cselect_b32 s14, 2457600, s14
    s_cselect_b32 s48, 0, s48
    s_cselect_b32 s49, 256, s49
    s_cselect_b32 s4, s50, s4
    s_cselect_b32 s5, 491520, s5
    s_cselect_b32 s51, 30, s51
    s_cselect_b32 s50, s50, 0
    s_cmp_ge_u32 s50, 491520
    s_cselect_b32 s51, 0, s51
    v_lshrrev_b32 v44, 1, v1
    v_and_b32 v45, 1, v1
    v_add_u32 v44, s48, v44
    v_mul_lo_u32 v44, v44, s49
    v_cmp_gt_u32 vcc, s51, v1
    v_lshl_add_u32 v44, v45, 7, v44
    v_mov_b32 v45, 0x7fffffff
    v_cndmask_b32 v44, v45, v44, vcc
    s_mul_i32 s48, s5, 2
    s_add_u32 s4, s4, s48
    v_lshlrev_b32 v0, 4, v1
    s_branch L_ldb_ffn
L_cons:
    s_cmp_eq_u32 s33, 3
    s_cbranch_scc1 L_cons_f
    s_cmp_eq_u32 s33, 4
    s_cbranch_scc1 L_spare
    s_cmp_gt_u32 s36, 2
    s_cbranch_scc1 L_ngw
    s_cmp_lg_u32 s36, 0
    s_cbranch_scc1 L_gw0
    s_cmp_eq_u32 s34, 0
    s_cbranch_scc1 L_gp_0
    s_cmp_eq_u32 s34, 1
    s_cbranch_scc1 L_gp_1
    s_cmp_eq_u32 s34, 2
    s_cbranch_scc1 L_gp_2
    s_cmp_eq_u32 s34, 3
    s_cbranch_scc1 L_gp_3
    s_cmp_eq_u32 s34, 4
    s_cbranch_scc1 L_gp_4
    s_cmp_eq_u32 s34, 5
    s_cbranch_scc1 L_gp_5
    s_cmp_eq_u32 s34, 6
    s_cbranch_scc1 L_gp_6
    s_cmp_eq_u32 s34, 7
    s_cbranch_scc1 L_gp_7
    s_cmp_eq_u32 s34, 8
    s_cbranch_scc1 L_gp_8
    s_cmp_eq_u32 s34, 9
    s_cbranch_scc1 L_gp_9
    s_cmp_eq_u32 s34, 10
    s_cbranch_scc1 L_gp_10
    s_branch L_gp_11
L_gw0:
    s_cmp_lg_u32 s36, 1
    s_cbranch_scc1 L_gw1
    s_cmp_eq_u32 s34, 0
    s_cbranch_scc1 L_gp_12
    s_cmp_eq_u32 s34, 1
    s_cbranch_scc1 L_gp_13
    s_cmp_eq_u32 s34, 2
    s_cbranch_scc1 L_gp_14
    s_cmp_eq_u32 s34, 3
    s_cbranch_scc1 L_gp_15
    s_cmp_eq_u32 s34, 4
    s_cbranch_scc1 L_gp_16
    s_cmp_eq_u32 s34, 5
    s_cbranch_scc1 L_gp_17
    s_cmp_eq_u32 s34, 6
    s_cbranch_scc1 L_gp_18
    s_cmp_eq_u32 s34, 7
    s_cbranch_scc1 L_gp_19
    s_cmp_eq_u32 s34, 8
    s_cbranch_scc1 L_gp_20
    s_cmp_eq_u32 s34, 9
    s_cbranch_scc1 L_gp_21
    s_cmp_eq_u32 s34, 10
    s_cbranch_scc1 L_gp_22
    s_branch L_gp_23
L_gw1:
    s_cmp_eq_u32 s34, 0
    s_cbranch_scc1 L_gp_24
    s_cmp_eq_u32 s34, 1
    s_cbranch_scc1 L_k1_c_qkv
    s_cmp_eq_u32 s34, 2
    s_cbranch_scc1 L_k1_c_qkv
    s_cmp_eq_u32 s34, 3
    s_cbranch_scc1 L_k1_c_qkv
    s_cmp_eq_u32 s34, 4
    s_cbranch_scc1 L_k1_c_qkv
    s_cmp_eq_u32 s34, 5
    s_cbranch_scc1 L_k1_c_qkv
    s_cmp_eq_u32 s34, 6
    s_cbranch_scc1 L_k1_c_qkv
    s_cmp_eq_u32 s34, 7
    s_cbranch_scc1 L_k1_c_qkv
    s_cmp_eq_u32 s34, 8
    s_cbranch_scc1 L_k1_c_qkv
    s_cmp_eq_u32 s34, 9
    s_cbranch_scc1 L_k1_c_qkv
    s_cmp_eq_u32 s34, 10
    s_cbranch_scc1 L_k1_c_qkv
    s_branch L_k1_c_qkv
L_gw2:
L_ngw:
    s_cmp_eq_u32 s36, 7
    s_cbranch_scc1 L_pad_ldq_0
    s_cmp_eq_u32 s36, 6
    s_cbranch_scc1 L_k1_c_qkv
    s_cmp_eq_u32 s33, 2
    s_cbranch_scc1 L_cons_v
    s_cmp_eq_u32 s36, 5
    s_cbranch_scc1 L_pad_mqk_0
    s_cmp_eq_u32 s36, 4
    s_cbranch_scc1 L_pad_mqk_1
    s_cmp_eq_u32 s36, 3
    s_cbranch_scc1 L_pad_mqk_2
    s_branch L_k1_c_qkv
L_cons_v:
    s_cmp_eq_u32 s36, 5
    s_cbranch_scc1 L_pad_mv_0
    s_cmp_eq_u32 s36, 4
    s_cbranch_scc1 L_pad_mv_1
    s_cmp_eq_u32 s36, 3
    s_cbranch_scc1 L_pad_mv_2
    s_branch L_k1_c_qkv
L_cons_f:
    s_cmp_eq_u32 s36, 7
    s_cbranch_scc1 L_pad_ldf_0
    s_cmp_eq_u32 s36, 6
    s_cbranch_scc1 L_pad_ldf_1
    s_cmp_eq_u32 s36, 5
    s_cbranch_scc1 L_pad_mf_0
    s_cmp_eq_u32 s36, 4
    s_cbranch_scc1 L_pad_mf_1
    s_cmp_eq_u32 s36, 3
    s_cbranch_scc1 L_k1_c_ffn
    s_branch L_k1_c_ffn
L_k1_ld_qkv:
    s_setprio 3
    v_lshrrev_b32 v2, 3, v1
    v_and_b32 v3, 7, v1
    v_lshrrev_b32 v4, 4, v1
    s_and_b32 s48, s37, 1
    s_lshl_b32 s48, s48, 1
    s_and_b32 s49, s40, 1
    s_sub_u32 s48, s48, s49
    s_lshl_b32 s48, s48, 1
    s_lshr_b32 s49, s37, 1
    s_add_u32 s48, s48, s49
    s_lshl_b32 s48, s48, 5
    s_add_u32 s48, s48, s45
    s_movk_i32 s49, 1280
    v_add_u32 v5, s48, v2
    v_mul_lo_u32 v5, v5, s49
    s_mul_i32 s50, s37, 16
    v_add_u32 v6, s50, v4
    v_and_b32 v6, 7, v6
    v_xor_b32 v6, v6, v3
    v_lshl_add_u32 v10, v6, 4, v5
    v_xor_b32 v6, 4, v6
    v_lshl_add_u32 v11, v6, 4, v5
    v_add_u32 v11, 10240, v11
    s_mul_i32 s52, s37, 4096
    s_add_u32 s52, s52, 102400
    s_mov_b32 s54, 0
    v_add_u32 v12, 20480, v10
    v_add_u32 v13, 20480, v11
    s_lshl_b32 s48, s37, 3
    v_add_u32 v5, s48, v2
    v_mul_lo_u32 v5, v5, s47
    v_add_u32 v5, s43, v5
    v_and_b32 v6, 1, v4
    v_lshlrev_b32 v6, 1, v6
    s_and_b32 s48, s37, 1
    s_lshl_b32 s48, s48, 2
    v_xor_b32 v6, s48, v6
    v_xor_b32 v6, v6, v3
    v_lshl_add_u32 v8, v6, 4, v5
    s_lshl_b32 s53, s37, 10
    s_mov_b32 s55, 0
    s_lshl_b32 s56, s47, 5
    s_mov_b32 s18, 2621440
    s_mov_b32 s19, 0x00020000
    s_mov_b32 s22, 2457600
    s_mov_b32 s23, 0x00020000
    s_mov_b32 s26, 2457600
    s_mov_b32 s27, 0x00020000
    s_waitcnt lgkmcnt(0)
    s_mov_b64 s[16:17], s[4:5]
    s_add_u32 m0, s52, 0
    s_nop 0
    buffer_load_dwordx4 v10, s[16:19], s54 offen lds
    s_add_u32 m0, s52, 1024
    s_nop 0
    buffer_load_dwordx4 v11, s[16:19], s54 offen lds
    s_add_u32 m0, s52, 2048
    s_nop 0
    buffer_load_dwordx4 v12, s[16:19], s54 offen lds
    s_add_u32 m0, s52, 3072
    s_nop 0
    buffer_load_dwordx4 v13, s[16:19], s54 offen lds
    s_add_u32 s54, s54, 128
    s_mov_b32 s60, s12
    s_mov_b32 s61, s13
    s_mov_b32 s62, 1280
    s_mov_b32 s63, 0x00020000
    s_mul_i32 s48, s37, 320
    v_lshlrev_b32 v16, 4, v1
    s_add_u32 m0, s48, 159744
    s_mov_b64 exec, 0xfffff
    buffer_load_dwordx4 v16, s[60:63], s48 offen lds
    s_mov_b64 exec, -1
    s_mov_b64 s[20:21], s[6:7]
    s_mov_b64 s[24:25], s[6:7]
    s_add_u32 m0, s53, 0
    s_nop 0
    buffer_load_dwordx4 v8, s[20:23], s55 offen offset:0 lds
    s_add_u32 m0, s53, 3968
    s_nop 0
    buffer_load_dwordx4 v8, s[20:23], s55 offen offset:128 lds
    s_add_u32 m0, s53, 7936
    s_nop 0
    buffer_load_dwordx4 v8, s[20:23], s55 offen offset:256 lds
    s_add_u32 m0, s53, 11904
    s_nop 0
    buffer_load_dwordx4 v8, s[20:23], s55 offen offset:384 lds
    s_add_u32 m0, s53, 15872
    s_nop 0
    buffer_load_dwordx4 v8, s[20:23], s55 offen offset:512 lds
    s_add_u32 s55, s55, s56
    s_add_u32 m0, s53, 20480
    s_nop 0
    buffer_load_dwordx4 v8, s[20:23], s55 offen offset:0 lds
    s_add_u32 m0, s53, 24448
    s_nop 0
    buffer_load_dwordx4 v8, s[20:23], s55 offen offset:128 lds
    s_add_u32 m0, s53, 28416
    s_nop 0
    buffer_load_dwordx4 v8, s[20:23], s55 offen offset:256 lds
    s_add_u32 m0, s53, 32384
    s_nop 0
    buffer_load_dwordx4 v8, s[20:23], s55 offen offset:384 lds
    s_add_u32 m0, s53, 36352
    s_nop 0
    buffer_load_dwordx4 v8, s[20:23], s55 offen offset:512 lds
    s_add_u32 s55, s55, s56
    s_mov_b32 s28, s14
    s_mov_b32 s29, s15
    s_mov_b32 s30, 22020096
    s_mov_b32 s31, 0x00020000
    s_mov_b32 s74, s76
    s_mov_b32 s75, s77
    s_mov_b32 s76, s78
    s_mov_b32 s77, s79
    s_mov_b32 s78, 256
    s_mov_b32 s79, 0x00020000
    s_lshl_b32 s48, s41, 2
    s_add_u32 s48, s48, s37
    s_and_b32 s59, s37, 2
    s_and_b32 s49, s40, 1
    s_sub_u32 s59, s59, s49
    s_lshl_b32 s59, s59, 1
    s_add_u32 s59, s59, s41
    s_lshl_b32 s59, s59, 1
    s_and_b32 s49, s37, 1
    s_add_u32 s59, s59, s49
    s_lshl_b32 s59, s59, 6
    s_lshl_b32 s48, s48, 11
    s_add_u32 s48, s48, 102400
    v_and_b32 v19, 15, v1
    v_lshrrev_b32 v16, 1, v19
    v_xor_b32 v16, v16, v4
    v_lshlrev_b32 v16, 4, v16
    v_lshl_add_u32 v16, v19, 7, v16
    v_add_u32 v16, s48, v16
    v_xor_b32 v17, 64, v16
    v_lshlrev_b32 v18, 4, v4
    v_add_u32 v18, 159744, v18
    v_mov_b32 v20, 0
    v_mov_b32 v24, 0
    v_mov_b32 v25, 0
    v_mov_b32 v26, 0
    v_mov_b32 v27, 0
    v_mov_b32 v28, 161024
    ds_write_b128 v28, v[24:27]
    ds_write_b128 v28, v[24:27] offset:16
    s_waitcnt vmcnt(5)
    s_waitcnt lgkmcnt(0)
    s_barrier
    s_add_u32 m0, s52, 16384
    s_nop 0
    buffer_load_dwordx4 v10, s[16:19], s54 offen lds
    s_add_u32 m0, s52, 17408
    s_nop 0
    buffer_load_dwordx4 v11, s[16:19], s54 offen lds
    s_add_u32 m0, s52, 18432
    s_nop 0
    buffer_load_dwordx4 v12, s[16:19], s54 offen lds
    s_add_u32 m0, s52, 19456
    s_nop 0
    buffer_load_dwordx4 v13, s[16:19], s54 offen lds
    s_add_u32 s54, s54, 128
    s_add_u32 m0, s53, 40960
    s_nop 0
    buffer_load_dwordx4 v8, s[20:23], s55 offen offset:0 lds
    s_add_u32 m0, s53, 44928
    s_nop 0
    buffer_load_dwordx4 v8, s[20:23], s55 offen offset:128 lds
    s_add_u32 m0, s53, 48896
    s_nop 0
    buffer_load_dwordx4 v8, s[20:23], s55 offen offset:256 lds
    s_add_u32 m0, s53, 52864
    s_nop 0
    buffer_load_dwordx4 v8, s[20:23], s55 offen offset:384 lds
    s_cmp_lg_u32 s33, 0
    s_cbranch_scc1 L_g_1
    ds_read_b128 v[24:27], v16 offset:0
    ds_read_b128 v[28:31], v18 offset:0
    s_waitcnt lgkmcnt(0)
    v_mfma_f32_16x16x32_bf16 v[20:23], v[28:31], v[24:27], 0
L_g_1:
    s_waitcnt vmcnt(8)
    s_barrier
    s_add_u32 m0, s53, 56832
    s_nop 0
    buffer_load_dwordx4 v8, s[20:23], s55 offen offset:512 lds
    s_add_u32 s55, s55, s56
    s_add_u32 m0, s53, 61440
    s_nop 0
    buffer_load_dwordx4 v8, s[20:23], s55 offen offset:0 lds
    s_add_u32 m0, s53, 65408
    s_nop 0
    buffer_load_dwordx4 v8, s[20:23], s55 offen offset:128 lds
    s_add_u32 m0, s53, 69376
    s_nop 0
    buffer_load_dwordx4 v8, s[20:23], s55 offen offset:256 lds
    s_add_u32 m0, s53, 73344
    s_nop 0
    buffer_load_dwordx4 v8, s[20:23], s55 offen offset:384 lds
    s_add_u32 m0, s53, 77312
    s_nop 0
    buffer_load_dwordx4 v8, s[20:23], s55 offen offset:512 lds
    s_add_u32 s55, s55, s56
    s_add_u32 m0, s52, 32768
    s_nop 0
    buffer_load_dwordx4 v10, s[16:19], s54 offen lds
    s_add_u32 m0, s52, 33792
    s_nop 0
    buffer_load_dwordx4 v11, s[16:19], s54 offen lds
    s_cmp_lg_u32 s33, 0
    s_cbranch_scc1 L_g_2
    ds_read_b128 v[24:27], v17 offset:0
    ds_read_b128 v[28:31], v18 offset:64
    s_waitcnt lgkmcnt(0)
    v_mfma_f32_16x16x32_bf16 v[20:23], v[28:31], v[24:27], v[20:23]
L_g_2:
    s_waitcnt vmcnt(7)
    s_barrier
    s_add_u32 m0, s52, 34816
    s_nop 0
    buffer_load_dwordx4 v12, s[16:19], s54 offen lds
    s_add_u32 m0, s52, 35840
    s_nop 0
    buffer_load_dwordx4 v13, s[16:19], s54 offen lds
    s_add_u32 s54, s54, 128
    s_add_u32 m0, s53, 81920
    s_nop 0
    buffer_load_dwordx4 v8, s[20:23], s55 offen offset:0 lds
    s_add_u32 m0, s53, 85888
    s_nop 0
    buffer_load_dwordx4 v8, s[20:23], s55 offen offset:128 lds
    s_add_u32 m0, s53, 89856
    s_nop 0
    buffer_load_dwordx4 v8, s[20:23], s55 offen offset:256 lds
    s_add_u32 m0, s53, 93824
    s_nop 0
    buffer_load_dwordx4 v8, s[20:23], s55 offen offset:384 lds
    s_add_u32 m0, s53, 97792
    s_nop 0
    buffer_load_dwordx4 v8, s[20:23], s55 offen offset:512 lds
    s_add_u32 s55, s55, s56
    s_add_u32 m0, s53, 0
    s_nop 0
    buffer_load_dwordx4 v8, s[20:23], s55 offen offset:0 lds
    s_cmp_lg_u32 s33, 0
    s_cbranch_scc1 L_g_3
    ds_read_b128 v[24:27], v16 offset:16384
    ds_read_b128 v[28:31], v18 offset:128
    s_waitcnt lgkmcnt(0)
    v_mfma_f32_16x16x32_bf16 v[20:23], v[28:31], v[24:27], v[20:23]
L_g_3:
    s_waitcnt vmcnt(10)
    s_barrier
    s_add_u32 m0, s53, 3968
    s_nop 0
    buffer_load_dwordx4 v8, s[20:23], s55 offen offset:128 lds
    s_add_u32 m0, s53, 7936
    s_nop 0
    buffer_load_dwordx4 v8, s[20:23], s55 offen offset:256 lds
    s_add_u32 m0, s53, 11904
    s_nop 0
    buffer_load_dwordx4 v8, s[20:23], s55 offen offset:384 lds
    s_add_u32 m0, s53, 15872
    s_nop 0
    buffer_load_dwordx4 v8, s[20:23], s55 offen offset:512 lds
    s_add_u32 s55, s55, s56
    s_add_u32 m0, s52, 0
    s_nop 0
    buffer_load_dwordx4 v10, s[16:19], s54 offen lds
    s_add_u32 m0, s52, 1024
    s_nop 0
    buffer_load_dwordx4 v11, s[16:19], s54 offen lds
    s_add_u32 m0, s52, 2048
    s_nop 0
    buffer_load_dwordx4 v12, s[16:19], s54 offen lds
    s_add_u32 m0, s52, 3072
    s_nop 0
    buffer_load_dwordx4 v13, s[16:19], s54 offen lds
    s_add_u32 s54, s54, 128
    s_cmp_lg_u32 s33, 0
    s_cbranch_scc1 L_g_4
    ds_read_b128 v[24:27], v17 offset:16384
    ds_read_b128 v[28:31], v18 offset:192
    s_waitcnt lgkmcnt(0)
    v_mfma_f32_16x16x32_bf16 v[20:23], v[28:31], v[24:27], v[20:23]
L_g_4:
    s_waitcnt vmcnt(9)
    s_barrier
    s_add_u32 m0, s53, 20480
    s_nop 0
    buffer_load_dwordx4 v8, s[20:23], s55 offen offset:0 lds
    s_add_u32 m0, s53, 24448
    s_nop 0
    buffer_load_dwordx4 v8, s[20:23], s55 offen offset:128 lds
    s_add_u32 m0, s53, 28416
    s_nop 0
    buffer_load_dwordx4 v8, s[20:23], s55 offen offset:256 lds
    s_add_u32 m0, s53, 32384
    s_nop 0
    buffer_load_dwordx4 v8, s[20:23], s55 offen offset:384 lds
    s_add_u32 m0, s53, 36352
    s_nop 0
    buffer_load_dwordx4 v8, s[20:23], s55 offen offset:512 lds
    s_add_u32 s55, s55, s56
    s_add_u32 m0, s53, 40960
    s_nop 0
    buffer_load_dwordx4 v8, s[20:23], s55 offen offset:0 lds
    s_add_u32 m0, s53, 44928
    s_nop 0
    buffer_load_dwordx4 v8, s[20:23], s55 offen offset:128 lds
    s_add_u32 m0, s53, 48896
    s_nop 0
    buffer_load_dwordx4 v8, s[20:23], s55 offen offset:256 lds
    s_cmp_lg_u32 s33, 0
    s_cbranch_scc1 L_g_5
    ds_read_b128 v[24:27], v16 offset:32768
    ds_read_b128 v[28:31], v18 offset:256
    s_waitcnt lgkmcnt(0)
    v_mfma_f32_16x16x32_bf16 v[20:23], v[28:31], v[24:27], v[20:23]
L_g_5:
    s_waitcnt vmcnt(12)
    s_barrier
    s_add_u32 m0, s53, 52864
    s_nop 0
    buffer_load_dwordx4 v8, s[20:23], s55 offen offset:384 lds
    s_add_u32 m0, s53, 56832
    s_nop 0
    buffer_load_dwordx4 v8, s[20:23], s55 offen offset:512 lds
    s_branch L_sk_771
L_pad_ldq_0:
    s_branch L_k1_c_qkv
L_sk_771:
    s_add_u32 s55, s55, s56
    s_add_u32 m0, s52, 16384
    s_nop 0
    buffer_load_dwordx4 v10, s[16:19], s54 offen lds
    s_add_u32 m0, s52, 17408
    s_nop 0
    buffer_load_dwordx4 v11, s[16:19], s54 offen lds
    s_add_u32 m0, s52, 18432
    s_nop 0
    buffer_load_dwordx4 v12, s[16:19], s54 offen lds
    s_add_u32 m0, s52, 19456
    s_nop 0
    buffer_load_dwordx4 v13, s[16:19], s54 offen lds
    s_add_u32 s54, s54, 128
    s_add_u32 m0, s53, 61440
    s_nop 0
    buffer_load_dwordx4 v8, s[20:23], s55 offen offset:0 lds
    s_add_u32 m0, s53, 65408
    s_nop 0
    buffer_load_dwordx4 v8, s[20:23], s55 offen offset:128 lds
    s_cmp_lg_u32 s33, 0
    s_cbranch_scc1 L_g_6
    ds_read_b128 v[24:27], v17 offset:32768
    ds_read_b128 v[28:31], v18 offset:320
    s_waitcnt lgkmcnt(0)
    v_mfma_f32_16x16x32_bf16 v[20:23], v[28:31], v[24:27], v[20:23]
L_g_6:
    s_waitcnt vmcnt(11)
    s_barrier
    s_add_u32 m0, s53, 69376
    s_nop 0
    buffer_load_dwordx4 v8, s[20:23], s55 offen offset:256 lds
    s_add_u32 m0, s53, 73344
    s_nop 0
    buffer_load_dwordx4 v8, s[20:23], s55 offen offset:384 lds
    s_add_u32 m0, s53, 77312
    s_nop 0
    buffer_load_dwordx4 v8, s[20:23], s55 offen offset:512 lds
    s_add_u32 s55, s55, s56
    s_add_u32 m0, s53, 81920
    s_nop 0
    buffer_load_dwordx4 v8, s[20:23], s55 offen offset:0 lds
    s_add_u32 m0, s53, 85888
    s_nop 0
    buffer_load_dwordx4 v8, s[20:23], s55 offen offset:128 lds
    s_add_u32 m0, s53, 89856
    s_nop 0
    buffer_load_dwordx4 v8, s[20:23], s55 offen offset:256 lds
    s_add_u32 m0, s53, 93824
    s_nop 0
    buffer_load_dwordx4 v8, s[20:23], s55 offen offset:384 lds
    s_add_u32 m0, s53, 97792
    s_nop 0
    buffer_load_dwordx4 v8, s[20:23], s55 offen offset:512 lds
    s_add_u32 s55, s55, s56
    s_cmp_lg_u32 s33, 0
    s_cbranch_scc1 L_g_7
    ds_read_b128 v[24:27], v16 offset:0
    ds_read_b128 v[28:31], v18 offset:384
    s_waitcnt lgkmcnt(0)
    v_mfma_f32_16x16x32_bf16 v[20:23], v[28:31], v[24:27], v[20:23]
L_g_7:
    s_waitcnt vmcnt(14)
    s_barrier
    s_add_u32 m0, s52, 32768
    s_nop 0
    buffer_load_dwordx4 v10, s[16:19], s54 offen lds
    s_add_u32 m0, s52, 33792
    s_nop 0
    buffer_load_dwordx4 v11, s[16:19], s54 offen lds
    s_add_u32 m0, s52, 34816
    s_nop 0
    buffer_load_dwordx4 v12, s[16:19], s54 offen lds
    s_add_u32 m0, s52, 35840
    s_nop 0
    buffer_load_dwordx4 v13, s[16:19], s54 offen lds
    s_add_u32 s54, s54, 128
    s_add_u32 m0, s53, 0
    s_nop 0
    buffer_load_dwordx4 v8, s[20:23], s55 offen offset:0 lds
    s_add_u32 m0, s53, 3968
    s_nop 0
    buffer_load_dwordx4 v8, s[20:23], s55 offen offset:128 lds
    s_add_u32 m0, s53, 7936
    s_nop 0
    buffer_load_dwordx4 v8, s[20:23], s55 offen offset:256 lds
    s_add_u32 m0, s53, 11904
    s_nop 0
    buffer_load_dwordx4 v8, s[20:23], s55 offen offset:384 lds
    s_cmp_lg_u32 s33, 0
    s_cbranch_scc1 L_g_8
    ds_read_b128 v[24:27], v17 offset:0
    ds_read_b128 v[28:31], v18 offset:448
    s_waitcnt lgkmcnt(0)
    v_mfma_f32_16x16x32_bf16 v[20:23], v[28:31], v[24:27], v[20:23]
L_g_8:
    s_waitcnt vmcnt(13)
    s_barrier
    s_add_u32 m0, s53, 15872
    s_nop 0
    buffer_load_dwordx4 v8, s[20:23], s55 offen offset:512 lds
    s_add_u32 s55, s55, s56
    s_add_u32 m0, s53, 20480
    s_nop 0
    buffer_load_dwordx4 v8, s[20:23], s55 offen offset:0 lds
    s_add_u32 m0, s53, 24448
    s_nop 0
    buffer_load_dwordx4 v8, s[20:23], s55 offen offset:128 lds
    s_add_u32 m0, s53, 28416
    s_nop 0
    buffer_load_dwordx4 v8, s[20:23], s55 offen offset:256 lds
    s_add_u32 m0, s53, 32384
    s_nop 0
    buffer_load_dwordx4 v8, s[20:23], s55 offen offset:384 lds
    s_add_u32 m0, s53, 36352
    s_nop 0
    buffer_load_dwordx4 v8, s[20:23], s55 offen offset:512 lds
    s_add_u32 s55, s55, s56
    s_cmp_lg_u32 s33, 0
    s_cbranch_scc1 L_g_9
    ds_read_b128 v[24:27], v16 offset:16384
    ds_read_b128 v[28:31], v18 offset:512
    s_waitcnt lgkmcnt(0)
    v_mfma_f32_16x16x32_bf16 v[20:23], v[28:31], v[24:27], v[20:23]
L_g_9:
    s_waitcnt vmcnt(14)
    s_barrier
    s_add_u32 m0, s52, 0
    s_nop 0
    buffer_load_dwordx4 v10, s[16:19], s54 offen lds
    s_add_u32 m0, s52, 1024
    s_nop 0
    buffer_load_dwordx4 v11, s[16:19], s54 offen lds
    s_add_u32 m0, s52, 2048
    s_nop 0
    buffer_load_dwordx4 v12, s[16:19], s54 offen lds
    s_add_u32 m0, s52, 3072
    s_nop 0
    buffer_load_dwordx4 v13, s[16:19], s54 offen lds
    s_add_u32 s54, s54, 128
    s_add_u32 m0, s53, 40960
    s_nop 0
    buffer_load_dwordx4 v8, s[20:23], s55 offen offset:0 lds
    s_add_u32 m0, s53, 44928
    s_nop 0
    buffer_load_dwordx4 v8, s[20:23], s55 offen offset:128 lds
    s_add_u32 m0, s53, 48896
    s_nop 0
    buffer_load_dwordx4 v8, s[20:23], s55 offen offset:256 lds
    s_add_u32 m0, s53, 52864
    s_nop 0
    buffer_load_dwordx4 v8, s[20:23], s55 offen offset:384 lds
    s_cmp_lg_u32 s33, 0
    s_cbranch_scc1 L_g_10
    ds_read_b128 v[24:27], v17 offset:16384
    ds_read_b128 v[28:31], v18 offset:576
    s_waitcnt lgkmcnt(0)
    v_mfma_f32_16x16x32_bf16 v[20:23], v[28:31], v[24:27], v[20:23]
L_g_10:
    s_waitcnt vmcnt(13)
    s_barrier
    s_add_u32 m0, s53, 56832
    s_nop 0
    buffer_load_dwordx4 v8, s[20:23], s55 offen offset:512 lds
    s_add_u32 s55, s55, s56
    s_add_u32 m0, s53, 61440
    s_nop 0
    buffer_load_dwordx4 v8, s[20:23], s55 offen offset:0 lds
    s_add_u32 m0, s53, 65408
    s_nop 0
    buffer_load_dwordx4 v8, s[20:23], s55 offen offset:128 lds
    s_add_u32 m0, s53, 69376
    s_nop 0
    buffer_load_dwordx4 v8, s[20:23], s55 offen offset:256 lds
    s_add_u32 m0, s53, 73344
    s_nop 0
    buffer_load_dwordx4 v8, s[20:23], s55 offen offset:384 lds
    s_add_u32 m0, s53, 77312
    s_nop 0
    buffer_load_dwordx4 v8, s[20:23], s55 offen offset:512 lds
    s_add_u32 s55, s55, s56
    s_cmp_lg_u32 s33, 0
    s_cbranch_scc1 L_g_11
    ds_read_b128 v[24:27], v16 offset:32768
    ds_read_b128 v[28:31], v18 offset:640
    s_waitcnt lgkmcnt(0)
    v_mfma_f32_16x16x32_bf16 v[20:23], v[28:31], v[24:27], v[20:23]
L_g_11:
    s_waitcnt vmcnt(14)
    s_barrier
    s_add_u32 m0, s52, 16384
    s_nop 0
    buffer_load_dwordx4 v10, s[16:19], s54 offen lds
    s_add_u32 m0, s52, 17408
    s_nop 0
    buffer_load_dwordx4 v11, s[16:19], s54 offen lds
    s_add_u32 m0, s52, 18432
    s_nop 0
    buffer_load_dwordx4 v12, s[16:19], s54 offen lds
    s_add_u32 m0, s52, 19456
    s_nop 0
    buffer_load_dwordx4 v13, s[16:19], s54 offen lds
    s_add_u32 s54, s54, 128
    s_add_u32 m0, s53, 81920
    s_nop 0
    buffer_load_dwordx4 v8, s[20:23], s55 offen offset:0 lds
    s_add_u32 m0, s53, 85888
    s_nop 0
    buffer_load_dwordx4 v8, s[20:23], s55 offen offset:128 lds
    s_add_u32 m0, s53, 89856
    s_nop 0
    buffer_load_dwordx4 v8, s[20:23], s55 offen offset:256 lds
    s_add_u32 m0, s53, 93824
    s_nop 0
    buffer_load_dwordx4 v8, s[20:23], s55 offen offset:384 lds
    s_cmp_lg_u32 s33, 0
    s_cbranch_scc1 L_g_12
    ds_read_b128 v[24:27], v17 offset:32768
    ds_read_b128 v[28:31], v18 offset:704
    s_waitcnt lgkmcnt(0)
    v_mfma_f32_16x16x32_bf16 v[20:23], v[28:31], v[24:27], v[20:23]
L_g_12:
    s_waitcnt vmcnt(13)
    s_barrier
    s_add_u32 m0, s53, 97792
    s_nop 0
    buffer_load_dwordx4 v8, s[20:23], s55 offen offset:512 lds
    s_add_u32 s55, s55, s56
    s_add_u32 m0, s53, 0
    s_nop 0
    buffer_load_dwordx4 v8, s[20:23], s55 offen offset:0 lds
    s_add_u32 m0, s53, 3968
    s_nop 0
    buffer_load_dwordx4 v8, s[20:23], s55 offen offset:128 lds
    s_add_u32 m0, s53, 7936
    s_nop 0
    buffer_load_dwordx4 v8, s[20:23], s55 offen offset:256 lds
    s_add_u32 m0, s53, 11904
    s_nop 0
    buffer_load_dwordx4 v8, s[20:23], s55 offen offset:384 lds
    s_add_u32 m0, s53, 15872
    s_nop 0
    buffer_load_dwordx4 v8, s[20:23], s55 offen offset:512 lds
    s_add_u32 s55, s55, s56
    s_cmp_lg_u32 s33, 0
    s_cbranch_scc1 L_g_13
    ds_read_b128 v[24:27], v16 offset:0
    ds_read_b128 v[28:31], v18 offset:768
    s_waitcnt lgkmcnt(0)
    v_mfma_f32_16x16x32_bf16 v[20:23], v[28:31], v[24:27], v[20:23]
L_g_13:
    s_waitcnt vmcnt(14)
    s_barrier
    s_add_u32 m0, s52, 32768
    s_nop 0
    buffer_load_dwordx4 v10, s[16:19], s54 offen lds
    s_add_u32 m0, s52, 33792
    s_nop 0
    buffer_load_dwordx4 v11, s[16:19], s54 offen lds
    s_add_u32 m0, s52, 34816
    s_nop 0
    buffer_load_dwordx4 v12, s[16:19], s54 offen lds
    s_add_u32 m0, s52, 35840
    s_nop 0
    buffer_load_dwordx4 v13, s[16:19], s54 offen lds
    s_add_u32 s54, s54, 128
    s_add_u32 m0, s53, 20480
    s_nop 0
    buffer_load_dwordx4 v8, s[20:23], s55 offen offset:0 lds
    s_add_u32 m0, s53, 24448
    s_nop 0
    buffer_load_dwordx4 v8, s[20:23], s55 offen offset:128 lds
    s_add_u32 m0, s53, 28416
    s_nop 0
    buffer_load_dwordx4 v8, s[20:23], s55 offen offset:256 lds
    s_add_u32 m0, s53, 32384
    s_nop 0
    buffer_load_dwordx4 v8, s[20:23], s55 offen offset:384 lds
    s_cmp_lg_u32 s33, 0
    s_cbranch_scc1 L_g_14
    ds_read_b128 v[24:27], v17 offset:0
    ds_read_b128 v[28:31], v18 offset:832
    s_waitcnt lgkmcnt(0)
    v_mfma_f32_16x16x32_bf16 v[20:23], v[28:31], v[24:27], v[20:23]
L_g_14:
    s_waitcnt vmcnt(13)
    s_barrier
    s_add_u32 m0, s53, 36352
    s_nop 0
    buffer_load_dwordx4 v8, s[20:23], s55 offen offset:512 lds
    s_add_u32 s55, s55, s56
    s_add_u32 m0, s53, 40960
    s_nop 0
    buffer_load_dwordx4 v8, s[20:23], s55 offen offset:0 lds
    s_add_u32 m0, s53, 44928
    s_nop 0
    buffer_load_dwordx4 v8, s[20:23], s55 offen offset:128 lds
    s_add_u32 m0, s53, 48896
    s_nop 0
    buffer_load_dwordx4 v8, s[20:23], s55 offen offset:256 lds
    s_add_u32 m0, s53, 52864
    s_nop 0
    buffer_load_dwordx4 v8, s[20:23], s55 offen offset:384 lds
    s_add_u32 m0, s53, 56832
    s_nop 0
    buffer_load_dwordx4 v8, s[20:23], s55 offen offset:512 lds
    s_add_u32 s55, s55, s56
    s_cmp_lg_u32 s33, 0
    s_cbranch_scc1 L_g_15
    ds_read_b128 v[24:27], v16 offset:16384
    ds_read_b128 v[28:31], v18 offset:896
    s_waitcnt lgkmcnt(0)
    v_mfma_f32_16x16x32_bf16 v[20:23], v[28:31], v[24:27], v[20:23]
L_g_15:
    s_waitcnt vmcnt(14)
    s_barrier
    s_add_u32 m0, s52, 0
    s_nop 0
    buffer_load_dwordx4 v10, s[16:19], s54 offen lds
    s_add_u32 m0, s52, 1024
    s_nop 0
    buffer_load_dwordx4 v11, s[16:19], s54 offen lds
    s_add_u32 m0, s52, 2048
    s_nop 0
    buffer_load_dwordx4 v12, s[16:19], s54 offen lds
    s_add_u32 m0, s52, 3072
    s_nop 0
    buffer_load_dwordx4 v13, s[16:19], s54 offen lds
    s_add_u32 s54, s54, 128
    s_add_u32 m0, s53, 61440
    s_nop 0
    buffer_load_dwordx4 v8, s[20:23], s55 offen offset:0 lds
    s_add_u32 m0, s53, 65408
    s_nop 0
    buffer_load_dwordx4 v8, s[20:23], s55 offen offset:128 lds
    s_add_u32 m0, s53, 69376
    s_nop 0
    buffer_load_dwordx4 v8, s[20:23], s55 offen offset:256 lds
    s_add_u32 m0, s53, 73344
    s_nop 0
    buffer_load_dwordx4 v8, s[20:23], s55 offen offset:384 lds
    s_cmp_lg_u32 s33, 0
    s_cbranch_scc1 L_g_16
    ds_read_b128 v[24:27], v17 offset:16384
    ds_read_b128 v[28:31], v18 offset:960
    s_waitcnt lgkmcnt(0)
    v_mfma_f32_16x16x32_bf16 v[20:23], v[28:31], v[24:27], v[20:23]
L_g_16:
    s_waitcnt vmcnt(13)
    s_barrier
    s_add_u32 m0, s53, 77312
    s_nop 0
    buffer_load_dwordx4 v8, s[20:23], s55 offen offset:512 lds
    s_add_u32 s55, s55, s56
    s_add_u32 m0, s53, 81920
    s_nop 0
    buffer_load_dwordx4 v8, s[20:23], s55 offen offset:0 lds
    s_add_u32 m0, s53, 85888
    s_nop 0
    buffer_load_dwordx4 v8, s[20:23], s55 offen offset:128 lds
    s_add_u32 m0, s53, 89856
    s_nop 0
    buffer_load_dwordx4 v8, s[20:23], s55 offen offset:256 lds
    s_add_u32 m0, s53, 93824
    s_nop 0
    buffer_load_dwordx4 v8, s[20:23], s55 offen offset:384 lds
    s_add_u32 m0, s53, 97792
    s_nop 0
    buffer_load_dwordx4 v8, s[20:23], s55 offen offset:512 lds
    s_add_u32 s55, s55, s56
    buffer_load_dword v46, off, s[76:79], 0 sc1
    s_cmp_lg_u32 s33, 0
    s_cbranch_scc1 L_g_17
    ds_read_b128 v[24:27], v16 offset:32768
    ds_read_b128 v[28:31], v18 offset:1024
    s_waitcnt lgkmcnt(0)
    v_mfma_f32_16x16x32_bf16 v[20:23], v[28:31], v[24:27], v[20:23]
L_g_17:
    s_waitcnt vmcnt(15)
    s_barrier
    s_cmp_lg_u32 s33, 0
    s_cbranch_scc1 L_g_18
    ds_read_b128 v[24:27], v17 offset:32768
    ds_read_b128 v[28:31], v18 offset:1088
    s_waitcnt lgkmcnt(0)
    v_mfma_f32_16x16x32_bf16 v[20:23], v[28:31], v[24:27], v[20:23]
L_g_18:
    s_waitcnt vmcnt(6)
    s_barrier
    s_waitcnt vmcnt(1)
    s_barrier
    s_waitcnt vmcnt(0)
    s_cmp_eq_u32 s37, 0
    s_cbranch_scc1 L_pad_att_0
    s_cmp_eq_u32 s37, 1
    s_cbranch_scc1 L_pad_att_1
    s_cmp_eq_u32 s37, 2
    s_cbranch_scc1 L_pad_att_2
    s_cmp_eq_u32 s37, 3
    s_cbranch_scc1 L_pad_att_3
    s_branch L_ldone
L_pad_ldf_0:
    s_branch L_k1_c_ffn
L_ldb_ffn:
    s_waitcnt vmcnt(5)
    s_waitcnt lgkmcnt(0)
    s_barrier
    s_add_u32 m0, s52, 21504
    s_nop 0
    buffer_load_dwordx4 v11, s[16:19], s54 offen lds
    s_add_u32 m0, s52, 22528
    s_nop 0
    buffer_load_dwordx4 v12, s[16:19], s54 offen lds
    s_add_u32 m0, s52, 23552
    s_nop 0
    buffer_load_dwordx4 v13, s[16:19], s54 offen lds
    s_add_u32 m0, s52, 24576
    s_nop 0
    buffer_load_dwordx4 v14, s[16:19], s54 offen lds
    s_add_u32 s54, s54, 128
    s_add_u32 m0, s53, 32768
    s_nop 0
    buffer_load_dwordx4 v8, s[20:23], s55 offen offset:0 lds
    s_add_u32 m0, s53, 36736
    s_nop 0
    buffer_load_dwordx4 v8, s[20:23], s55 offen offset:128 lds
    s_add_u32 m0, s53, 40960
    s_nop 0
    buffer_load_dwordx4 v8, s[24:27], s55 offen offset:0 lds
    s_add_u32 m0, s53, 44928
    s_nop 0
    buffer_load_dwordx4 v8, s[24:27], s55 offen offset:128 lds
    s_add_u32 s55, s55, s56
    s_waitcnt vmcnt(9)
    s_barrier
    s_add_u32 m0, s53, 49152
    s_nop 0
    buffer_load_dwordx4 v8, s[20:23], s55 offen offset:0 lds
    s_add_u32 m0, s53, 53120
    s_nop 0
    buffer_load_dwordx4 v8, s[20:23], s55 offen offset:128 lds
    s_add_u32 m0, s53, 57344
    s_nop 0
    buffer_load_dwordx4 v8, s[24:27], s55 offen offset:0 lds
    s_add_u32 m0, s53, 61312
    s_nop 0
    buffer_load_dwordx4 v8, s[24:27], s55 offen offset:128 lds
    s_add_u32 s55, s55, s56
    s_add_u32 m0, s52, 40960
    s_nop 0
    buffer_load_dwordx4 v10, s[16:19], s54 offen lds
    s_add_u32 m0, s52, 41984
    s_nop 0
    buffer_load_dwordx4 v11, s[16:19], s54 offen lds
    s_add_u32 m0, s52, 43008
    s_nop 0
    buffer_load_dwordx4 v12, s[16:19], s54 offen lds
    s_add_u32 m0, s52, 44032
    s_nop 0
    buffer_load_dwordx4 v13, s[16:19], s54 offen lds
    s_waitcnt vmcnt(8)
    s_barrier
    s_add_u32 m0, s52, 45056
    s_nop 0
    buffer_load_dwordx4 v14, s[16:19], s54 offen lds
    s_add_u32 s54, s54, 128
    s_add_u32 m0, s53, 65536
    s_nop 0
    buffer_load_dwordx4 v8, s[20:23], s55 offen offset:0 lds
    s_add_u32 m0, s53, 69504
    s_nop 0
    buffer_load_dwordx4 v8, s[20:23], s55 offen offset:128 lds
    s_add_u32 m0, s53, 73728
    s_nop 0
    buffer_load_dwordx4 v8, s[24:27], s55 offen offset:0 lds
    s_add_u32 m0, s53, 77696
    s_nop 0
    buffer_load_dwordx4 v8, s[24:27], s55 offen offset:128 lds
    s_add_u32 s55, s55, s56
    s_add_u32 m0, s53, 81920
    s_nop 0
    buffer_load_dwordx4 v8, s[20:23], s55 offen offset:0 lds
    s_add_u32 m0, s53, 85888
    s_nop 0
    buffer_load_dwordx4 v8, s[20:23], s55 offen offset:128 lds
    s_add_u32 m0, s53, 90112
    s_nop 0
    buffer_load_dwordx4 v8, s[24:27], s55 offen offset:0 lds
    buffer_load_dword v45, v44, s[12:15], s4 offen sc1
    s_add_u32 s4, s4, s5
    s_waitcnt vmcnt(13)
    s_barrier
    s_add_u32 m0, s53, 94080
    s_nop 0
    buffer_load_dwordx4 v8, s[24:27], s55 offen offset:128 lds
    s_add_u32 s55, s55, s56
    s_add_u32 m0, s52, 0
    s_nop 0
    buffer_load_dwordx4 v10, s[16:19], s54 offen lds
    s_add_u32 m0, s52, 1024
    s_nop 0
    buffer_load_dwordx4 v11, s[16:19], s54 offen lds
    s_add_u32 m0, s52, 2048
    s_nop 0
    buffer_load_dwordx4 v12, s[16:19], s54 offen lds
    s_add_u32 m0, s52, 3072
    s_nop 0
    buffer_load_dwordx4 v13, s[16:19], s54 offen lds
    s_add_u32 m0, s52, 4096
    s_nop 0
    buffer_load_dwordx4 v14, s[16:19], s54 offen lds
    s_add_u32 s54, s54, 128
    s_add_u32 m0, s53, 0
    s_nop 0
    buffer_load_dwordx4 v8, s[20:23], s55 offen offset:0 lds
    s_add_u32 m0, s53, 3968
    s_nop 0
    buffer_load_dwordx4 v8, s[20:23], s55 offen offset:128 lds
    s_waitcnt vmcnt(12)
    s_barrier
    s_add_u32 m0, s53, 8192
    s_nop 0
    buffer_load_dwordx4 v8, s[24:27], s55 offen offset:0 lds
    s_add_u32 m0, s53, 12160
    s_nop 0
    buffer_load_dwordx4 v8, s[24:27], s55 offen offset:128 lds
    s_add_u32 s55, s55, s56
    s_add_u32 m0, s53, 16384
    s_nop 0
    buffer_load_dwordx4 v8, s[20:23], s55 offen offset:0 lds
    s_add_u32 m0, s53, 20352
    s_nop 0
    buffer_load_dwordx4 v8, s[20:23], s55 offen offset:128 lds
    s_add_u32 m0, s53, 24576
    s_nop 0
    buffer_load_dwordx4 v8, s[24:27], s55 offen offset:0 lds
    s_add_u32 m0, s53, 28544
    s_nop 0
    buffer_load_dwordx4 v8, s[24:27], s55 offen offset:128 lds
    s_add_u32 s55, s55, s56
    s_waitcnt vmcnt(13)
    s_barrier
    s_add_u32 m0, s52, 20480
    s_nop 0
    buffer_load_dwordx4 v10, s[16:19], s54 offen lds
    s_add_u32 m0, s52, 21504
    s_nop 0
    buffer_load_dwordx4 v11, s[16:19], s54 offen lds
    s_add_u32 m0, s52, 22528
    s_nop 0
    buffer_load_dwordx4 v12, s[16:19], s54 offen lds
    s_add_u32 m0, s52, 23552
    s_nop 0
    buffer_load_dwordx4 v13, s[16:19], s54 offen lds
    s_add_u32 m0, s52, 24576
    s_nop 0
    buffer_load_dwordx4 v14, s[16:19], s54 offen lds
    s_add_u32 s54, s54, 128
    s_add_u32 m0, s53, 32768
    s_nop 0
    buffer_load_dwordx4 v8, s[20:23], s55 offen offset:0 lds
    s_add_u32 m0, s53, 36736
    s_nop 0
    buffer_load_dwordx4 v8, s[20:23], s55 offen offset:128 lds
    s_add_u32 m0, s53, 40960
    s_nop 0
    buffer_load_dwordx4 v8, s[24:27], s55 offen offset:0 lds
    s_waitcnt vmcnt(12)
    s_barrier
    s_add_u32 m0, s53, 44928
    s_nop 0
    buffer_load_dwordx4 v8, s[24:27], s55 offen offset:128 lds
    s_add_u32 s55, s55, s56
    s_add_u32 m0, s53, 49152
    s_nop 0
    buffer_load_dwordx4 v8, s[20:23], s55 offen offset:0 lds
    s_add_u32 m0, s53, 53120
    s_nop 0
    buffer_load_dwordx4 v8, s[20:23], s55 offen offset:128 lds
    s_add_u32 m0, s53, 57344
    s_nop 0
    buffer_load_dwordx4 v8, s[24:27], s55 offen offset:0 lds
    s_add_u32 m0, s53, 61312
    s_nop 0
    buffer_load_dwordx4 v8, s[24:27], s55 offen offset:128 lds
    s_add_u32 s55, s55, s56
    buffer_load_dword v45, v44, s[12:15], s4 offen sc1
    s_add_u32 s4, s4, s5
    s_waitcnt vmcnt(14)
    s_barrier
    s_add_u32 m0, s52, 40960
    s_nop 0
    buffer_load_dwordx4 v10, s[16:19], s54 offen lds
    s_add_u32 m0, s52, 41984
    s_nop 0
    buffer_load_dwordx4 v11, s[16:19], s54 offen lds
    s_add_u32 m0, s52, 43008
    s_nop 0
    buffer_load_dwordx4 v12, s[16:19], s54 offen lds
    s_add_u32 m0, s52, 44032
    s_nop 0
    buffer_load_dwordx4 v13, s[16:19], s54 offen lds
    s_add_u32 m0, s52, 45056
    s_nop 0
    buffer_load_dwordx4 v14, s[16:19], s54 offen lds
    s_add_u32 s54, s54, 128
    s_add_u32 m0, s53, 65536
    s_nop 0
    buffer_load_dwordx4 v8, s[20:23], s55 offen offset:0 lds
    s_add_u32 m0, s53, 69504
    s_nop 0
    buffer_load_dwordx4 v8, s[20:23], s55 offen offset:128 lds
    s_add_u32 m0, s53, 73728
    s_nop 0
    buffer_load_dwordx4 v8, s[24:27], s55 offen offset:0 lds
    s_waitcnt vmcnt(13)
    s_barrier
    s_add_u32 m0, s53, 77696
    s_nop 0
    buffer_load_dwordx4 v8, s[24:27], s55 offen offset:128 lds
    s_add_u32 s55, s55, s56
    s_add_u32 m0, s53, 81920
    s_nop 0
    buffer_load_dwordx4 v8, s[20:23], s55 offen offset:0 lds
    s_add_u32 m0, s53, 85888
    s_nop 0
    buffer_load_dwordx4 v8, s[20:23], s55 offen offset:128 lds
    s_add_u32 m0, s53, 90112
    s_nop 0
    buffer_load_dwordx4 v8, s[24:27], s55 offen offset:0 lds
    s_add_u32 m0, s53, 94080
    s_nop 0
    buffer_load_dwordx4 v8, s[24:27], s55 offen offset:128 lds
    s_add_u32 s55, s55, s56
    s_waitcnt vmcnt(14)
    s_barrier
    s_add_u32 m0, s52, 0
    s_nop 0
    buffer_load_dwordx4 v10, s[16:19], s54 offen lds
    s_add_u32 m0, s52, 1024
    s_nop 0
    buffer_load_dwordx4 v11, s[16:19], s54 offen lds
    s_add_u32 m0, s52, 2048
    s_nop 0
    buffer_load_dwordx4 v12, s[16:19], s54 offen lds
    s_add_u32 m0, s52, 3072
    s_nop 0
    buffer_load_dwordx4 v13, s[16:19], s54 offen lds
    s_add_u32 m0, s52, 4096
    s_nop 0
    buffer_load_dwordx4 v14, s[16:19], s54 offen lds
    s_add_u32 s54, s54, 128
    s_add_u32 m0, s53, 0
    s_nop 0
    buffer_load_dwordx4 v8, s[20:23], s55 offen offset:0 lds
    s_add_u32 m0, s53, 3968
    s_nop 0
    buffer_load_dwordx4 v8, s[20:23], s55 offen offset:128 lds
    s_add_u32 m0, s53, 8192
    s_nop 0
    buffer_load_dwordx4 v8, s[24:27], s55 offen offset:0 lds
    s_waitcnt vmcnt(12)
    s_barrier
    s_add_u32 m0, s53, 12160
    s_nop 0
    buffer_load_dwordx4 v8, s[24:27], s55 offen offset:128 lds
    s_add_u32 s55, s55, s56
    s_add_u32 m0, s53, 16384
    s_nop 0
    buffer_load_dwordx4 v8, s[20:23], s55 offen offset:0 lds
    s_add_u32 m0, s53, 20352
    s_nop 0
    buffer_load_dwordx4 v8, s[20:23], s55 offen offset:128 lds
    s_branch L_sk_1448
L_pad_ldf_1:
    s_branch L_k1_c_ffn
L_sk_1448:
    s_add_u32 m0, s53, 24576
    s_nop 0
    buffer_load_dwordx4 v8, s[24:27], s55 offen offset:0 lds
    s_add_u32 m0, s53, 28544
    s_nop 0
    buffer_load_dwordx4 v8, s[24:27], s55 offen offset:128 lds
    s_add_u32 s55, s55, s56
    buffer_load_dword v45, v44, s[12:15], s4 offen sc1
    s_add_u32 s4, s4, s5
    s_waitcnt vmcnt(14)
    s_barrier
    s_add_u32 m0, s52, 20480
    s_nop 0
    buffer_load_dwordx4 v10, s[16:19], s54 offen lds
    s_add_u32 m0, s52, 21504
    s_nop 0
    buffer_load_dwordx4 v11, s[16:19], s54 offen lds
    s_add_u32 m0, s52, 22528
    s_nop 0
    buffer_load_dwordx4 v12, s[16:19], s54 offen lds
    s_add_u32 m0, s52, 23552
    s_nop 0
    buffer_load_dwordx4 v13, s[16:19], s54 offen lds
    s_add_u32 m0, s52, 24576
    s_nop 0
    buffer_load_dwordx4 v14, s[16:19], s54 offen lds
    s_add_u32 s54, s54, 128
    s_add_u32 m0, s53, 32768
    s_nop 0
    buffer_load_dwordx4 v8, s[20:23], s55 offen offset:0 lds
    s_add_u32 m0, s53, 36736
    s_nop 0
    buffer_load_dwordx4 v8, s[20:23], s55 offen offset:128 lds
    s_add_u32 m0, s53, 40960
    s_nop 0
    buffer_load_dwordx4 v8, s[24:27], s55 offen offset:0 lds
    s_waitcnt vmcnt(13)
    s_barrier
    s_add_u32 m0, s53, 44928
    s_nop 0
    buffer_load_dwordx4 v8, s[24:27], s55 offen offset:128 lds
    s_add_u32 s55, s55, s56
    s_add_u32 m0, s53, 49152
    s_nop 0
    buffer_load_dwordx4 v8, s[20:23], s55 offen offset:0 lds
    s_add_u32 m0, s53, 53120
    s_nop 0
    buffer_load_dwordx4 v8, s[20:23], s55 offen offset:128 lds
    s_add_u32 m0, s53, 57344
    s_nop 0
    buffer_load_dwordx4 v8, s[24:27], s55 offen offset:0 lds
    s_add_u32 m0, s53, 61312
    s_nop 0
    buffer_load_dwordx4 v8, s[24:27], s55 offen offset:128 lds
    s_add_u32 s55, s55, s56
    s_waitcnt vmcnt(14)
    s_barrier
    s_add_u32 m0, s52, 40960
    s_nop 0
    buffer_load_dwordx4 v10, s[16:19], s54 offen lds
    s_add_u32 m0, s52, 41984
    s_nop 0
    buffer_load_dwordx4 v11, s[16:19], s54 offen lds
    s_add_u32 m0, s52, 43008
    s_nop 0
    buffer_load_dwordx4 v12, s[16:19], s54 offen lds
    s_add_u32 m0, s52, 44032
    s_nop 0
    buffer_load_dwordx4 v13, s[16:19], s54 offen lds
    s_add_u32 m0, s52, 45056
    s_nop 0
    buffer_load_dwordx4 v14, s[16:19], s54 offen lds
    s_add_u32 s54, s54, 128
    s_add_u32 m0, s53, 65536
    s_nop 0
    buffer_load_dwordx4 v8, s[20:23], s55 offen offset:0 lds
    s_add_u32 m0, s53, 69504
    s_nop 0
    buffer_load_dwordx4 v8, s[20:23], s55 offen offset:128 lds
    s_add_u32 m0, s53, 73728
    s_nop 0
    buffer_load_dwordx4 v8, s[24:27], s55 offen offset:0 lds
    s_waitcnt vmcnt(12)
    s_barrier
    s_add_u32 m0, s53, 77696
    s_nop 0
    buffer_load_dwordx4 v8, s[24:27], s55 offen offset:128 lds
    s_add_u32 s55, s55, s56
    s_add_u32 m0, s53, 81920
    s_nop 0
    buffer_load_dwordx4 v8, s[20:23], s55 offen offset:0 lds
    s_add_u32 m0, s53, 85888
    s_nop 0
    buffer_load_dwordx4 v8, s[20:23], s55 offen offset:128 lds
    s_add_u32 m0, s53, 90112
    s_nop 0
    buffer_load_dwordx4 v8, s[24:27], s55 offen offset:0 lds
    s_add_u32 m0, s53, 94080
    s_nop 0
    buffer_load_dwordx4 v8, s[24:27], s55 offen offset:128 lds
    s_add_u32 s55, s55, s56
    s_waitcnt vmcnt(13)
    s_barrier
    s_add_u32 m0, s52, 0
    s_nop 0
    buffer_load_dwordx4 v10, s[16:19], s54 offen lds
    s_add_u32 m0, s52, 1024
    s_nop 0
    buffer_load_dwordx4 v11, s[16:19], s54 offen lds
    s_add_u32 m0, s52, 2048
    s_nop 0
    buffer_load_dwordx4 v12, s[16:19], s54 offen lds
    s_add_u32 m0, s52, 3072
    s_nop 0
    buffer_load_dwordx4 v13, s[16:19], s54 offen lds
    s_add_u32 m0, s52, 4096
    s_nop 0
    buffer_load_dwordx4 v14, s[16:19], s54 offen lds
    s_add_u32 s54, s54, 128
    s_add_u32 m0, s53, 0
    s_nop 0
    buffer_load_dwordx4 v8, s[20:23], s55 offen offset:0 lds
    s_add_u32 m0, s53, 3968
    s_nop 0
    buffer_load_dwordx4 v8, s[20:23], s55 offen offset:128 lds
    s_add_u32 m0, s53, 8192
    s_nop 0
    buffer_load_dwordx4 v8, s[24:27], s55 offen offset:0 lds
    s_waitcnt vmcnt(12)
    s_barrier
    s_add_u32 m0, s53, 12160
    s_nop 0
    buffer_load_dwordx4 v8, s[24:27], s55 offen offset:128 lds
    s_add_u32 s55, s55, s56
    s_add_u32 m0, s53, 16384
    s_nop 0
    buffer_load_dwordx4 v8, s[20:23], s55 offen offset:0 lds
    s_add_u32 m0, s53, 20352
    s_nop 0
    buffer_load_dwordx4 v8, s[20:23], s55 offen offset:128 lds
    s_add_u32 m0, s53, 24576
    s_nop 0
    buffer_load_dwordx4 v8, s[24:27], s55 offen offset:0 lds
    s_add_u32 m0, s53, 28544
    s_nop 0
    buffer_load_dwordx4 v8, s[24:27], s55 offen offset:128 lds
    s_add_u32 s55, s55, s56
    buffer_load_dwordx4 v[60:63], v52, s[64:67], s58 offen
    buffer_load_dwordx4 v[64:67], v53, s[64:67], s58 offen
    buffer_load_dwordx4 v[68:71], v54, s[64:67], s58 offen
    buffer_load_dwordx4 v[72:75], v55, s[64:67], s58 offen
    buffer_load_dwordx4 v[76:79], v56, s[64:67], s58 offen
    buffer_load_dword v46, off, s[76:79], 0 sc1
    s_waitcnt vmcnt(19)
    s_barrier
    s_waitcnt vmcnt(10)
    s_barrier
    s_waitcnt vmcnt(6)
    s_barrier
    s_waitcnt vmcnt(0)
    ds_write_b128 v47, v[60:63] offset:0
    ds_write_b128 v47, v[64:67] offset:1024
    ds_write_b128 v47, v[68:71] offset:2048
    ds_write_b128 v47, v[72:75] offset:3072
    ds_write_b128 v47, v[76:79] offset:4096
    s_waitcnt lgkmcnt(0)
    ds_read_b64_tr_b16 v[60:61], v48 offset:0
    ds_read_b64_tr_b16 v[62:63], v48 offset:1280
    ds_read_b64_tr_b16 v[64:65], v48 offset:8
    ds_read_b64_tr_b16 v[66:67], v48 offset:1288
    ds_read_b64_tr_b16 v[68:69], v49 offset:0
    ds_read_b64_tr_b16 v[70:71], v49 offset:1280
    ds_read_b64_tr_b16 v[72:73], v49 offset:8
    ds_read_b64_tr_b16 v[74:75], v49 offset:1288
    ds_read_b64_tr_b16 v[76:77], v49 offset:16
    ds_read_b64_tr_b16 v[78:79], v49 offset:1296
    s_cmp_lt_u32 s60, 17
    s_cbranch_scc0 L_nwo
    s_waitcnt lgkmcnt(0)
    buffer_store_dwordx4 v[60:63], v0, s[28:31], s69 offen offset:0 sc1
    buffer_store_dwordx4 v[64:67], v0, s[28:31], s69 offen offset:1024 sc1
    buffer_store_dwordx4 v[68:71], v0, s[28:31], s69 offen offset:2048 sc1
    buffer_store_dwordx4 v[72:75], v0, s[28:31], s69 offen offset:3072 sc1
    buffer_store_dwordx4 v[76:79], v0, s[28:31], s68 offen offset:0 sc1
L_nwo:
    s_cmp_eq_u32 s37, 0
    s_cbranch_scc1 L_pad_att_0
    s_cmp_eq_u32 s37, 1
    s_cbranch_scc1 L_pad_att_1
    s_cmp_eq_u32 s37, 2
    s_cbranch_scc1 L_pad_att_2
    s_cmp_eq_u32 s37, 3
    s_cbranch_scc1 L_pad_att_3
    s_branch L_ldone
L_k1_c_qkv:
    s_mov_b32 s18, 2621440
    s_mov_b32 s19, 0x00020000
    s_mov_b32 s22, 2457600
    s_mov_b32 s23, 0x00020000
    s_mov_b32 s26, 2457600
    s_mov_b32 s27, 0x00020000
    s_waitcnt lgkmcnt(0)
    s_mov_b64 s[16:17], s[4:5]
    s_mov_b64 s[20:21], s[6:7]
    s_mov_b64 s[24:25], s[6:7]
    s_mov_b32 s28, s14
    s_mov_b32 s29, s15
    s_mov_b32 s30, 22020096
    s_mov_b32 s31, 0x00020000
    s_mov_b32 s74, s76
    s_mov_b32 s75, s77
    s_mov_b32 s76, s78
    s_mov_b32 s77, s79
    s_mov_b32 s78, 256
    s_mov_b32 s79, 0x00020000
    s_and_b32 s50, s36, 1
    s_lshr_b32 s51, s36, 1
    s_mul_i32 s48, s50, 8192
    s_add_u32 s48, s48, 102400
    v_and_b32 v68, 15, v1
    v_lshrrev_b32 v69, 4, v1
    v_lshrrev_b32 v70, 1, v68
    v_xor_b32 v70, v70, v69
    v_lshlrev_b32 v70, 4, v70
    v_lshl_add_u32 v70, v68, 7, v70
    v_add_u32 v86, s48, v70
    v_xor_b32 v87, 64, v86
    v_lshrrev_b32 v70, 2, v68
    v_lshl_add_u32 v71, v69, 3, v70
    v_lshlrev_b32 v71, 7, v71
    v_lshrrev_b32 v70, 1, v70
    v_and_b32 v72, 1, v69
    v_lshlrev_b32 v72, 2, v72
    v_and_b32 v73, 3, v68
    v_lshl_or_b32 v72, v70, 1, v72
    s_mul_i32 s48, s51, 20
    v_mad_u32_u24 v73, v73, 5, s48
    v_add_u32 v74, 0, v73
    v_lshrrev_b32 v75, 4, v74
    v_lshl_add_u32 v76, v75, 12, v71
    v_bfe_u32 v75, v74, 1, 3
    v_xor_b32 v75, v75, v72
    v_lshl_add_u32 v76, v75, 4, v76
    v_and_b32 v75, 1, v74
    v_lshl_add_u32 v6, v75, 3, v76
    v_add_u32 v11, 61440, v6
    v_add_u32 v74, 1, v73
    v_lshrrev_b32 v75, 4, v74
    v_lshl_add_u32 v76, v75, 12, v71
    v_bfe_u32 v75, v74, 1, 3
    v_xor_b32 v75, v75, v72
    v_lshl_add_u32 v76, v75, 4, v76
    v_and_b32 v75, 1, v74
    v_lshl_add_u32 v7, v75, 3, v76
    v_add_u32 v12, 61440, v7
    v_add_u32 v74, 2, v73
    v_lshrrev_b32 v75, 4, v74
    v_lshl_add_u32 v76, v75, 12, v71
    v_bfe_u32 v75, v74, 1, 3
    v_xor_b32 v75, v75, v72
    v_lshl_add_u32 v76, v75, 4, v76
    v_and_b32 v75, 1, v74
    v_lshl_add_u32 v8, v75, 3, v76
    v_add_u32 v13, 61440, v8
    v_add_u32 v74, 3, v73
    v_lshrrev_b32 v75, 4, v74
    v_lshl_add_u32 v76, v75, 12, v71
    v_bfe_u32 v75, v74, 1, 3
    v_xor_b32 v75, v75, v72
    v_lshl_add_u32 v76, v75, 4, v76
    v_and_b32 v75, 1, v74
    v_lshl_add_u32 v9, v75, 3, v76
    v_add_u32 v0, 61440, v9
    v_add_u32 v74, 4, v73
    v_lshrrev_b32 v75, 4, v74
    v_lshl_add_u32 v76, v75, 12, v71
    v_bfe_u32 v75, v74, 1, 3
    v_xor_b32 v75, v75, v72
    v_lshl_add_u32 v76, v75, 4, v76
    v_and_b32 v75, 1, v74
    v_lshl_add_u32 v10, v75, 3, v76
    v_add_u32 v5, 61440, v10
    s_lshl_b32 s64, s41, 4
    s_lshl_b32 s65, s51, 2
    s_add_u32 s64, s64, s65
    s_lshl_b32 s66, s40, 2
    s_add_u32 s66, s66, s50
    s_and_b32 s65, s40, 1
    s_lshl_b32 s65, s65, 1
    s_sub_u32 s66, s66, s65
    s_cmp_eq_u32 s33, 2
    s_cbranch_scc1 L_k1_c_v
    s_barrier
    ds_read_b64_tr_b16 v[48:49], v6 offset:0
    ds_read_b64_tr_b16 v[50:51], v6 offset:512
    ds_read_b128 v[16:19], v86 offset:0
    ds_read_b128 v[20:23], v86 offset:2048
    ds_read_b128 v[24:27], v86 offset:4096
    ds_read_b128 v[28:31], v86 offset:6144
    ds_read_b64_tr_b16 v[52:53], v7 offset:0
    ds_read_b64_tr_b16 v[54:55], v7 offset:512
    ds_read_b64_tr_b16 v[56:57], v8 offset:0
    ds_read_b64_tr_b16 v[58:59], v8 offset:512
    ds_read_b64_tr_b16 v[60:61], v9 offset:0
    ds_read_b64_tr_b16 v[62:63], v9 offset:512
    ds_read_b64_tr_b16 v[64:65], v10 offset:0
    ds_read_b64_tr_b16 v[66:67], v10 offset:512
    s_waitcnt lgkmcnt(8)
    v_mfma_f32_16x16x32_bf16 v[88:91], v[48:51], v[16:19], 0
    v_mfma_f32_16x16x32_bf16 v[108:111], v[48:51], v[20:23], 0
    v_mfma_f32_16x16x32_bf16 v[128:131], v[48:51], v[24:27], 0
    v_mfma_f32_16x16x32_bf16 v[148:151], v[48:51], v[28:31], 0
    s_waitcnt lgkmcnt(6)
    v_mfma_f32_16x16x32_bf16 v[152:155], v[52:55], v[28:31], 0
    v_mfma_f32_16x16x32_bf16 v[132:135], v[52:55], v[24:27], 0
    v_mfma_f32_16x16x32_bf16 v[112:115], v[52:55], v[20:23], 0
    v_mfma_f32_16x16x32_bf16 v[92:95], v[52:55], v[16:19], 0
    s_waitcnt lgkmcnt(4)
    v_mfma_f32_16x16x32_bf16 v[96:99], v[56:59], v[16:19], 0
    v_mfma_f32_16x16x32_bf16 v[116:119], v[56:59], v[20:23], 0
    v_mfma_f32_16x16x32_bf16 v[136:139], v[56:59], v[24:27], 0
    v_mfma_f32_16x16x32_bf16 v[156:159], v[56:59], v[28:31], 0
    s_waitcnt lgkmcnt(2)
    s_barrier
    v_mfma_f32_16x16x32_bf16 v[160:163], v[60:63], v[28:31], 0
    ds_read_b64_tr_b16 v[48:49], v6 offset:20480
    ds_read_b64_tr_b16 v[50:51], v6 offset:20992
    v_mfma_f32_16x16x32_bf16 v[140:143], v[60:63], v[24:27], 0
    ds_read_b128 v[32:35], v87 offset:0
    ds_read_b128 v[36:39], v87 offset:2048
    v_mfma_f32_16x16x32_bf16 v[120:123], v[60:63], v[20:23], 0
    ds_read_b128 v[40:43], v87 offset:4096
    ds_read_b128 v[44:47], v87 offset:6144
    v_mfma_f32_16x16x32_bf16 v[100:103], v[60:63], v[16:19], 0
    ds_read_b64_tr_b16 v[52:53], v7 offset:20480
    ds_read_b64_tr_b16 v[54:55], v7 offset:20992
    s_waitcnt lgkmcnt(8)
    v_mfma_f32_16x16x32_bf16 v[104:107], v[64:67], v[16:19], 0
    ds_read_b64_tr_b16 v[56:57], v8 offset:20480
    ds_read_b64_tr_b16 v[58:59], v8 offset:20992
    v_mfma_f32_16x16x32_bf16 v[124:127], v[64:67], v[20:23], 0
    ds_read_b64_tr_b16 v[60:61], v9 offset:20480
    ds_read_b64_tr_b16 v[62:63], v9 offset:20992
    v_mfma_f32_16x16x32_bf16 v[144:147], v[64:67], v[24:27], 0
    v_mfma_f32_16x16x32_bf16 v[164:167], v[64:67], v[28:31], 0
    ds_read_b64_tr_b16 v[64:65], v10 offset:20480
    ds_read_b64_tr_b16 v[66:67], v10 offset:20992
    s_waitcnt lgkmcnt(8)
    v_mfma_f32_16x16x32_bf16 v[88:91], v[48:51], v[32:35], v[88:91]
    v_mfma_f32_16x16x32_bf16 v[108:111], v[48:51], v[36:39], v[108:111]
    s_lshr_b32 s34, s2, 3
    v_mfma_f32_16x16x32_bf16 v[128:131], v[48:51], v[40:43], v[128:131]
    v_mfma_f32_16x16x32_bf16 v[148:151], v[48:51], v[44:47], v[148:151]
    s_and_b32 s58, s2, 7
    s_waitcnt lgkmcnt(6)
    v_mfma_f32_16x16x32_bf16 v[152:155], v[52:55], v[44:47], v[152:155]
    s_lshl_b32 s58, s58, 2
    v_mfma_f32_16x16x32_bf16 v[132:135], v[52:55], v[40:43], v[132:135]
    v_mfma_f32_16x16x32_bf16 v[112:115], v[52:55], v[36:39], v[112:115]
    s_bfe_u32 s59, s2, 0x20003
    v_mfma_f32_16x16x32_bf16 v[92:95], v[52:55], v[32:35], v[92:95]
    s_waitcnt lgkmcnt(4)
    v_mfma_f32_16x16x32_bf16 v[96:99], v[56:59], v[32:35], v[96:99]
    s_add_u32 s58, s58, s59
    v_mfma_f32_16x16x32_bf16 v[116:119], v[56:59], v[36:39], v[116:119]
    s_lshr_b32 s7, s2, 5
    v_mfma_f32_16x16x32_bf16 v[136:139], v[56:59], v[40:43], v[136:139]
    s_lshl_b32 s7, s7, 3
    v_mfma_f32_16x16x32_bf16 v[156:159], v[56:59], v[44:47], v[156:159]
    s_add_u32 s7, s7, s36
    s_waitcnt lgkmcnt(2)
    v_mfma_f32_16x16x32_bf16 v[160:163], v[60:63], v[44:47], v[160:163]
    s_mul_i32 s7, s7, 40
    v_mfma_f32_16x16x32_bf16 v[140:143], v[60:63], v[40:43], v[140:143]
    v_mfma_f32_16x16x32_bf16 v[120:123], v[60:63], v[36:39], v[120:123]
    s_add_u32 s6, s7, s58
    v_mfma_f32_16x16x32_bf16 v[100:103], v[60:63], v[32:35], v[100:103]
    s_waitcnt lgkmcnt(0)
    v_mfma_f32_16x16x32_bf16 v[104:107], v[64:67], v[32:35], v[104:107]
    v_mfma_f32_16x16x32_bf16 v[124:127], v[64:67], v[36:39], v[124:127]
    s_lshl_b32 s6, s6, 10
    v_mfma_f32_16x16x32_bf16 v[144:147], v[64:67], v[40:43], v[144:147]
    v_mfma_f32_16x16x32_bf16 v[164:167], v[64:67], v[44:47], v[164:167]
    s_add_u32 s6, s6, 14155776
    s_barrier
    ds_read_b64_tr_b16 v[48:49], v6 offset:40960
    ds_read_b64_tr_b16 v[50:51], v6 offset:41472
    ds_read_b128 v[16:19], v86 offset:16384
    ds_read_b128 v[20:23], v86 offset:18432
    ds_read_b128 v[24:27], v86 offset:20480
    ds_read_b128 v[28:31], v86 offset:22528
    ds_read_b64_tr_b16 v[52:53], v7 offset:40960
    ds_read_b64_tr_b16 v[54:55], v7 offset:41472
    ds_read_b64_tr_b16 v[56:57], v8 offset:40960
    ds_read_b64_tr_b16 v[58:59], v8 offset:41472
    ds_read_b64_tr_b16 v[60:61], v9 offset:40960
    ds_read_b64_tr_b16 v[62:63], v9 offset:41472
    ds_read_b64_tr_b16 v[64:65], v10 offset:40960
    ds_read_b64_tr_b16 v[66:67], v10 offset:41472
    s_waitcnt lgkmcnt(8)
    v_mfma_f32_16x16x32_bf16 v[88:91], v[48:51], v[16:19], v[88:91]
    v_mfma_f32_16x16x32_bf16 v[108:111], v[48:51], v[20:23], v[108:111]
    s_lshr_b32 s58, s58, 2
    v_mfma_f32_16x16x32_bf16 v[128:131], v[48:51], v[24:27], v[128:131]
    v_mfma_f32_16x16x32_bf16 v[148:151], v[48:51], v[28:31], v[148:151]
    s_add_u32 s7, s7, s58
    s_waitcnt lgkmcnt(6)
    v_mfma_f32_16x16x32_bf16 v[152:155], v[52:55], v[28:31], v[152:155]
    s_lshl_b32 s7, s7, 10
    v_mfma_f32_16x16x32_bf16 v[132:135], v[52:55], v[24:27], v[132:135]
    v_mfma_f32_16x16x32_bf16 v[112:115], v[52:55], v[20:23], v[112:115]
    s_add_u32 s7, s7, 14188544
    v_mfma_f32_16x16x32_bf16 v[92:95], v[52:55], v[16:19], v[92:95]
    s_waitcnt lgkmcnt(4)
    v_mfma_f32_16x16x32_bf16 v[96:99], v[56:59], v[16:19], v[96:99]
    s_and_b32 s58, s59, 1
    v_mfma_f32_16x16x32_bf16 v[116:119], v[56:59], v[20:23], v[116:119]
    s_lshl_b32 s58, s58, 9
    v_mfma_f32_16x16x32_bf16 v[136:139], v[56:59], v[24:27], v[136:139]
    s_add_u32 s7, s7, s58
    v_mfma_f32_16x16x32_bf16 v[156:159], v[56:59], v[28:31], v[156:159]
    s_and_b32 s58, s59, 2
    s_waitcnt lgkmcnt(2)
    s_barrier
    v_mfma_f32_16x16x32_bf16 v[160:163], v[60:63], v[28:31], v[160:163]
    ds_read_b64_tr_b16 v[48:49], v11 offset:0
    ds_read_b64_tr_b16 v[50:51], v11 offset:512
    s_lshl_b32 s58, s58, 7
    v_mfma_f32_16x16x32_bf16 v[140:143], v[60:63], v[24:27], v[140:143]
    ds_read_b128 v[32:35], v87 offset:16384
    ds_read_b128 v[36:39], v87 offset:18432
    v_mfma_f32_16x16x32_bf16 v[120:123], v[60:63], v[20:23], v[120:123]
    ds_read_b128 v[40:43], v87 offset:20480
    ds_read_b128 v[44:47], v87 offset:22528
    s_add_u32 s7, s7, s58
    v_mfma_f32_16x16x32_bf16 v[100:103], v[60:63], v[16:19], v[100:103]
    ds_read_b64_tr_b16 v[52:53], v12 offset:0
    ds_read_b64_tr_b16 v[54:55], v12 offset:512
    s_waitcnt lgkmcnt(8)
    v_mfma_f32_16x16x32_bf16 v[104:107], v[64:67], v[16:19], v[104:107]
    ds_read_b64_tr_b16 v[56:57], v13 offset:0
    ds_read_b64_tr_b16 v[58:59], v13 offset:512
    v_mfma_f32_16x16x32_bf16 v[124:127], v[64:67], v[20:23], v[124:127]
    ds_read_b64_tr_b16 v[60:61], v0 offset:0
    ds_read_b64_tr_b16 v[62:63], v0 offset:512
    s_and_b32 s13, s2, 7
    v_mfma_f32_16x16x32_bf16 v[144:147], v[64:67], v[24:27], v[144:147]
    v_mfma_f32_16x16x32_bf16 v[164:167], v[64:67], v[28:31], v[164:167]
    s_lshl_b32 s13, s13, 2
    ds_read_b64_tr_b16 v[64:65], v5 offset:0
    ds_read_b64_tr_b16 v[66:67], v5 offset:512
    s_waitcnt lgkmcnt(8)
    v_mfma_f32_16x16x32_bf16 v[88:91], v[48:51], v[32:35], v[88:91]
    v_mfma_f32_16x16x32_bf16 v[108:111], v[48:51], v[36:39], v[108:111]
    s_and_b32 s34, s34, 3
    v_mfma_f32_16x16x32_bf16 v[128:131], v[48:51], v[40:43], v[128:131]
    v_mfma_f32_16x16x32_bf16 v[148:151], v[48:51], v[44:47], v[148:151]
    s_add_u32 s13, s13, s34
    s_waitcnt lgkmcnt(6)
    v_mfma_f32_16x16x32_bf16 v[152:155], v[52:55], v[44:47], v[152:155]
    s_lshr_b32 s34, s2, 5
    v_mfma_f32_16x16x32_bf16 v[132:135], v[52:55], v[40:43], v[132:135]
    s_barrier
    v_mfma_f32_16x16x32_bf16 v[112:115], v[52:55], v[36:39], v[112:115]
    ds_read_b64_tr_b16 v[48:49], v11 offset:20480
    ds_read_b64_tr_b16 v[50:51], v11 offset:20992
    s_lshr_b32 s38, s36, 2
    v_mfma_f32_16x16x32_bf16 v[92:95], v[52:55], v[32:35], v[92:95]
    ds_read_b128 v[16:19], v86 offset:32768
    ds_read_b128 v[20:23], v86 offset:34816
    s_waitcnt lgkmcnt(8)
    v_mfma_f32_16x16x32_bf16 v[96:99], v[56:59], v[32:35], v[96:99]
    ds_read_b128 v[24:27], v86 offset:36864
    ds_read_b128 v[28:31], v86 offset:38912
    s_mov_b64 s[20:21], 0xffffffff
    v_mfma_f32_16x16x32_bf16 v[116:119], v[56:59], v[36:39], v[116:119]
    ds_read_b64_tr_b16 v[52:53], v12 offset:20480
    ds_read_b64_tr_b16 v[54:55], v12 offset:20992
    s_mov_b32 s22, 0x000fffff
    v_mfma_f32_16x16x32_bf16 v[136:139], v[56:59], v[40:43], v[136:139]
    s_mov_b32 s23, 0x000fffff
    v_mfma_f32_16x16x32_bf16 v[156:159], v[56:59], v[44:47], v[156:159]
    s_not_b64 s[24:25], s[20:21]
    s_waitcnt lgkmcnt(10)
    v_mfma_f32_16x16x32_bf16 v[160:163], v[60:63], v[44:47], v[160:163]
    ds_read_b64_tr_b16 v[56:57], v13 offset:20480
    ds_read_b64_tr_b16 v[58:59], v13 offset:20992
    s_mov_b32 s14, 0
    v_mfma_f32_16x16x32_bf16 v[140:143], v[60:63], v[40:43], v[140:143]
    v_mfma_f32_16x16x32_bf16 v[120:123], v[60:63], v[36:39], v[120:123]
    s_xor_b32 s15, s38, 1
    v_mfma_f32_16x16x32_bf16 v[100:103], v[60:63], v[32:35], v[100:103]
    s_waitcnt lgkmcnt(10)
    s_barrier
    v_mfma_f32_16x16x32_bf16 v[104:107], v[64:67], v[32:35], v[104:107]
    ds_read_b64_tr_b16 v[60:61], v0 offset:20480
    ds_read_b64_tr_b16 v[62:63], v0 offset:20992
    v_mfma_f32_16x16x32_bf16 v[124:127], v[64:67], v[36:39], v[124:127]
    s_mul_i32 s54, s37, 39936
    v_mfma_f32_16x16x32_bf16 v[144:147], v[64:67], v[40:43], v[144:147]
    v_mfma_f32_16x16x32_bf16 v[164:167], v[64:67], v[44:47], v[164:167]
    s_add_u32 s54, s54, 64
    ds_read_b64_tr_b16 v[64:65], v5 offset:20480
    ds_read_b64_tr_b16 v[66:67], v5 offset:20992
    s_waitcnt lgkmcnt(8)
    v_mfma_f32_16x16x32_bf16 v[88:91], v[48:51], v[16:19], v[88:91]
    ds_read_b128 v[32:35], v87 offset:32768
    v_mfma_f32_16x16x32_bf16 v[108:111], v[48:51], v[20:23], v[108:111]
    ds_read_b128 v[36:39], v87 offset:34816
    s_mul_i32 s39, s13, 163840
    v_mfma_f32_16x16x32_bf16 v[128:131], v[48:51], v[24:27], v[128:131]
    ds_read_b128 v[40:43], v87 offset:36864
    v_mfma_f32_16x16x32_bf16 v[148:151], v[48:51], v[28:31], v[148:151]
    ds_read_b128 v[44:47], v87 offset:38912
    s_add_u32 s39, s39, 2621440
    s_waitcnt lgkmcnt(10)
    v_mfma_f32_16x16x32_bf16 v[152:155], v[52:55], v[28:31], v[152:155]
    ds_read_b64_tr_b16 v[48:49], v6 offset:0
    s_sub_u32 s41, s39, s54
    v_mfma_f32_16x16x32_bf16 v[132:135], v[52:55], v[24:27], v[132:135]
    ds_read_b64_tr_b16 v[50:51], v6 offset:512
    v_mfma_f32_16x16x32_bf16 v[112:115], v[52:55], v[20:23], v[112:115]
    s_add_u32 s56, s28, s41
    v_mfma_f32_16x16x32_bf16 v[92:95], v[52:55], v[16:19], v[92:95]
    s_waitcnt lgkmcnt(10)
    v_mfma_f32_16x16x32_bf16 v[96:99], v[56:59], v[16:19], v[96:99]
    ds_read_b64_tr_b16 v[52:53], v7 offset:0
    s_addc_u32 s57, s29, 0
    v_mfma_f32_16x16x32_bf16 v[116:119], v[56:59], v[20:23], v[116:119]
    ds_read_b64_tr_b16 v[54:55], v7 offset:512
    s_add_u32 s58, s54, 163840
    v_mfma_f32_16x16x32_bf16 v[136:139], v[56:59], v[24:27], v[136:139]
    s_mov_b32 s59, 0x00020000
    v_mfma_f32_16x16x32_bf16 v[156:159], v[56:59], v[28:31], v[156:159]
    s_mul_i32 s52, s37, 40960
    s_waitcnt lgkmcnt(10)
    v_mfma_f32_16x16x32_bf16 v[160:163], v[60:63], v[28:31], v[160:163]
    ds_read_b64_tr_b16 v[56:57], v8 offset:0
    s_add_u32 s53, s52, 40960
    v_mfma_f32_16x16x32_bf16 v[140:143], v[60:63], v[24:27], v[140:143]
    ds_read_b64_tr_b16 v[58:59], v8 offset:512
    v_mfma_f32_16x16x32_bf16 v[120:123], v[60:63], v[20:23], v[120:123]
    s_and_b32 s40, s34, 5
    v_mfma_f32_16x16x32_bf16 v[100:103], v[60:63], v[16:19], v[100:103]
    s_waitcnt lgkmcnt(10)
    s_barrier
    v_mfma_f32_16x16x32_bf16 v[104:107], v[64:67], v[16:19], v[104:107]
    ds_read_b64_tr_b16 v[60:61], v9 offset:0
    v_mfma_f32_16x16x32_bf16 v[124:127], v[64:67], v[20:23], v[124:127]
    ds_read_b64_tr_b16 v[62:63], v9 offset:512
    s_mul_i32 s40, s40, 5120
    v_mfma_f32_16x16x32_bf16 v[144:147], v[64:67], v[24:27], v[144:147]
    v_mfma_f32_16x16x32_bf16 v[164:167], v[64:67], v[28:31], v[164:167]
    s_add_u32 s41, s40, s52
    ds_read_b64_tr_b16 v[64:65], v10 offset:0
    ds_read_b64_tr_b16 v[66:67], v10 offset:512
    s_waitcnt lgkmcnt(8)
    v_mfma_f32_16x16x32_bf16 v[88:91], v[48:51], v[32:35], v[88:91]
    ds_read_b128 v[16:19], v86 offset:0
    v_mfma_f32_16x16x32_bf16 v[108:111], v[48:51], v[36:39], v[108:111]
    ds_read_b128 v[20:23], v86 offset:2048
    s_add_u32 s42, s41, 5120
    v_mfma_f32_16x16x32_bf16 v[128:131], v[48:51], v[40:43], v[128:131]
    ds_read_b128 v[24:27], v86 offset:4096
    v_mfma_f32_16x16x32_bf16 v[148:151], v[48:51], v[44:47], v[148:151]
    ds_read_b128 v[28:31], v86 offset:6144
    s_cmp_eq_u32 s42, s53
    s_waitcnt lgkmcnt(10)
    v_mfma_f32_16x16x32_bf16 v[152:155], v[52:55], v[44:47], v[152:155]
    ds_read_b64_tr_b16 v[48:49], v6 offset:20480
    s_cselect_b32 s42, s52, s42
    v_mfma_f32_16x16x32_bf16 v[132:135], v[52:55], v[40:43], v[132:135]
    ds_read_b64_tr_b16 v[50:51], v6 offset:20992
    v_mfma_f32_16x16x32_bf16 v[112:115], v[52:55], v[36:39], v[112:115]
    s_add_u32 s52, s41, s39
    v_mfma_f32_16x16x32_bf16 v[92:95], v[52:55], v[32:35], v[92:95]
    s_waitcnt lgkmcnt(10)
    v_mfma_f32_16x16x32_bf16 v[96:99], v[56:59], v[32:35], v[96:99]
    ds_read_b64_tr_b16 v[52:53], v7 offset:20480
    s_add_u32 s53, s52, 4096
    v_mfma_f32_16x16x32_bf16 v[116:119], v[56:59], v[36:39], v[116:119]
    ds_read_b64_tr_b16 v[54:55], v7 offset:20992
    s_mul_i32 s44, s13, 81920
    v_mfma_f32_16x16x32_bf16 v[136:139], v[56:59], v[40:43], v[136:139]
    s_lshl_b32 s43, s34, 1
    v_mfma_f32_16x16x32_bf16 v[156:159], v[56:59], v[44:47], v[156:159]
    s_add_u32 s43, s43, s38
    s_waitcnt lgkmcnt(10)
    v_mfma_f32_16x16x32_bf16 v[160:163], v[60:63], v[44:47], v[160:163]
    ds_read_b64_tr_b16 v[56:57], v8 offset:20480
    s_mul_i32 s43, s43, 5120
    v_mfma_f32_16x16x32_bf16 v[140:143], v[60:63], v[40:43], v[140:143]
    ds_read_b64_tr_b16 v[58:59], v8 offset:20992
    v_mfma_f32_16x16x32_bf16 v[120:123], v[60:63], v[36:39], v[120:123]
    s_add_u32 s44, s44, s43
    v_mfma_f32_16x16x32_bf16 v[100:103], v[60:63], v[32:35], v[100:103]
    s_waitcnt lgkmcnt(10)
    s_barrier
    v_mfma_f32_16x16x32_bf16 v[104:107], v[64:67], v[32:35], v[104:107]
    ds_read_b64_tr_b16 v[60:61], v9 offset:20480
    v_mfma_f32_16x16x32_bf16 v[124:127], v[64:67], v[36:39], v[124:127]
    ds_read_b64_tr_b16 v[62:63], v9 offset:20992
    s_lshl_b32 s49, s36, 7
    v_mfma_f32_16x16x32_bf16 v[144:147], v[64:67], v[40:43], v[144:147]
    v_mfma_f32_16x16x32_bf16 v[164:167], v[64:67], v[44:47], v[164:167]
    s_add_u32 s49, s49, 159808
    ds_read_b64_tr_b16 v[64:65], v10 offset:20480
    ds_read_b64_tr_b16 v[66:67], v10 offset:20992
    s_waitcnt lgkmcnt(8)
    v_mfma_f32_16x16x32_bf16 v[88:91], v[48:51], v[16:19], v[88:91]
    ds_read_b128 v[32:35], v87 offset:0
    v_mfma_f32_16x16x32_bf16 v[108:111], v[48:51], v[20:23], v[108:111]
    ds_read_b128 v[36:39], v87 offset:2048
    s_cmp_eq_u32 s38, 0
    v_mfma_f32_16x16x32_bf16 v[128:131], v[48:51], v[24:27], v[128:131]
    ds_read_b128 v[40:43], v87 offset:4096
    v_mfma_f32_16x16x32_bf16 v[148:151], v[48:51], v[28:31], v[148:151]
    ds_read_b128 v[44:47], v87 offset:6144
    s_mov_b32 s35, 161028
    s_waitcnt lgkmcnt(10)
    v_mfma_f32_16x16x32_bf16 v[152:155], v[52:55], v[28:31], v[152:155]
    ds_read_b64_tr_b16 v[48:49], v6 offset:40960
    s_cselect_b32 s35, 4, s35
    v_mfma_f32_16x16x32_bf16 v[132:135], v[52:55], v[24:27], v[132:135]
    s_branch L_sk_2076
L_pad_mqk_0:
    s_branch L_k1_c_qkv
L_sk_2076:
    ds_read_b64_tr_b16 v[50:51], v6 offset:41472
    v_mfma_f32_16x16x32_bf16 v[112:115], v[52:55], v[20:23], v[112:115]
    s_cselect_b32 s26, 12, 4
    v_mfma_f32_16x16x32_bf16 v[92:95], v[52:55], v[16:19], v[92:95]
    s_waitcnt lgkmcnt(10)
    v_mfma_f32_16x16x32_bf16 v[96:99], v[56:59], v[16:19], v[96:99]
    ds_read_b64_tr_b16 v[52:53], v7 offset:40960
    s_mul_i32 s27, s38, 20480
    v_mfma_f32_16x16x32_bf16 v[116:119], v[56:59], v[20:23], v[116:119]
    ds_read_b64_tr_b16 v[54:55], v7 offset:41472
    s_add_u32 s27, s27, 64
    v_mfma_f32_16x16x32_bf16 v[136:139], v[56:59], v[24:27], v[136:139]
    s_lshl_b32 s55, s38, 2
    v_mfma_f32_16x16x32_bf16 v[156:159], v[56:59], v[28:31], v[156:159]
    s_add_u32 s55, s55, 161028
    s_waitcnt lgkmcnt(10)
    v_mfma_f32_16x16x32_bf16 v[160:163], v[60:63], v[28:31], v[160:163]
    ds_read_b64_tr_b16 v[56:57], v8 offset:40960
    s_lshl_b32 s11, s34, 2
    v_mfma_f32_16x16x32_bf16 v[140:143], v[60:63], v[24:27], v[140:143]
    ds_read_b64_tr_b16 v[58:59], v8 offset:41472
    v_mfma_f32_16x16x32_bf16 v[120:123], v[60:63], v[20:23], v[120:123]
    s_add_u32 s11, s11, s37
    v_mfma_f32_16x16x32_bf16 v[100:103], v[60:63], v[16:19], v[100:103]
    s_waitcnt lgkmcnt(10)
    s_barrier
    v_mfma_f32_16x16x32_bf16 v[104:107], v[64:67], v[16:19], v[104:107]
    ds_read_b64_tr_b16 v[60:61], v9 offset:40960
    v_mfma_f32_16x16x32_bf16 v[124:127], v[64:67], v[20:23], v[124:127]
    ds_read_b64_tr_b16 v[62:63], v9 offset:41472
    s_lshl_b32 s11, s11, 2
    v_mfma_f32_16x16x32_bf16 v[144:147], v[64:67], v[24:27], v[144:147]
    v_mfma_f32_16x16x32_bf16 v[164:167], v[64:67], v[28:31], v[164:167]
    s_lshr_b32 s12, s13, 3
    ds_read_b64_tr_b16 v[64:65], v10 offset:40960
    ds_read_b64_tr_b16 v[66:67], v10 offset:41472
    s_waitcnt lgkmcnt(8)
    v_mfma_f32_16x16x32_bf16 v[88:91], v[48:51], v[32:35], v[88:91]
    ds_read_b128 v[16:19], v86 offset:16384
    v_mfma_f32_16x16x32_bf16 v[108:111], v[48:51], v[36:39], v[108:111]
    ds_read_b128 v[20:23], v86 offset:18432
    s_add_u32 s11, s11, s12
    v_mfma_f32_16x16x32_bf16 v[128:131], v[48:51], v[40:43], v[128:131]
    ds_read_b128 v[24:27], v86 offset:20480
    v_mfma_f32_16x16x32_bf16 v[148:151], v[48:51], v[44:47], v[148:151]
    ds_read_b128 v[28:31], v86 offset:22528
    s_lshl_b32 s11, s11, 9
    s_waitcnt lgkmcnt(10)
    v_mfma_f32_16x16x32_bf16 v[152:155], v[52:55], v[44:47], v[152:155]
    ds_read_b64_tr_b16 v[48:49], v11 offset:0
    s_lshl_b32 s12, s38, 16
    v_mfma_f32_16x16x32_bf16 v[132:135], v[52:55], v[40:43], v[132:135]
    ds_read_b64_tr_b16 v[50:51], v11 offset:512
    v_mfma_f32_16x16x32_bf16 v[112:115], v[52:55], v[36:39], v[112:115]
    s_sub_u32 s11, s11, s12
    v_mfma_f32_16x16x32_bf16 v[92:95], v[52:55], v[32:35], v[92:95]
    s_waitcnt lgkmcnt(10)
    v_mfma_f32_16x16x32_bf16 v[96:99], v[56:59], v[32:35], v[96:99]
    ds_read_b64_tr_b16 v[52:53], v12 offset:0
    s_add_u32 s11, s11, 17891328
    v_mfma_f32_16x16x32_bf16 v[116:119], v[56:59], v[36:39], v[116:119]
    ds_read_b64_tr_b16 v[54:55], v12 offset:512
    s_and_b32 s12, s13, 6
    v_mfma_f32_16x16x32_bf16 v[136:139], v[56:59], v[40:43], v[136:139]
    s_lshl_b32 s12, 1, s12
    v_mfma_f32_16x16x32_bf16 v[156:159], v[56:59], v[44:47], v[156:159]
    s_add_u32 s12, s12, 256
    s_waitcnt lgkmcnt(10)
    v_mfma_f32_16x16x32_bf16 v[160:163], v[60:63], v[44:47], v[160:163]
    ds_read_b64_tr_b16 v[56:57], v13 offset:0
    s_xor_b32 s43, s37, 1
    v_mfma_f32_16x16x32_bf16 v[140:143], v[60:63], v[40:43], v[140:143]
    ds_read_b64_tr_b16 v[58:59], v13 offset:512
    v_mfma_f32_16x16x32_bf16 v[120:123], v[60:63], v[36:39], v[120:123]
    s_mul_i32 s39, s43, 1280
    v_mfma_f32_16x16x32_bf16 v[100:103], v[60:63], v[32:35], v[100:103]
    s_waitcnt lgkmcnt(10)
    s_barrier
    v_mfma_f32_16x16x32_bf16 v[104:107], v[64:67], v[32:35], v[104:107]
    ds_read_b64_tr_b16 v[60:61], v0 offset:0
    v_mfma_f32_16x16x32_bf16 v[124:127], v[64:67], v[36:39], v[124:127]
    ds_read_b64_tr_b16 v[62:63], v0 offset:512
    s_add_u32 s45, s39, s44
    v_mfma_f32_16x16x32_bf16 v[144:147], v[64:67], v[40:43], v[144:147]
    v_mfma_f32_16x16x32_bf16 v[164:167], v[64:67], v[44:47], v[164:167]
    s_mul_i32 s16, s43, 39936
    ds_read_b64_tr_b16 v[64:65], v5 offset:0
    ds_read_b64_tr_b16 v[66:67], v5 offset:512
    s_waitcnt lgkmcnt(8)
    v_mfma_f32_16x16x32_bf16 v[88:91], v[48:51], v[16:19], v[88:91]
    ds_read_b128 v[32:35], v87 offset:16384
    v_mfma_f32_16x16x32_bf16 v[108:111], v[48:51], v[20:23], v[108:111]
    ds_read_b128 v[36:39], v87 offset:18432
    s_xor_b32 s43, s37, 2
    v_mfma_f32_16x16x32_bf16 v[128:131], v[48:51], v[24:27], v[128:131]
    ds_read_b128 v[40:43], v87 offset:20480
    v_mfma_f32_16x16x32_bf16 v[148:151], v[48:51], v[28:31], v[148:151]
    ds_read_b128 v[44:47], v87 offset:22528
    s_mul_i32 s39, s43, 1280
    s_waitcnt lgkmcnt(10)
    v_mfma_f32_16x16x32_bf16 v[152:155], v[52:55], v[28:31], v[152:155]
    ds_read_b64_tr_b16 v[48:49], v11 offset:20480
    s_add_u32 s46, s39, s44
    v_mfma_f32_16x16x32_bf16 v[132:135], v[52:55], v[24:27], v[132:135]
    ds_read_b64_tr_b16 v[50:51], v11 offset:20992
    v_mfma_f32_16x16x32_bf16 v[112:115], v[52:55], v[20:23], v[112:115]
    s_mul_i32 s17, s43, 39936
    v_mfma_f32_16x16x32_bf16 v[92:95], v[52:55], v[16:19], v[92:95]
    s_waitcnt lgkmcnt(10)
    v_mfma_f32_16x16x32_bf16 v[96:99], v[56:59], v[16:19], v[96:99]
    ds_read_b64_tr_b16 v[52:53], v12 offset:20480
    s_xor_b32 s43, s37, 3
    v_mfma_f32_16x16x32_bf16 v[116:119], v[56:59], v[20:23], v[116:119]
    ds_read_b64_tr_b16 v[54:55], v12 offset:20992
    s_mul_i32 s39, s43, 1280
    v_mfma_f32_16x16x32_bf16 v[136:139], v[56:59], v[24:27], v[136:139]
    s_add_u32 s47, s39, s44
    v_mfma_f32_16x16x32_bf16 v[156:159], v[56:59], v[28:31], v[156:159]
    s_mul_i32 s18, s43, 39936
    s_waitcnt lgkmcnt(10)
    v_mfma_f32_16x16x32_bf16 v[160:163], v[60:63], v[28:31], v[160:163]
    ds_read_b64_tr_b16 v[56:57], v13 offset:20480
    s_xor_b32 s43, s37, 0
    v_mfma_f32_16x16x32_bf16 v[140:143], v[60:63], v[24:27], v[140:143]
    ds_read_b64_tr_b16 v[58:59], v13 offset:20992
    v_mfma_f32_16x16x32_bf16 v[120:123], v[60:63], v[20:23], v[120:123]
    s_mul_i32 s39, s43, 1280
    v_mfma_f32_16x16x32_bf16 v[100:103], v[60:63], v[16:19], v[100:103]
    s_waitcnt lgkmcnt(10)
    s_barrier
    v_mfma_f32_16x16x32_bf16 v[104:107], v[64:67], v[16:19], v[104:107]
    ds_read_b64_tr_b16 v[60:61], v0 offset:20480
    v_mfma_f32_16x16x32_bf16 v[124:127], v[64:67], v[20:23], v[124:127]
    ds_read_b64_tr_b16 v[62:63], v0 offset:20992
    s_add_u32 s48, s39, s44
    v_mfma_f32_16x16x32_bf16 v[144:147], v[64:67], v[24:27], v[144:147]
    v_mfma_f32_16x16x32_bf16 v[164:167], v[64:67], v[28:31], v[164:167]
    s_mul_i32 s19, s43, 39936
    ds_read_b64_tr_b16 v[64:65], v5 offset:20480
    ds_read_b64_tr_b16 v[66:67], v5 offset:20992
    s_waitcnt lgkmcnt(8)
    v_mfma_f32_16x16x32_bf16 v[88:91], v[48:51], v[32:35], v[88:91]
    ds_read_b128 v[16:19], v86 offset:32768
    v_mfma_f32_16x16x32_bf16 v[108:111], v[48:51], v[36:39], v[108:111]
    ds_read_b128 v[20:23], v86 offset:34816
    s_waitcnt vmcnt(0)
    v_mfma_f32_16x16x32_bf16 v[128:131], v[48:51], v[40:43], v[128:131]
    ds_read_b128 v[24:27], v86 offset:36864
    v_mfma_f32_16x16x32_bf16 v[148:151], v[48:51], v[44:47], v[148:151]
    ds_read_b128 v[28:31], v86 offset:38912
    v_lshlrev_b32 v2, 4, v1
    s_waitcnt lgkmcnt(10)
    v_mfma_f32_16x16x32_bf16 v[152:155], v[52:55], v[44:47], v[152:155]
    ds_read_b64_tr_b16 v[48:49], v6 offset:0
    v_and_b32 v70, 31, v1
    v_mfma_f32_16x16x32_bf16 v[132:135], v[52:55], v[40:43], v[132:135]
    ds_read_b64_tr_b16 v[50:51], v6 offset:512
    v_mfma_f32_16x16x32_bf16 v[112:115], v[52:55], v[36:39], v[112:115]
    v_lshrrev_b32 v71, 5, v1
    v_mfma_f32_16x16x32_bf16 v[92:95], v[52:55], v[32:35], v[92:95]
    s_waitcnt lgkmcnt(10)
    v_mfma_f32_16x16x32_bf16 v[96:99], v[56:59], v[32:35], v[96:99]
    ds_read_b64_tr_b16 v[52:53], v7 offset:0
    v_lshrrev_b32 v4, 2, v70
    v_mfma_f32_16x16x32_bf16 v[116:119], v[56:59], v[36:39], v[116:119]
    ds_read_b64_tr_b16 v[54:55], v7 offset:512
    v_lshl_add_u32 v4, v4, 8, s54
    v_mfma_f32_16x16x32_bf16 v[136:139], v[56:59], v[40:43], v[136:139]
    v_lshl_add_u32 v4, v71, 6, v4
    v_mfma_f32_16x16x32_bf16 v[156:159], v[56:59], v[44:47], v[156:159]
    v_and_b32 v72, 3, v70
    s_waitcnt lgkmcnt(10)
    v_mfma_f32_16x16x32_bf16 v[160:163], v[60:63], v[44:47], v[160:163]
    ds_read_b64_tr_b16 v[56:57], v8 offset:0
    v_lshl_add_u32 v4, v72, 4, v4
    v_mfma_f32_16x16x32_bf16 v[140:143], v[60:63], v[40:43], v[140:143]
    ds_read_b64_tr_b16 v[58:59], v8 offset:512
    v_mfma_f32_16x16x32_bf16 v[120:123], v[60:63], v[36:39], v[120:123]
    v_lshrrev_b32 v73, 3, v70
    v_mfma_f32_16x16x32_bf16 v[100:103], v[60:63], v[32:35], v[100:103]
    s_waitcnt lgkmcnt(10)
    s_barrier
    v_mfma_f32_16x16x32_bf16 v[104:107], v[64:67], v[32:35], v[104:107]
    ds_read_b64_tr_b16 v[60:61], v9 offset:0
    v_mfma_f32_16x16x32_bf16 v[124:127], v[64:67], v[36:39], v[124:127]
    ds_read_b64_tr_b16 v[62:63], v9 offset:512
    v_lshl_add_u32 v72, v73, 2, v72
    v_mfma_f32_16x16x32_bf16 v[144:147], v[64:67], v[40:43], v[144:147]
    v_mfma_f32_16x16x32_bf16 v[164:167], v[64:67], v[44:47], v[164:167]
    v_lshl_add_u32 v72, v72, 4, s54
    ds_read_b64_tr_b16 v[64:65], v10 offset:0
    ds_read_b64_tr_b16 v[66:67], v10 offset:512
    s_waitcnt lgkmcnt(8)
    v_mfma_f32_16x16x32_bf16 v[88:91], v[48:51], v[16:19], v[88:91]
    ds_read_b128 v[32:35], v87 offset:32768
    v_mfma_f32_16x16x32_bf16 v[108:111], v[48:51], v[20:23], v[108:111]
    ds_read_b128 v[36:39], v87 offset:34816
    v_lshrrev_b32 v73, 4, v70
    v_mfma_f32_16x16x32_bf16 v[128:131], v[48:51], v[24:27], v[128:131]
    ds_read_b128 v[40:43], v87 offset:36864
    v_mfma_f32_16x16x32_bf16 v[148:151], v[48:51], v[28:31], v[148:151]
    ds_read_b128 v[44:47], v87 offset:38912
    v_bfe_u32 v74, v70, 2, 1
    s_waitcnt lgkmcnt(10)
    v_mfma_f32_16x16x32_bf16 v[152:155], v[52:55], v[28:31], v[152:155]
    ds_read_b64_tr_b16 v[48:49], v6 offset:20480
    v_lshl_add_u32 v3, v74, 3, v72
    v_mfma_f32_16x16x32_bf16 v[132:135], v[52:55], v[24:27], v[132:135]
    ds_read_b64_tr_b16 v[50:51], v6 offset:20992
    v_mfma_f32_16x16x32_bf16 v[112:115], v[52:55], v[20:23], v[112:115]
    v_lshl_add_u32 v14, v74, 8, v72
    v_mfma_f32_16x16x32_bf16 v[92:95], v[52:55], v[16:19], v[92:95]
    s_waitcnt lgkmcnt(10)
    v_mfma_f32_16x16x32_bf16 v[96:99], v[56:59], v[16:19], v[96:99]
    ds_read_b64_tr_b16 v[52:53], v7 offset:20480
    v_lshl_add_u32 v14, v71, 9, v14
    v_mfma_f32_16x16x32_bf16 v[116:119], v[56:59], v[20:23], v[116:119]
    ds_read_b64_tr_b16 v[54:55], v7 offset:20992
    v_and_b32 v15, 15, v70
    v_mfma_f32_16x16x32_bf16 v[136:139], v[56:59], v[24:27], v[136:139]
    v_lshlrev_b32 v15, 4, v15
    v_mfma_f32_16x16x32_bf16 v[156:159], v[56:59], v[28:31], v[156:159]
    v_lshl_add_u32 v15, v73, 3, v15
    s_waitcnt lgkmcnt(10)
    v_mfma_f32_16x16x32_bf16 v[160:163], v[60:63], v[28:31], v[160:163]
    ds_read_b64_tr_b16 v[56:57], v8 offset:20480
    v_mfma_f32_16x16x32_bf16 v[140:143], v[60:63], v[24:27], v[140:143]
    ds_read_b64_tr_b16 v[58:59], v8 offset:20992
    v_mfma_f32_16x16x32_bf16 v[120:123], v[60:63], v[20:23], v[120:123]
    v_mfma_f32_16x16x32_bf16 v[100:103], v[60:63], v[16:19], v[100:103]
    s_waitcnt lgkmcnt(10)
    s_barrier
    v_mfma_f32_16x16x32_bf16 v[104:107], v[64:67], v[16:19], v[104:107]
    ds_read_b64_tr_b16 v[60:61], v9 offset:20480
    v_mfma_f32_16x16x32_bf16 v[124:127], v[64:67], v[20:23], v[124:127]
    ds_read_b64_tr_b16 v[62:63], v9 offset:20992
    v_mfma_f32_16x16x32_bf16 v[144:147], v[64:67], v[24:27], v[144:147]
    v_mfma_f32_16x16x32_bf16 v[164:167], v[64:67], v[28:31], v[164:167]
    ds_read_b64_tr_b16 v[64:65], v10 offset:20480
    ds_read_b64_tr_b16 v[66:67], v10 offset:20992
    s_waitcnt lgkmcnt(8)
    v_mfma_f32_16x16x32_bf16 v[88:91], v[48:51], v[32:35], v[88:91]
    ds_read_b128 v[16:19], v86 offset:0
    v_mfma_f32_16x16x32_bf16 v[108:111], v[48:51], v[36:39], v[108:111]
    ds_read_b128 v[20:23], v86 offset:2048
    v_mfma_f32_16x16x32_bf16 v[128:131], v[48:51], v[40:43], v[128:131]
    ds_read_b128 v[24:27], v86 offset:4096
    v_mfma_f32_16x16x32_bf16 v[148:151], v[48:51], v[44:47], v[148:151]
    ds_read_b128 v[28:31], v86 offset:6144
    s_waitcnt lgkmcnt(10)
    v_mfma_f32_16x16x32_bf16 v[152:155], v[52:55], v[44:47], v[152:155]
    ds_read_b64_tr_b16 v[48:49], v6 offset:40960
    v_mfma_f32_16x16x32_bf16 v[132:135], v[52:55], v[40:43], v[132:135]
    ds_read_b64_tr_b16 v[50:51], v6 offset:41472
    v_mfma_f32_16x16x32_bf16 v[112:115], v[52:55], v[36:39], v[112:115]
    v_mfma_f32_16x16x32_bf16 v[92:95], v[52:55], v[32:35], v[92:95]
    s_waitcnt lgkmcnt(10)
    v_mfma_f32_16x16x32_bf16 v[96:99], v[56:59], v[32:35], v[96:99]
    ds_read_b64_tr_b16 v[52:53], v7 offset:40960
    v_mfma_f32_16x16x32_bf16 v[116:119], v[56:59], v[36:39], v[116:119]
    ds_read_b64_tr_b16 v[54:55], v7 offset:41472
    v_mfma_f32_16x16x32_bf16 v[136:139], v[56:59], v[40:43], v[136:139]
    v_mfma_f32_16x16x32_bf16 v[156:159], v[56:59], v[44:47], v[156:159]
    s_waitcnt lgkmcnt(10)
    v_mfma_f32_16x16x32_bf16 v[160:163], v[60:63], v[44:47], v[160:163]
    ds_read_b64_tr_b16 v[56:57], v8 offset:40960
    v_mfma_f32_16x16x32_bf16 v[140:143], v[60:63], v[40:43], v[140:143]
    ds_read_b64_tr_b16 v[58:59], v8 offset:41472
    v_mfma_f32_16x16x32_bf16 v[120:123], v[60:63], v[36:39], v[120:123]
    v_mfma_f32_16x16x32_bf16 v[100:103], v[60:63], v[32:35], v[100:103]
    s_waitcnt lgkmcnt(10)
    s_barrier
    v_mfma_f32_16x16x32_bf16 v[104:107], v[64:67], v[32:35], v[104:107]
    ds_read_b64_tr_b16 v[60:61], v9 offset:40960
    v_mfma_f32_16x16x32_bf16 v[124:127], v[64:67], v[36:39], v[124:127]
    ds_read_b64_tr_b16 v[62:63], v9 offset:41472
    v_mfma_f32_16x16x32_bf16 v[144:147], v[64:67], v[40:43], v[144:147]
    v_mfma_f32_16x16x32_bf16 v[164:167], v[64:67], v[44:47], v[164:167]
    ds_read_b64_tr_b16 v[64:65], v10 offset:40960
    ds_read_b64_tr_b16 v[66:67], v10 offset:41472
    s_waitcnt lgkmcnt(8)
    v_mfma_f32_16x16x32_bf16 v[88:91], v[48:51], v[16:19], v[88:91]
    ds_read_b128 v[32:35], v87 offset:0
    v_mfma_f32_16x16x32_bf16 v[108:111], v[48:51], v[20:23], v[108:111]
    ds_read_b128 v[36:39], v87 offset:2048
    v_mfma_f32_16x16x32_bf16 v[128:131], v[48:51], v[24:27], v[128:131]
    ds_read_b128 v[40:43], v87 offset:4096
    v_mfma_f32_16x16x32_bf16 v[148:151], v[48:51], v[28:31], v[148:151]
    ds_read_b128 v[44:47], v87 offset:6144
    s_waitcnt lgkmcnt(10)
    v_mfma_f32_16x16x32_bf16 v[152:155], v[52:55], v[28:31], v[152:155]
    ds_read_b64_tr_b16 v[48:49], v11 offset:0
    v_mfma_f32_16x16x32_bf16 v[132:135], v[52:55], v[24:27], v[132:135]
    ds_read_b64_tr_b16 v[50:51], v11 offset:512
    v_mfma_f32_16x16x32_bf16 v[112:115], v[52:55], v[20:23], v[112:115]
    v_mfma_f32_16x16x32_bf16 v[92:95], v[52:55], v[16:19], v[92:95]
    s_waitcnt lgkmcnt(10)
    v_mfma_f32_16x16x32_bf16 v[96:99], v[56:59], v[16:19], v[96:99]
    ds_read_b64_tr_b16 v[52:53], v12 offset:0
    v_mfma_f32_16x16x32_bf16 v[116:119], v[56:59], v[20:23], v[116:119]
    ds_read_b64_tr_b16 v[54:55], v12 offset:512
    v_mfma_f32_16x16x32_bf16 v[136:139], v[56:59], v[24:27], v[136:139]
    v_mfma_f32_16x16x32_bf16 v[156:159], v[56:59], v[28:31], v[156:159]
    s_waitcnt lgkmcnt(10)
    v_mfma_f32_16x16x32_bf16 v[160:163], v[60:63], v[28:31], v[160:163]
    ds_read_b64_tr_b16 v[56:57], v13 offset:0
    v_mfma_f32_16x16x32_bf16 v[140:143], v[60:63], v[24:27], v[140:143]
    ds_read_b64_tr_b16 v[58:59], v13 offset:512
    v_mfma_f32_16x16x32_bf16 v[120:123], v[60:63], v[20:23], v[120:123]
    v_mfma_f32_16x16x32_bf16 v[100:103], v[60:63], v[16:19], v[100:103]
    s_waitcnt lgkmcnt(10)
    s_barrier
    v_mfma_f32_16x16x32_bf16 v[104:107], v[64:67], v[16:19], v[104:107]
    ds_read_b64_tr_b16 v[60:61], v0 offset:0
    v_mfma_f32_16x16x32_bf16 v[124:127], v[64:67], v[20:23], v[124:127]
    ds_read_b64_tr_b16 v[62:63], v0 offset:512
    v_mfma_f32_16x16x32_bf16 v[144:147], v[64:67], v[24:27], v[144:147]
    v_mfma_f32_16x16x32_bf16 v[164:167], v[64:67], v[28:31], v[164:167]
    ds_read_b64_tr_b16 v[64:65], v5 offset:0
    ds_read_b64_tr_b16 v[66:67], v5 offset:512
    s_waitcnt lgkmcnt(8)
    v_mfma_f32_16x16x32_bf16 v[88:91], v[48:51], v[32:35], v[88:91]
    ds_read_b128 v[16:19], v86 offset:16384
    v_mfma_f32_16x16x32_bf16 v[108:111], v[48:51], v[36:39], v[108:111]
    ds_read_b128 v[20:23], v86 offset:18432
    v_mfma_f32_16x16x32_bf16 v[128:131], v[48:51], v[40:43], v[128:131]
    ds_read_b128 v[24:27], v86 offset:20480
    v_mfma_f32_16x16x32_bf16 v[148:151], v[48:51], v[44:47], v[148:151]
    ds_read_b128 v[28:31], v86 offset:22528
    s_waitcnt lgkmcnt(10)
    v_mfma_f32_16x16x32_bf16 v[152:155], v[52:55], v[44:47], v[152:155]
    ds_read_b64_tr_b16 v[48:49], v11 offset:20480
    v_mfma_f32_16x16x32_bf16 v[132:135], v[52:55], v[40:43], v[132:135]
    ds_read_b64_tr_b16 v[50:51], v11 offset:20992
    v_mfma_f32_16x16x32_bf16 v[112:115], v[52:55], v[36:39], v[112:115]
    v_mfma_f32_16x16x32_bf16 v[92:95], v[52:55], v[32:35], v[92:95]
    s_waitcnt lgkmcnt(10)
    v_mfma_f32_16x16x32_bf16 v[96:99], v[56:59], v[32:35], v[96:99]
    ds_read_b64_tr_b16 v[52:53], v12 offset:20480
    v_mfma_f32_16x16x32_bf16 v[116:119], v[56:59], v[36:39], v[116:119]
    ds_read_b64_tr_b16 v[54:55], v12 offset:20992
    v_mfma_f32_16x16x32_bf16 v[136:139], v[56:59], v[40:43], v[136:139]
    v_mfma_f32_16x16x32_bf16 v[156:159], v[56:59], v[44:47], v[156:159]
    s_waitcnt lgkmcnt(10)
    v_mfma_f32_16x16x32_bf16 v[160:163], v[60:63], v[44:47], v[160:163]
    ds_read_b64_tr_b16 v[56:57], v13 offset:20480
    v_mfma_f32_16x16x32_bf16 v[140:143], v[60:63], v[40:43], v[140:143]
    ds_read_b64_tr_b16 v[58:59], v13 offset:20992
    v_mfma_f32_16x16x32_bf16 v[120:123], v[60:63], v[36:39], v[120:123]
    v_mfma_f32_16x16x32_bf16 v[100:103], v[60:63], v[32:35], v[100:103]
    s_waitcnt lgkmcnt(10)
    s_barrier
    v_mfma_f32_16x16x32_bf16 v[104:107], v[64:67], v[32:35], v[104:107]
    ds_read_b64_tr_b16 v[60:61], v0 offset:20480
    v_mfma_f32_16x16x32_bf16 v[124:127], v[64:67], v[36:39], v[124:127]
    ds_read_b64_tr_b16 v[62:63], v0 offset:20992
    v_mfma_f32_16x16x32_bf16 v[144:147], v[64:67], v[40:43], v[144:147]
    v_mfma_f32_16x16x32_bf16 v[164:167], v[64:67], v[44:47], v[164:167]
    ds_read_b64_tr_b16 v[64:65], v5 offset:20480
    ds_read_b64_tr_b16 v[66:67], v5 offset:20992
    s_waitcnt lgkmcnt(8)
    v_mfma_f32_16x16x32_bf16 v[88:91], v[48:51], v[16:19], v[88:91]
    ds_read_b128 v[32:35], v87 offset:16384
    v_mfma_f32_16x16x32_bf16 v[108:111], v[48:51], v[20:23], v[108:111]
    ds_read_b128 v[36:39], v87 offset:18432
    v_mfma_f32_16x16x32_bf16 v[128:131], v[48:51], v[24:27], v[128:131]
    ds_read_b128 v[40:43], v87 offset:20480
    v_mfma_f32_16x16x32_bf16 v[148:151], v[48:51], v[28:31], v[148:151]
    ds_read_b128 v[44:47], v87 offset:22528
    s_waitcnt lgkmcnt(10)
    v_mfma_f32_16x16x32_bf16 v[152:155], v[52:55], v[28:31], v[152:155]
    ds_read_b64_tr_b16 v[48:49], v6 offset:0
    v_mfma_f32_16x16x32_bf16 v[132:135], v[52:55], v[24:27], v[132:135]
    ds_read_b64_tr_b16 v[50:51], v6 offset:512
    v_mfma_f32_16x16x32_bf16 v[112:115], v[52:55], v[20:23], v[112:115]
    v_mfma_f32_16x16x32_bf16 v[92:95], v[52:55], v[16:19], v[92:95]
    s_waitcnt lgkmcnt(10)
    v_mfma_f32_16x16x32_bf16 v[96:99], v[56:59], v[16:19], v[96:99]
    ds_read_b64_tr_b16 v[52:53], v7 offset:0
    v_mfma_f32_16x16x32_bf16 v[116:119], v[56:59], v[20:23], v[116:119]
    ds_read_b64_tr_b16 v[54:55], v7 offset:512
    v_mfma_f32_16x16x32_bf16 v[136:139], v[56:59], v[24:27], v[136:139]
    v_mfma_f32_16x16x32_bf16 v[156:159], v[56:59], v[28:31], v[156:159]
    s_waitcnt lgkmcnt(10)
    v_mfma_f32_16x16x32_bf16 v[160:163], v[60:63], v[28:31], v[160:163]
    ds_read_b64_tr_b16 v[56:57], v8 offset:0
    v_mfma_f32_16x16x32_bf16 v[140:143], v[60:63], v[24:27], v[140:143]
    ds_read_b64_tr_b16 v[58:59], v8 offset:512
    v_mfma_f32_16x16x32_bf16 v[120:123], v[60:63], v[20:23], v[120:123]
    v_mfma_f32_16x16x32_bf16 v[100:103], v[60:63], v[16:19], v[100:103]
    s_waitcnt lgkmcnt(10)
    s_barrier
    v_mfma_f32_16x16x32_bf16 v[104:107], v[64:67], v[16:19], v[104:107]
    ds_read_b64_tr_b16 v[60:61], v9 offset:0
    v_mfma_f32_16x16x32_bf16 v[124:127], v[64:67], v[20:23], v[124:127]
    ds_read_b64_tr_b16 v[62:63], v9 offset:512
    v_mfma_f32_16x16x32_bf16 v[144:147], v[64:67], v[24:27], v[144:147]
    v_mfma_f32_16x16x32_bf16 v[164:167], v[64:67], v[28:31], v[164:167]
    ds_read_b64_tr_b16 v[64:65], v10 offset:0
    ds_read_b64_tr_b16 v[66:67], v10 offset:512
    s_waitcnt lgkmcnt(8)
    v_mfma_f32_16x16x32_bf16 v[88:91], v[48:51], v[32:35], v[88:91]
    ds_read_b128 v[16:19], v86 offset:32768
    v_mfma_f32_16x16x32_bf16 v[108:111], v[48:51], v[36:39], v[108:111]
    ds_read_b128 v[20:23], v86 offset:34816
    v_mfma_f32_16x16x32_bf16 v[128:131], v[48:51], v[40:43], v[128:131]
    ds_read_b128 v[24:27], v86 offset:36864
    v_mfma_f32_16x16x32_bf16 v[148:151], v[48:51], v[44:47], v[148:151]
    ds_read_b128 v[28:31], v86 offset:38912
    s_waitcnt lgkmcnt(10)
    v_mfma_f32_16x16x32_bf16 v[152:155], v[52:55], v[44:47], v[152:155]
    ds_read_b64_tr_b16 v[48:49], v6 offset:20480
    v_mfma_f32_16x16x32_bf16 v[132:135], v[52:55], v[40:43], v[132:135]
    ds_read_b64_tr_b16 v[50:51], v6 offset:20992
    v_mfma_f32_16x16x32_bf16 v[112:115], v[52:55], v[36:39], v[112:115]
    v_mfma_f32_16x16x32_bf16 v[92:95], v[52:55], v[32:35], v[92:95]
    s_waitcnt lgkmcnt(10)
    v_mfma_f32_16x16x32_bf16 v[96:99], v[56:59], v[32:35], v[96:99]
    ds_read_b64_tr_b16 v[52:53], v7 offset:20480
    v_mfma_f32_16x16x32_bf16 v[116:119], v[56:59], v[36:39], v[116:119]
    ds_read_b64_tr_b16 v[54:55], v7 offset:20992
    v_mfma_f32_16x16x32_bf16 v[136:139], v[56:59], v[40:43], v[136:139]
    v_mfma_f32_16x16x32_bf16 v[156:159], v[56:59], v[44:47], v[156:159]
    s_waitcnt lgkmcnt(10)
    v_mfma_f32_16x16x32_bf16 v[160:163], v[60:63], v[44:47], v[160:163]
    ds_read_b64_tr_b16 v[56:57], v8 offset:20480
    v_mfma_f32_16x16x32_bf16 v[140:143], v[60:63], v[40:43], v[140:143]
    ds_read_b64_tr_b16 v[58:59], v8 offset:20992
    v_mfma_f32_16x16x32_bf16 v[120:123], v[60:63], v[36:39], v[120:123]
    v_mfma_f32_16x16x32_bf16 v[100:103], v[60:63], v[32:35], v[100:103]
    s_waitcnt lgkmcnt(10)
    s_barrier
    v_mfma_f32_16x16x32_bf16 v[104:107], v[64:67], v[32:35], v[104:107]
    ds_read_b64_tr_b16 v[60:61], v9 offset:20480
    v_mfma_f32_16x16x32_bf16 v[124:127], v[64:67], v[36:39], v[124:127]
    ds_read_b64_tr_b16 v[62:63], v9 offset:20992
    v_mfma_f32_16x16x32_bf16 v[144:147], v[64:67], v[40:43], v[144:147]
    v_mfma_f32_16x16x32_bf16 v[164:167], v[64:67], v[44:47], v[164:167]
    ds_read_b64_tr_b16 v[64:65], v10 offset:20480
    ds_read_b64_tr_b16 v[66:67], v10 offset:20992
    s_cmp_eq_u32 s33, 0
    s_cbranch_scc1 L_k1_epi_q
    s_branch L_sk_2522
L_gp_0:
    s_branch L_k1_c_qkv
L_sk_2522:
    s_setprio 1
    s_waitcnt lgkmcnt(8)
    v_mfma_f32_16x16x32_bf16 v[88:91], v[48:51], v[16:19], v[88:91]
    ds_read_b64_tr_b16 v[32:33], v6 offset:40960
    ds_read_b64_tr_b16 v[34:35], v6 offset:41472
    s_mul_i32 s64, s64, 163840
    s_mul_i32 s66, s66, 2560
    s_add_u32 s64, s64, s66
    s_add_u32 s64, s64, 2621440
    s_add_u32 s65, s64, 10240
    v_mul_u32_u24 v69, 163840, v69
    v_lshl_add_u32 v68, v68, 4, v69
    s_mov_b32 s60, 0x3ea52b5c
    s_mov_b32 s61, 0x3ea52b5c
    v_mov_b32 v69, 161044
    v_mfma_f32_16x16x32_bf16 v[108:111], v[48:51], v[20:23], v[108:111]
    ds_read_b128 v[36:39], v87 offset:32768
    ds_read_b128 v[40:43], v87 offset:34816
    s_waitcnt lgkmcnt(10)
    v_mfma_f32_16x16x32_bf16 v[112:115], v[52:55], v[20:23], v[112:115]
    ds_read_b64_tr_b16 v[44:45], v7 offset:40960
    ds_read_b64_tr_b16 v[46:47], v7 offset:41472
    v_mfma_f32_16x16x32_bf16 v[92:95], v[52:55], v[16:19], v[92:95]
    ds_read_b64_tr_b16 v[70:71], v8 offset:40960
    s_waitcnt lgkmcnt(11)
    v_mfma_f32_16x16x32_bf16 v[96:99], v[56:59], v[16:19], v[96:99]
    ds_read_b64_tr_b16 v[72:73], v8 offset:41472
    ds_read_b64_tr_b16 v[74:75], v9 offset:40960
    v_mfma_f32_16x16x32_bf16 v[116:119], v[56:59], v[20:23], v[116:119]
    s_waitcnt lgkmcnt(11)
    s_barrier
    v_mfma_f32_16x16x32_bf16 v[120:123], v[60:63], v[20:23], v[120:123]
    ds_read_b64_tr_b16 v[76:77], v9 offset:41472
    ds_read_b64_tr_b16 v[78:79], v10 offset:40960
    v_mfma_f32_16x16x32_bf16 v[100:103], v[60:63], v[16:19], v[100:103]
    s_waitcnt lgkmcnt(11)
    v_mfma_f32_16x16x32_bf16 v[104:107], v[64:67], v[16:19], v[104:107]
    ds_read_b64_tr_b16 v[80:81], v10 offset:41472
    ds_read_b64_tr_b16 v[82:83], v12 offset:0
    v_mfma_f32_16x16x32_bf16 v[124:127], v[64:67], v[20:23], v[124:127]
    s_waitcnt lgkmcnt(10)
    v_mfma_f32_16x16x32_bf16 v[88:91], v[32:35], v[36:39], v[88:91]
    ds_read_b64_tr_b16 v[84:85], v12 offset:512
    ds_read_b128 v[48:51], v86 offset:0
    s_waitcnt lgkmcnt(11)
    v_mfma_f32_16x16x32_bf16 v[108:111], v[32:35], v[40:43], v[108:111]
    ds_read_b64_tr_b16 v[52:53], v13 offset:0
    ds_read_b64_tr_b16 v[54:55], v13 offset:512
    s_waitcnt lgkmcnt(11)
    s_barrier
    v_mfma_f32_16x16x32_bf16 v[112:115], v[44:47], v[40:43], v[112:115]
    ds_read_b64_tr_b16 v[56:57], v0 offset:0
    ds_read_b64_tr_b16 v[58:59], v0 offset:512
    v_mfma_f32_16x16x32_bf16 v[92:95], v[44:47], v[36:39], v[92:95]
    s_waitcnt lgkmcnt(11)
    v_mfma_f32_16x16x32_bf16 v[96:99], v[70:73], v[36:39], v[96:99]
    ds_read_b64_tr_b16 v[60:61], v5 offset:0
    ds_read_b64_tr_b16 v[62:63], v5 offset:512
    v_mfma_f32_16x16x32_bf16 v[116:119], v[70:73], v[40:43], v[116:119]
    s_waitcnt lgkmcnt(11)
    v_mfma_f32_16x16x32_bf16 v[120:123], v[74:77], v[40:43], v[120:123]
    ds_read_b64_tr_b16 v[16:17], v11 offset:0
    ds_read_b64_tr_b16 v[18:19], v11 offset:512
    v_mfma_f32_16x16x32_bf16 v[100:103], v[74:77], v[36:39], v[100:103]
    s_waitcnt lgkmcnt(11)
    v_mfma_f32_16x16x32_bf16 v[104:107], v[78:81], v[36:39], v[104:107]
    ds_read_b64_tr_b16 v[64:65], v12 offset:20480
    ds_read_b64_tr_b16 v[66:67], v12 offset:20992
    v_mfma_f32_16x16x32_bf16 v[124:127], v[78:81], v[40:43], v[124:127]
    s_waitcnt lgkmcnt(10)
    v_mfma_f32_16x16x32_bf16 v[92:95], v[82:85], v[48:51], v[92:95]
    ds_read_b128 v[20:23], v87 offset:0
    ds_read_b64_tr_b16 v[32:33], v13 offset:20480
    s_waitcnt lgkmcnt(10)
    v_mfma_f32_16x16x32_bf16 v[96:99], v[52:55], v[48:51], v[96:99]
    ds_read_b64_tr_b16 v[34:35], v13 offset:20992
    ds_read_b64_tr_b16 v[44:45], v0 offset:20480
    s_waitcnt lgkmcnt(10)
    v_mfma_f32_16x16x32_bf16 v[100:103], v[56:59], v[48:51], v[100:103]
    ds_read_b64_tr_b16 v[46:47], v0 offset:20992
    ds_read_b64_tr_b16 v[70:71], v5 offset:20480
    s_waitcnt lgkmcnt(10)
    v_mfma_f32_16x16x32_bf16 v[104:107], v[60:63], v[48:51], v[104:107]
    ds_read_b64_tr_b16 v[72:73], v5 offset:20992
    ds_read_b64_tr_b16 v[74:75], v11 offset:20480
    s_waitcnt lgkmcnt(10)
    v_mfma_f32_16x16x32_bf16 v[88:91], v[16:19], v[48:51], v[88:91]
    ds_read_b64_tr_b16 v[76:77], v11 offset:20992
    ds_read_b128 v[36:39], v86 offset:2048
    s_waitcnt lgkmcnt(9)
    v_mfma_f32_16x16x32_bf16 v[92:95], v[64:67], v[20:23], v[92:95]
    ds_read_b128 v[78:81], v87 offset:2048
    ds_read_b128 v[40:43], v86 offset:4096
    s_waitcnt lgkmcnt(9)
    v_mfma_f32_16x16x32_bf16 v[96:99], v[32:35], v[20:23], v[96:99]
    ds_read_b128 v[48:51], v86 offset:6144
    s_waitcnt lgkmcnt(8)
    v_mfma_f32_16x16x32_bf16 v[100:103], v[44:47], v[20:23], v[100:103]
    s_waitcnt lgkmcnt(6)
    v_mfma_f32_16x16x32_bf16 v[104:107], v[70:73], v[20:23], v[104:107]
    s_waitcnt lgkmcnt(4)
    v_mfma_f32_16x16x32_bf16 v[88:91], v[74:77], v[20:23], v[88:91]
    ds_read_b128 v[20:23], v87 offset:4096
    s_waitcnt lgkmcnt(4)
    v_mfma_f32_16x16x32_bf16 v[112:115], v[82:85], v[36:39], v[112:115]
    v_mfma_f32_16x16x32_bf16 v[116:119], v[52:55], v[36:39], v[116:119]
    v_cvt_pk_bf16_f32 v96, v96, v97
    v_cvt_pk_bf16_f32 v97, v98, v99
    v_cvt_pk_bf16_f32 v98, v100, v101
    v_mfma_f32_16x16x32_bf16 v[120:123], v[56:59], v[36:39], v[120:123]
    v_cvt_pk_bf16_f32 v99, v102, v103
    buffer_store_dwordx4 v[96:99], v68, s[28:31], s64 offen offset:512 sc1
    v_cvt_pk_bf16_f32 v104, v104, v105
    v_mfma_f32_16x16x32_bf16 v[124:127], v[60:63], v[36:39], v[124:127]
    v_cvt_pk_bf16_f32 v105, v106, v107
    v_cvt_pk_bf16_f32 v88, v88, v89
    v_cvt_pk_bf16_f32 v89, v90, v91
    v_mfma_f32_16x16x32_bf16 v[108:111], v[16:19], v[36:39], v[108:111]
    ds_read_b128 v[36:39], v87 offset:6144
    v_cvt_pk_bf16_f32 v90, v92, v93
    v_cvt_pk_bf16_f32 v91, v94, v95
    buffer_store_dwordx4 v[88:91], v68, s[28:31], s64 offen offset:0 sc1
    s_waitcnt lgkmcnt(4)
    v_mfma_f32_16x16x32_bf16 v[112:115], v[64:67], v[78:81], v[112:115]
    v_mfma_f32_16x16x32_bf16 v[116:119], v[32:35], v[78:81], v[116:119]
    v_mfma_f32_16x16x32_bf16 v[120:123], v[44:47], v[78:81], v[120:123]
    v_mfma_f32_16x16x32_bf16 v[124:127], v[70:73], v[78:81], v[124:127]
    s_branch L_sk_2653
L_pad_mqk_1:
    s_branch L_k1_c_qkv
L_gp_1:
    s_branch L_k1_c_qkv
L_sk_2653:
    v_mfma_f32_16x16x32_bf16 v[108:111], v[74:77], v[78:81], v[108:111]
    ds_read_b64_tr_b16 v[78:79], v7 offset:20480
    ds_read_b64_tr_b16 v[80:81], v7 offset:20992
    s_waitcnt lgkmcnt(5)
    v_mfma_f32_16x16x32_bf16 v[128:131], v[16:19], v[40:43], v[128:131]
    s_waitcnt lgkmcnt(4)
    v_mfma_f32_16x16x32_bf16 v[148:151], v[16:19], v[48:51], v[148:151]
    ds_read_b64_tr_b16 v[16:17], v8 offset:20480
    ds_read_b64_tr_b16 v[18:19], v8 offset:20992
    v_cvt_pk_bf16_f32 v116, v116, v117
    v_cvt_pk_bf16_f32 v117, v118, v119
    v_cvt_pk_bf16_f32 v118, v120, v121
    v_mfma_f32_16x16x32_bf16 v[152:155], v[82:85], v[48:51], v[152:155]
    v_cvt_pk_bf16_f32 v119, v122, v123
    buffer_store_dwordx4 v[116:119], v68, s[28:31], s64 offen offset:768 sc1
    v_cvt_pk_bf16_f32 v106, v124, v125
    v_mfma_f32_16x16x32_bf16 v[132:135], v[82:85], v[40:43], v[132:135]
    ds_read_b64_tr_b16 v[82:83], v9 offset:20480
    ds_read_b64_tr_b16 v[84:85], v9 offset:20992
    v_cvt_pk_bf16_f32 v107, v126, v127
    buffer_store_dwordx4 v[104:107], v68, s[28:31], s64 offen offset:1024 sc1
    v_cvt_pk_bf16_f32 v108, v108, v109
    v_mfma_f32_16x16x32_bf16 v[136:139], v[52:55], v[40:43], v[136:139]
    v_cvt_pk_bf16_f32 v109, v110, v111
    v_cvt_pk_bf16_f32 v110, v112, v113
    v_cvt_pk_bf16_f32 v111, v114, v115
    v_mfma_f32_16x16x32_bf16 v[156:159], v[52:55], v[48:51], v[156:159]
    ds_read_b64_tr_b16 v[52:53], v10 offset:20480
    ds_read_b64_tr_b16 v[54:55], v10 offset:20992
    buffer_store_dwordx4 v[108:111], v68, s[28:31], s64 offen offset:256 sc1
    s_setprio 0
    v_mfma_f32_16x16x32_bf16 v[160:163], v[56:59], v[48:51], v[160:163]
    v_mfma_f32_16x16x32_bf16 v[140:143], v[56:59], v[40:43], v[140:143]
    ds_read_b64_tr_b16 v[56:57], v6 offset:20480
    ds_read_b64_tr_b16 v[58:59], v6 offset:20992
    v_mfma_f32_16x16x32_bf16 v[144:147], v[60:63], v[40:43], v[144:147]
    ds_read_b64_tr_b16 v[40:41], v7 offset:40960
    v_mfma_f32_16x16x32_bf16 v[164:167], v[60:63], v[48:51], v[164:167]
    s_waitcnt lgkmcnt(12)
    v_mfma_f32_16x16x32_bf16 v[128:131], v[74:77], v[20:23], v[128:131]
    ds_read_b64_tr_b16 v[42:43], v7 offset:41472
    s_waitcnt lgkmcnt(12)
    v_mfma_f32_16x16x32_bf16 v[148:151], v[74:77], v[36:39], v[148:151]
    ds_read_b128 v[60:63], v87 offset:36864
    v_mfma_f32_16x16x32_bf16 v[152:155], v[64:67], v[36:39], v[152:155]
    v_mfma_f32_16x16x32_bf16 v[132:135], v[64:67], v[20:23], v[132:135]
    v_mfma_f32_16x16x32_bf16 v[136:139], v[32:35], v[20:23], v[136:139]
    v_mfma_f32_16x16x32_bf16 v[156:159], v[32:35], v[36:39], v[156:159]
    v_mfma_f32_16x16x32_bf16 v[160:163], v[44:47], v[36:39], v[160:163]
    v_mfma_f32_16x16x32_bf16 v[140:143], v[44:47], v[20:23], v[140:143]
    v_mfma_f32_16x16x32_bf16 v[144:147], v[70:73], v[20:23], v[144:147]
    v_mfma_f32_16x16x32_bf16 v[164:167], v[70:73], v[36:39], v[164:167]
    s_waitcnt lgkmcnt(11)
    v_mfma_f32_16x16x32_bf16 v[132:135], v[78:81], v[24:27], v[132:135]
    ds_read_b64_tr_b16 v[48:49], v8 offset:40960
    ds_read_b64_tr_b16 v[50:51], v8 offset:41472
    s_waitcnt lgkmcnt(11)
    v_mfma_f32_16x16x32_bf16 v[136:139], v[16:19], v[24:27], v[136:139]
    ds_read_b64_tr_b16 v[74:75], v9 offset:40960
    ds_read_b64_tr_b16 v[76:77], v9 offset:41472
    s_waitcnt lgkmcnt(11)
    v_mfma_f32_16x16x32_bf16 v[140:143], v[82:85], v[24:27], v[140:143]
    ds_read_b64_tr_b16 v[64:65], v10 offset:40960
    ds_read_b64_tr_b16 v[66:67], v10 offset:41472
    s_waitcnt lgkmcnt(11)
    v_mfma_f32_16x16x32_bf16 v[144:147], v[52:55], v[24:27], v[144:147]
    ds_read_b64_tr_b16 v[32:33], v6 offset:40960
    ds_read_b64_tr_b16 v[34:35], v6 offset:41472
    s_waitcnt lgkmcnt(11)
    v_mfma_f32_16x16x32_bf16 v[128:131], v[56:59], v[24:27], v[128:131]
    ds_read_b128 v[44:47], v87 offset:38912
    s_waitcnt lgkmcnt(9)
    v_mfma_f32_16x16x32_bf16 v[132:135], v[40:43], v[60:63], v[132:135]
    s_waitcnt lgkmcnt(7)
    v_mfma_f32_16x16x32_bf16 v[136:139], v[48:51], v[60:63], v[136:139]
    s_waitcnt lgkmcnt(5)
    v_mfma_f32_16x16x32_bf16 v[140:143], v[74:77], v[60:63], v[140:143]
    s_waitcnt lgkmcnt(3)
    v_mfma_f32_16x16x32_bf16 v[144:147], v[64:67], v[60:63], v[144:147]
    s_waitcnt lgkmcnt(1)
    v_mfma_f32_16x16x32_bf16 v[128:131], v[32:35], v[60:63], v[128:131]
    v_mfma_f32_16x16x32_bf16 v[152:155], v[78:81], v[28:31], v[152:155]
    v_mfma_f32_16x16x32_bf16 v[156:159], v[16:19], v[28:31], v[156:159]
    v_cvt_pk_bf16_f32 v136, v136, v137
    v_cvt_pk_bf16_f32 v137, v138, v139
    v_cvt_pk_bf16_f32 v138, v140, v141
    v_mfma_f32_16x16x32_bf16 v[160:163], v[82:85], v[28:31], v[160:163]
    v_cvt_pk_bf16_f32 v139, v142, v143
    buffer_store_dwordx4 v[136:139], v68, s[28:31], s65 offen offset:512 sc1
    v_cvt_pk_bf16_f32 v144, v144, v145
    v_mfma_f32_16x16x32_bf16 v[164:167], v[52:55], v[28:31], v[164:167]
    v_cvt_pk_bf16_f32 v145, v146, v147
    v_cvt_pk_bf16_f32 v128, v128, v129
    v_cvt_pk_bf16_f32 v129, v130, v131
    v_mfma_f32_16x16x32_bf16 v[148:151], v[56:59], v[28:31], v[148:151]
    s_mov_b64 exec, 1
    s_waitcnt vmcnt(1)
    ds_add_u32 v69, v69
    s_mov_b64 exec, -1
    v_cvt_pk_bf16_f32 v130, v132, v133
    v_cvt_pk_bf16_f32 v131, v134, v135
    buffer_store_dwordx4 v[128:131], v68, s[28:31], s65 offen offset:0 sc1
    s_waitcnt lgkmcnt(1)
    v_mfma_f32_16x16x32_bf16 v[152:155], v[40:43], v[44:47], v[152:155]
    v_mfma_f32_16x16x32_bf16 v[156:159], v[48:51], v[44:47], v[156:159]
    v_mfma_f32_16x16x32_bf16 v[160:163], v[74:77], v[44:47], v[160:163]
    v_mfma_f32_16x16x32_bf16 v[164:167], v[64:67], v[44:47], v[164:167]
    v_mfma_f32_16x16x32_bf16 v[148:151], v[32:35], v[44:47], v[148:151]
    s_nop 7
    v_cvt_pk_bf16_f32 v156, v156, v157
    v_cvt_pk_bf16_f32 v157, v158, v159
    v_cvt_pk_bf16_f32 v158, v160, v161
    v_cvt_pk_bf16_f32 v159, v162, v163
    buffer_store_dwordx4 v[156:159], v68, s[28:31], s65 offen offset:768 sc1
    v_cvt_pk_bf16_f32 v146, v164, v165
    v_cvt_pk_bf16_f32 v147, v166, v167
    buffer_store_dwordx4 v[144:147], v68, s[28:31], s65 offen offset:1024 sc1
    v_cvt_pk_bf16_f32 v148, v148, v149
    v_cvt_pk_bf16_f32 v149, v150, v151
    v_cvt_pk_bf16_f32 v150, v152, v153
    v_cvt_pk_bf16_f32 v151, v154, v155
    buffer_store_dwordx4 v[148:151], v68, s[28:31], s65 offen offset:256 sc1
    s_branch L_cdone
L_pad_mqk_2:
    s_branch L_k1_c_qkv
L_k1_epi_q:
    s_setprio 1
    s_waitcnt lgkmcnt(8)
    v_mfma_f32_16x16x32_bf16 v[88:91], v[48:51], v[16:19], v[88:91]
    ds_read_b64_tr_b16 v[32:33], v6 offset:40960
    ds_read_b64_tr_b16 v[34:35], v6 offset:41472
    s_mul_i32 s64, s64, 81920
    s_mul_i32 s66, s66, 1280
    s_add_u32 s64, s64, s66
    s_add_u32 s64, s64, 0
    s_add_u32 s65, s64, 5120
    v_mul_u32_u24 v69, 81920, v69
    v_lshl_add_u32 v68, v68, 4, v69
    s_mov_b32 s60, 0x3ea52b5c
    s_mov_b32 s61, 0x3ea52b5c
    v_mov_b32 v69, 161044
    v_mfma_f32_16x16x32_bf16 v[108:111], v[48:51], v[20:23], v[108:111]
    ds_read_b128 v[36:39], v87 offset:32768
    ds_read_b128 v[40:43], v87 offset:34816
    s_waitcnt lgkmcnt(10)
    v_mfma_f32_16x16x32_bf16 v[112:115], v[52:55], v[20:23], v[112:115]
    ds_read_b64_tr_b16 v[44:45], v7 offset:40960
    ds_read_b64_tr_b16 v[46:47], v7 offset:41472
    v_mfma_f32_16x16x32_bf16 v[92:95], v[52:55], v[16:19], v[92:95]
    ds_read_b64_tr_b16 v[70:71], v8 offset:40960
    s_branch L_sk_2809
L_gp_2:
    s_branch L_k1_c_qkv
L_sk_2809:
    s_waitcnt lgkmcnt(11)
    v_mfma_f32_16x16x32_bf16 v[96:99], v[56:59], v[16:19], v[96:99]
    ds_read_b64_tr_b16 v[72:73], v8 offset:41472
    ds_read_b64_tr_b16 v[74:75], v9 offset:40960
    v_mfma_f32_16x16x32_bf16 v[116:119], v[56:59], v[20:23], v[116:119]
    s_waitcnt lgkmcnt(11)
    s_barrier
    v_mfma_f32_16x16x32_bf16 v[120:123], v[60:63], v[20:23], v[120:123]
    ds_read_b64_tr_b16 v[76:77], v9 offset:41472
    ds_read_b64_tr_b16 v[78:79], v10 offset:40960
    v_mfma_f32_16x16x32_bf16 v[100:103], v[60:63], v[16:19], v[100:103]
    s_waitcnt lgkmcnt(11)
    v_mfma_f32_16x16x32_bf16 v[104:107], v[64:67], v[16:19], v[104:107]
    ds_read_b64_tr_b16 v[80:81], v10 offset:41472
    ds_read_b64_tr_b16 v[82:83], v12 offset:0
    v_mfma_f32_16x16x32_bf16 v[124:127], v[64:67], v[20:23], v[124:127]
    s_waitcnt lgkmcnt(10)
    v_mfma_f32_16x16x32_bf16 v[88:91], v[32:35], v[36:39], v[88:91]
    ds_read_b64_tr_b16 v[84:85], v12 offset:512
    ds_read_b128 v[48:51], v86 offset:0
    s_waitcnt lgkmcnt(11)
    v_mfma_f32_16x16x32_bf16 v[108:111], v[32:35], v[40:43], v[108:111]
    ds_read_b64_tr_b16 v[52:53], v13 offset:0
    ds_read_b64_tr_b16 v[54:55], v13 offset:512
    s_waitcnt lgkmcnt(11)
    s_barrier
    v_mfma_f32_16x16x32_bf16 v[112:115], v[44:47], v[40:43], v[112:115]
    ds_read_b64_tr_b16 v[56:57], v0 offset:0
    ds_read_b64_tr_b16 v[58:59], v0 offset:512
    v_mfma_f32_16x16x32_bf16 v[92:95], v[44:47], v[36:39], v[92:95]
    s_waitcnt lgkmcnt(11)
    v_mfma_f32_16x16x32_bf16 v[96:99], v[70:73], v[36:39], v[96:99]
    ds_read_b64_tr_b16 v[60:61], v5 offset:0
    ds_read_b64_tr_b16 v[62:63], v5 offset:512
    v_mfma_f32_16x16x32_bf16 v[116:119], v[70:73], v[40:43], v[116:119]
    s_waitcnt lgkmcnt(11)
    v_mfma_f32_16x16x32_bf16 v[120:123], v[74:77], v[40:43], v[120:123]
    ds_read_b64_tr_b16 v[16:17], v11 offset:0
    ds_read_b64_tr_b16 v[18:19], v11 offset:512
    v_mfma_f32_16x16x32_bf16 v[100:103], v[74:77], v[36:39], v[100:103]
    s_waitcnt lgkmcnt(11)
    v_mfma_f32_16x16x32_bf16 v[104:107], v[78:81], v[36:39], v[104:107]
    ds_read_b64_tr_b16 v[64:65], v12 offset:20480
    ds_read_b64_tr_b16 v[66:67], v12 offset:20992
    v_mfma_f32_16x16x32_bf16 v[124:127], v[78:81], v[40:43], v[124:127]
    s_waitcnt lgkmcnt(10)
    v_mfma_f32_16x16x32_bf16 v[92:95], v[82:85], v[48:51], v[92:95]
    ds_read_b128 v[20:23], v87 offset:0
    ds_read_b64_tr_b16 v[32:33], v13 offset:20480
    s_waitcnt lgkmcnt(10)
    v_mfma_f32_16x16x32_bf16 v[96:99], v[52:55], v[48:51], v[96:99]
    ds_read_b64_tr_b16 v[34:35], v13 offset:20992
    ds_read_b64_tr_b16 v[44:45], v0 offset:20480
    s_waitcnt lgkmcnt(10)
    v_mfma_f32_16x16x32_bf16 v[100:103], v[56:59], v[48:51], v[100:103]
    ds_read_b64_tr_b16 v[46:47], v0 offset:20992
    ds_read_b64_tr_b16 v[70:71], v5 offset:20480
    s_waitcnt lgkmcnt(10)
    v_mfma_f32_16x16x32_bf16 v[104:107], v[60:63], v[48:51], v[104:107]
    ds_read_b64_tr_b16 v[72:73], v5 offset:20992
    ds_read_b64_tr_b16 v[74:75], v11 offset:20480
    s_waitcnt lgkmcnt(10)
    v_mfma_f32_16x16x32_bf16 v[88:91], v[16:19], v[48:51], v[88:91]
    ds_read_b64_tr_b16 v[76:77], v11 offset:20992
    ds_read_b128 v[36:39], v86 offset:2048
    s_waitcnt lgkmcnt(9)
    v_mfma_f32_16x16x32_bf16 v[92:95], v[64:67], v[20:23], v[92:95]
    ds_read_b128 v[78:81], v87 offset:2048
    ds_read_b128 v[40:43], v86 offset:4096
    s_waitcnt lgkmcnt(9)
    v_mfma_f32_16x16x32_bf16 v[96:99], v[32:35], v[20:23], v[96:99]
    ds_read_b128 v[48:51], v86 offset:6144
    s_waitcnt lgkmcnt(8)
    v_mfma_f32_16x16x32_bf16 v[100:103], v[44:47], v[20:23], v[100:103]
    s_waitcnt lgkmcnt(6)
    v_mfma_f32_16x16x32_bf16 v[104:107], v[70:73], v[20:23], v[104:107]
    s_waitcnt lgkmcnt(4)
    v_mfma_f32_16x16x32_bf16 v[88:91], v[74:77], v[20:23], v[88:91]
    ds_read_b128 v[20:23], v87 offset:4096
    s_waitcnt lgkmcnt(4)
    v_mfma_f32_16x16x32_bf16 v[112:115], v[82:85], v[36:39], v[112:115]
    v_mfma_f32_16x16x32_bf16 v[116:119], v[52:55], v[36:39], v[116:119]
    v_mul_f32 v96, s60, v96
    v_mul_f32 v97, s61, v97
    v_mul_f32 v98, s60, v98
    v_mfma_f32_16x16x32_bf16 v[120:123], v[56:59], v[36:39], v[120:123]
    v_mul_f32 v99, s61, v99
    v_mul_f32 v100, s60, v100
    v_mul_f32 v101, s61, v101
    v_mfma_f32_16x16x32_bf16 v[124:127], v[60:63], v[36:39], v[124:127]
    v_mul_f32 v102, s60, v102
    v_mul_f32 v103, s61, v103
    v_cvt_pk_bf16_f32 v96, v96, v97
    v_mfma_f32_16x16x32_bf16 v[108:111], v[16:19], v[36:39], v[108:111]
    ds_read_b128 v[36:39], v87 offset:6144
    v_cvt_pk_bf16_f32 v97, v98, v99
    v_cvt_pk_bf16_f32 v98, v100, v101
    v_cvt_pk_bf16_f32 v99, v102, v103
    s_waitcnt lgkmcnt(4)
    v_mfma_f32_16x16x32_bf16 v[112:115], v[64:67], v[78:81], v[112:115]
    buffer_store_dwordx4 v[96:99], v68, s[28:31], s64 offen offset:512 sc1
    v_mul_f32 v104, s60, v104
    v_mul_f32 v105, s61, v105
    v_mfma_f32_16x16x32_bf16 v[116:119], v[32:35], v[78:81], v[116:119]
    v_mul_f32 v106, s60, v106
    v_mul_f32 v107, s61, v107
    v_cvt_pk_bf16_f32 v104, v104, v105
    v_mfma_f32_16x16x32_bf16 v[120:123], v[44:47], v[78:81], v[120:123]
    v_cvt_pk_bf16_f32 v105, v106, v107
    v_mul_f32 v88, s60, v88
    v_mul_f32 v89, s61, v89
    v_mfma_f32_16x16x32_bf16 v[124:127], v[70:73], v[78:81], v[124:127]
    v_mul_f32 v90, s60, v90
    v_mul_f32 v91, s61, v91
    v_mul_f32 v92, s60, v92
    v_mfma_f32_16x16x32_bf16 v[108:111], v[74:77], v[78:81], v[108:111]
    ds_read_b64_tr_b16 v[78:79], v7 offset:20480
    ds_read_b64_tr_b16 v[80:81], v7 offset:20992
    v_mul_f32 v93, s61, v93
    v_mul_f32 v94, s60, v94
    v_mul_f32 v95, s61, v95
    s_waitcnt lgkmcnt(5)
    v_mfma_f32_16x16x32_bf16 v[128:131], v[16:19], v[40:43], v[128:131]
    v_cvt_pk_bf16_f32 v88, v88, v89
    v_cvt_pk_bf16_f32 v89, v90, v91
    v_cvt_pk_bf16_f32 v90, v92, v93
    s_waitcnt lgkmcnt(4)
    v_mfma_f32_16x16x32_bf16 v[148:151], v[16:19], v[48:51], v[148:151]
    ds_read_b64_tr_b16 v[16:17], v8 offset:20480
    ds_read_b64_tr_b16 v[18:19], v8 offset:20992
    v_cvt_pk_bf16_f32 v91, v94, v95
    buffer_store_dwordx4 v[88:91], v68, s[28:31], s64 offen offset:0 sc1
    v_mul_f32 v116, s60, v116
    v_mfma_f32_16x16x32_bf16 v[152:155], v[82:85], v[48:51], v[152:155]
    v_mul_f32 v117, s61, v117
    v_mul_f32 v118, s60, v118
    v_mul_f32 v119, s61, v119
    v_mfma_f32_16x16x32_bf16 v[132:135], v[82:85], v[40:43], v[132:135]
    ds_read_b64_tr_b16 v[82:83], v9 offset:20480
    ds_read_b64_tr_b16 v[84:85], v9 offset:20992
    v_mul_f32 v120, s60, v120
    v_mul_f32 v121, s61, v121
    v_mul_f32 v122, s60, v122
    v_mfma_f32_16x16x32_bf16 v[136:139], v[52:55], v[40:43], v[136:139]
    v_mul_f32 v123, s61, v123
    v_cvt_pk_bf16_f32 v116, v116, v117
    v_cvt_pk_bf16_f32 v117, v118, v119
    v_mfma_f32_16x16x32_bf16 v[156:159], v[52:55], v[48:51], v[156:159]
    ds_read_b64_tr_b16 v[52:53], v10 offset:20480
    ds_read_b64_tr_b16 v[54:55], v10 offset:20992
    v_cvt_pk_bf16_f32 v118, v120, v121
    v_cvt_pk_bf16_f32 v119, v122, v123
    buffer_store_dwordx4 v[116:119], v68, s[28:31], s64 offen offset:768 sc1
    v_mfma_f32_16x16x32_bf16 v[160:163], v[56:59], v[48:51], v[160:163]
    v_mul_f32 v124, s60, v124
    v_mul_f32 v125, s61, v125
    v_mul_f32 v126, s60, v126
    v_mfma_f32_16x16x32_bf16 v[140:143], v[56:59], v[40:43], v[140:143]
    ds_read_b64_tr_b16 v[56:57], v6 offset:20480
    ds_read_b64_tr_b16 v[58:59], v6 offset:20992
    v_mul_f32 v127, s61, v127
    v_cvt_pk_bf16_f32 v106, v124, v125
    v_cvt_pk_bf16_f32 v107, v126, v127
    v_mfma_f32_16x16x32_bf16 v[144:147], v[60:63], v[40:43], v[144:147]
    s_branch L_sk_2977
L_gp_3:
    s_branch L_k1_c_qkv
L_sk_2977:
    ds_read_b64_tr_b16 v[40:41], v7 offset:40960
    buffer_store_dwordx4 v[104:107], v68, s[28:31], s64 offen offset:1024 sc1
    v_mul_f32 v108, s60, v108
    v_mul_f32 v109, s61, v109
    v_mfma_f32_16x16x32_bf16 v[164:167], v[60:63], v[48:51], v[164:167]
    v_mul_f32 v110, s60, v110
    v_mul_f32 v111, s61, v111
    v_mul_f32 v112, s60, v112
    s_waitcnt lgkmcnt(12)
    v_mfma_f32_16x16x32_bf16 v[128:131], v[74:77], v[20:23], v[128:131]
    ds_read_b64_tr_b16 v[42:43], v7 offset:41472
    v_mul_f32 v113, s61, v113
    v_mul_f32 v114, s60, v114
    v_mul_f32 v115, s61, v115
    s_waitcnt lgkmcnt(12)
    v_mfma_f32_16x16x32_bf16 v[148:151], v[74:77], v[36:39], v[148:151]
    ds_read_b128 v[60:63], v87 offset:36864
    v_cvt_pk_bf16_f32 v108, v108, v109
    v_cvt_pk_bf16_f32 v109, v110, v111
    v_cvt_pk_bf16_f32 v110, v112, v113
    v_mfma_f32_16x16x32_bf16 v[152:155], v[64:67], v[36:39], v[152:155]
    v_cvt_pk_bf16_f32 v111, v114, v115
    buffer_store_dwordx4 v[108:111], v68, s[28:31], s64 offen offset:256 sc1
    s_setprio 0
    v_mfma_f32_16x16x32_bf16 v[132:135], v[64:67], v[20:23], v[132:135]
    v_mfma_f32_16x16x32_bf16 v[136:139], v[32:35], v[20:23], v[136:139]
    v_mfma_f32_16x16x32_bf16 v[156:159], v[32:35], v[36:39], v[156:159]
    v_mfma_f32_16x16x32_bf16 v[160:163], v[44:47], v[36:39], v[160:163]
    v_mfma_f32_16x16x32_bf16 v[140:143], v[44:47], v[20:23], v[140:143]
    v_mfma_f32_16x16x32_bf16 v[144:147], v[70:73], v[20:23], v[144:147]
    v_mfma_f32_16x16x32_bf16 v[164:167], v[70:73], v[36:39], v[164:167]
    s_waitcnt lgkmcnt(11)
    v_mfma_f32_16x16x32_bf16 v[132:135], v[78:81], v[24:27], v[132:135]
    ds_read_b64_tr_b16 v[48:49], v8 offset:40960
    ds_read_b64_tr_b16 v[50:51], v8 offset:41472
    s_waitcnt lgkmcnt(11)
    v_mfma_f32_16x16x32_bf16 v[136:139], v[16:19], v[24:27], v[136:139]
    ds_read_b64_tr_b16 v[74:75], v9 offset:40960
    ds_read_b64_tr_b16 v[76:77], v9 offset:41472
    s_waitcnt lgkmcnt(11)
    v_mfma_f32_16x16x32_bf16 v[140:143], v[82:85], v[24:27], v[140:143]
    ds_read_b64_tr_b16 v[64:65], v10 offset:40960
    ds_read_b64_tr_b16 v[66:67], v10 offset:41472
    s_waitcnt lgkmcnt(11)
    v_mfma_f32_16x16x32_bf16 v[144:147], v[52:55], v[24:27], v[144:147]
    ds_read_b64_tr_b16 v[32:33], v6 offset:40960
    ds_read_b64_tr_b16 v[34:35], v6 offset:41472
    s_waitcnt lgkmcnt(11)
    v_mfma_f32_16x16x32_bf16 v[128:131], v[56:59], v[24:27], v[128:131]
    ds_read_b128 v[44:47], v87 offset:38912
    s_waitcnt lgkmcnt(9)
    v_mfma_f32_16x16x32_bf16 v[132:135], v[40:43], v[60:63], v[132:135]
    s_waitcnt lgkmcnt(7)
    v_mfma_f32_16x16x32_bf16 v[136:139], v[48:51], v[60:63], v[136:139]
    s_waitcnt lgkmcnt(5)
    v_mfma_f32_16x16x32_bf16 v[140:143], v[74:77], v[60:63], v[140:143]
    s_waitcnt lgkmcnt(3)
    v_mfma_f32_16x16x32_bf16 v[144:147], v[64:67], v[60:63], v[144:147]
    s_waitcnt lgkmcnt(1)
    v_mfma_f32_16x16x32_bf16 v[128:131], v[32:35], v[60:63], v[128:131]
    v_mfma_f32_16x16x32_bf16 v[152:155], v[78:81], v[28:31], v[152:155]
    v_mfma_f32_16x16x32_bf16 v[156:159], v[16:19], v[28:31], v[156:159]
    v_mul_f32 v136, s60, v136
    v_mul_f32 v137, s61, v137
    v_mul_f32 v138, s60, v138
    v_mfma_f32_16x16x32_bf16 v[160:163], v[82:85], v[28:31], v[160:163]
    v_mul_f32 v139, s61, v139
    v_mul_f32 v140, s60, v140
    v_mul_f32 v141, s61, v141
    v_mfma_f32_16x16x32_bf16 v[164:167], v[52:55], v[28:31], v[164:167]
    v_mul_f32 v142, s60, v142
    v_mul_f32 v143, s61, v143
    v_cvt_pk_bf16_f32 v136, v136, v137
    v_mfma_f32_16x16x32_bf16 v[148:151], v[56:59], v[28:31], v[148:151]
    s_mov_b64 exec, 1
    s_waitcnt vmcnt(0)
    ds_add_u32 v69, v69
    s_mov_b64 exec, -1
    v_cvt_pk_bf16_f32 v137, v138, v139
    v_cvt_pk_bf16_f32 v138, v140, v141
    v_cvt_pk_bf16_f32 v139, v142, v143
    s_waitcnt lgkmcnt(1)
    v_mfma_f32_16x16x32_bf16 v[152:155], v[40:43], v[44:47], v[152:155]
    buffer_store_dwordx4 v[136:139], v68, s[28:31], s65 offen offset:512 sc1
    v_mul_f32 v144, s60, v144
    v_mul_f32 v145, s61, v145
    v_mfma_f32_16x16x32_bf16 v[156:159], v[48:51], v[44:47], v[156:159]
    v_mul_f32 v146, s60, v146
    v_mul_f32 v147, s61, v147
    v_cvt_pk_bf16_f32 v144, v144, v145
    v_mfma_f32_16x16x32_bf16 v[160:163], v[74:77], v[44:47], v[160:163]
    v_cvt_pk_bf16_f32 v145, v146, v147
    v_mul_f32 v128, s60, v128
    v_mul_f32 v129, s61, v129
    v_mfma_f32_16x16x32_bf16 v[164:167], v[64:67], v[44:47], v[164:167]
    v_mul_f32 v130, s60, v130
    v_mul_f32 v131, s61, v131
    v_mul_f32 v132, s60, v132
    v_mfma_f32_16x16x32_bf16 v[148:151], v[32:35], v[44:47], v[148:151]
    v_mul_f32 v133, s61, v133
    v_mul_f32 v134, s60, v134
    v_mul_f32 v135, s61, v135
    v_cvt_pk_bf16_f32 v128, v128, v129
    v_cvt_pk_bf16_f32 v129, v130, v131
    v_cvt_pk_bf16_f32 v130, v132, v133
    v_cvt_pk_bf16_f32 v131, v134, v135
    buffer_store_dwordx4 v[128:131], v68, s[28:31], s65 offen offset:0 sc1
    s_nop 7
    v_mul_f32 v156, s60, v156
    v_mul_f32 v157, s61, v157
    v_mul_f32 v158, s60, v158
    v_mul_f32 v159, s61, v159
    v_mul_f32 v160, s60, v160
    v_mul_f32 v161, s61, v161
    v_mul_f32 v162, s60, v162
    v_mul_f32 v163, s61, v163
    v_cvt_pk_bf16_f32 v156, v156, v157
    v_cvt_pk_bf16_f32 v157, v158, v159
    v_cvt_pk_bf16_f32 v158, v160, v161
    v_cvt_pk_bf16_f32 v159, v162, v163
    buffer_store_dwordx4 v[156:159], v68, s[28:31], s65 offen offset:768 sc1
    v_mul_f32 v164, s60, v164
    v_mul_f32 v165, s61, v165
    v_mul_f32 v166, s60, v166
    v_mul_f32 v167, s61, v167
    v_cvt_pk_bf16_f32 v146, v164, v165
    v_cvt_pk_bf16_f32 v147, v166, v167
    buffer_store_dwordx4 v[144:147], v68, s[28:31], s65 offen offset:1024 sc1
    v_mul_f32 v148, s60, v148
    v_mul_f32 v149, s61, v149
    v_mul_f32 v150, s60, v150
    v_mul_f32 v151, s61, v151
    v_mul_f32 v152, s60, v152
    v_mul_f32 v153, s61, v153
    v_mul_f32 v154, s60, v154
    v_mul_f32 v155, s61, v155
    v_cvt_pk_bf16_f32 v148, v148, v149
    v_cvt_pk_bf16_f32 v149, v150, v151
    v_cvt_pk_bf16_f32 v150, v152, v153
    v_cvt_pk_bf16_f32 v151, v154, v155
    buffer_store_dwordx4 v[148:151], v68, s[28:31], s65 offen offset:256 sc1
    s_branch L_cdone
L_pad_mv_0:
    s_branch L_k1_c_qkv
L_k1_c_v:
    s_barrier
    ds_read_b64_tr_b16 v[48:49], v6 offset:0
    ds_read_b64_tr_b16 v[50:51], v6 offset:512
    ds_read_b128 v[16:19], v86 offset:0
    ds_read_b128 v[20:23], v86 offset:2048
    ds_read_b128 v[24:27], v86 offset:4096
    ds_read_b128 v[28:31], v86 offset:6144
    ds_read_b64_tr_b16 v[52:53], v7 offset:0
    ds_read_b64_tr_b16 v[54:55], v7 offset:512
    ds_read_b64_tr_b16 v[56:57], v8 offset:0
    ds_read_b64_tr_b16 v[58:59], v8 offset:512
    ds_read_b64_tr_b16 v[60:61], v9 offset:0
    ds_read_b64_tr_b16 v[62:63], v9 offset:512
    ds_read_b64_tr_b16 v[64:65], v10 offset:0
    ds_read_b64_tr_b16 v[66:67], v10 offset:512
    s_waitcnt lgkmcnt(8)
    v_mfma_f32_16x16x32_bf16 v[88:91], v[16:19], v[48:51], 0
    v_mfma_f32_16x16x32_bf16 v[108:111], v[20:23], v[48:51], 0
    v_mfma_f32_16x16x32_bf16 v[128:131], v[24:27], v[48:51], 0
    v_mfma_f32_16x16x32_bf16 v[148:151], v[28:31], v[48:51], 0
    s_waitcnt lgkmcnt(6)
    v_mfma_f32_16x16x32_bf16 v[152:155], v[28:31], v[52:55], 0
    v_mfma_f32_16x16x32_bf16 v[132:135], v[24:27], v[52:55], 0
    v_mfma_f32_16x16x32_bf16 v[112:115], v[20:23], v[52:55], 0
    v_mfma_f32_16x16x32_bf16 v[92:95], v[16:19], v[52:55], 0
    s_waitcnt lgkmcnt(4)
    v_mfma_f32_16x16x32_bf16 v[96:99], v[16:19], v[56:59], 0
    v_mfma_f32_16x16x32_bf16 v[116:119], v[20:23], v[56:59], 0
    v_mfma_f32_16x16x32_bf16 v[136:139], v[24:27], v[56:59], 0
    v_mfma_f32_16x16x32_bf16 v[156:159], v[28:31], v[56:59], 0
    s_waitcnt lgkmcnt(2)
    s_barrier
    v_mfma_f32_16x16x32_bf16 v[160:163], v[28:31], v[60:63], 0
    ds_read_b64_tr_b16 v[48:49], v6 offset:20480
    ds_read_b64_tr_b16 v[50:51], v6 offset:20992
    v_mfma_f32_16x16x32_bf16 v[140:143], v[24:27], v[60:63], 0
    ds_read_b128 v[32:35], v87 offset:0
    ds_read_b128 v[36:39], v87 offset:2048
    v_mfma_f32_16x16x32_bf16 v[120:123], v[20:23], v[60:63], 0
    ds_read_b128 v[40:43], v87 offset:4096
    ds_read_b128 v[44:47], v87 offset:6144
    v_mfma_f32_16x16x32_bf16 v[100:103], v[16:19], v[60:63], 0
    ds_read_b64_tr_b16 v[52:53], v7 offset:20480
    ds_read_b64_tr_b16 v[54:55], v7 offset:20992
    s_waitcnt lgkmcnt(8)
    v_mfma_f32_16x16x32_bf16 v[104:107], v[16:19], v[64:67], 0
    ds_read_b64_tr_b16 v[56:57], v8 offset:20480
    ds_read_b64_tr_b16 v[58:59], v8 offset:20992
    v_mfma_f32_16x16x32_bf16 v[124:127], v[20:23], v[64:67], 0
    ds_read_b64_tr_b16 v[60:61], v9 offset:20480
    ds_read_b64_tr_b16 v[62:63], v9 offset:20992
    v_mfma_f32_16x16x32_bf16 v[144:147], v[24:27], v[64:67], 0
    v_mfma_f32_16x16x32_bf16 v[164:167], v[28:31], v[64:67], 0
    ds_read_b64_tr_b16 v[64:65], v10 offset:20480
    ds_read_b64_tr_b16 v[66:67], v10 offset:20992
    s_waitcnt lgkmcnt(8)
    v_mfma_f32_16x16x32_bf16 v[88:91], v[32:35], v[48:51], v[88:91]
    v_mfma_f32_16x16x32_bf16 v[108:111], v[36:39], v[48:51], v[108:111]
    s_lshr_b32 s34, s2, 3
    v_mfma_f32_16x16x32_bf16 v[128:131], v[40:43], v[48:51], v[128:131]
    v_mfma_f32_16x16x32_bf16 v[148:151], v[44:47], v[48:51], v[148:151]
    s_and_b32 s58, s2, 7
    s_waitcnt lgkmcnt(6)
    v_mfma_f32_16x16x32_bf16 v[152:155], v[44:47], v[52:55], v[152:155]
    s_lshl_b32 s58, s58, 2
    v_mfma_f32_16x16x32_bf16 v[132:135], v[40:43], v[52:55], v[132:135]
    v_mfma_f32_16x16x32_bf16 v[112:115], v[36:39], v[52:55], v[112:115]
    s_bfe_u32 s59, s2, 0x20003
    v_mfma_f32_16x16x32_bf16 v[92:95], v[32:35], v[52:55], v[92:95]
    s_waitcnt lgkmcnt(4)
    v_mfma_f32_16x16x32_bf16 v[96:99], v[32:35], v[56:59], v[96:99]
    s_add_u32 s58, s58, s59
    v_mfma_f32_16x16x32_bf16 v[116:119], v[36:39], v[56:59], v[116:119]
    s_lshr_b32 s7, s2, 5
    v_mfma_f32_16x16x32_bf16 v[136:139], v[40:43], v[56:59], v[136:139]
    s_lshl_b32 s7, s7, 3
    v_mfma_f32_16x16x32_bf16 v[156:159], v[44:47], v[56:59], v[156:159]
    s_add_u32 s7, s7, s36
    s_waitcnt lgkmcnt(2)
    v_mfma_f32_16x16x32_bf16 v[160:163], v[44:47], v[60:63], v[160:163]
    s_mul_i32 s7, s7, 40
    v_mfma_f32_16x16x32_bf16 v[140:143], v[40:43], v[60:63], v[140:143]
    v_mfma_f32_16x16x32_bf16 v[120:123], v[36:39], v[60:63], v[120:123]
    s_add_u32 s6, s7, s58
    v_mfma_f32_16x16x32_bf16 v[100:103], v[32:35], v[60:63], v[100:103]
    s_waitcnt lgkmcnt(0)
    v_mfma_f32_16x16x32_bf16 v[104:107], v[32:35], v[64:67], v[104:107]
    v_mfma_f32_16x16x32_bf16 v[124:127], v[36:39], v[64:67], v[124:127]
    s_lshl_b32 s6, s6, 10
    v_mfma_f32_16x16x32_bf16 v[144:147], v[40:43], v[64:67], v[144:147]
    v_mfma_f32_16x16x32_bf16 v[164:167], v[44:47], v[64:67], v[164:167]
    s_add_u32 s6, s6, 14155776
    s_barrier
    ds_read_b64_tr_b16 v[48:49], v6 offset:40960
    ds_read_b64_tr_b16 v[50:51], v6 offset:41472
    ds_read_b128 v[16:19], v86 offset:16384
    ds_read_b128 v[20:23], v86 offset:18432
    ds_read_b128 v[24:27], v86 offset:20480
    ds_read_b128 v[28:31], v86 offset:22528
    ds_read_b64_tr_b16 v[52:53], v7 offset:40960
    ds_read_b64_tr_b16 v[54:55], v7 offset:41472
    ds_read_b64_tr_b16 v[56:57], v8 offset:40960
    ds_read_b64_tr_b16 v[58:59], v8 offset:41472
    ds_read_b64_tr_b16 v[60:61], v9 offset:40960
    ds_read_b64_tr_b16 v[62:63], v9 offset:41472
    ds_read_b64_tr_b16 v[64:65], v10 offset:40960
    ds_read_b64_tr_b16 v[66:67], v10 offset:41472
    s_waitcnt lgkmcnt(8)
    v_mfma_f32_16x16x32_bf16 v[88:91], v[16:19], v[48:51], v[88:91]
    v_mfma_f32_16x16x32_bf16 v[108:111], v[20:23], v[48:51], v[108:111]
    s_lshr_b32 s58, s58, 2
    v_mfma_f32_16x16x32_bf16 v[128:131], v[24:27], v[48:51], v[128:131]
    v_mfma_f32_16x16x32_bf16 v[148:151], v[28:31], v[48:51], v[148:151]
    s_add_u32 s7, s7, s58
    s_waitcnt lgkmcnt(6)
    v_mfma_f32_16x16x32_bf16 v[152:155], v[28:31], v[52:55], v[152:155]
    s_lshl_b32 s7, s7, 10
    v_mfma_f32_16x16x32_bf16 v[132:135], v[24:27], v[52:55], v[132:135]
    v_mfma_f32_16x16x32_bf16 v[112:115], v[20:23], v[52:55], v[112:115]
    s_add_u32 s7, s7, 14188544
    v_mfma_f32_16x16x32_bf16 v[92:95], v[16:19], v[52:55], v[92:95]
    s_waitcnt lgkmcnt(4)
    v_mfma_f32_16x16x32_bf16 v[96:99], v[16:19], v[56:59], v[96:99]
    s_and_b32 s58, s59, 1
    v_mfma_f32_16x16x32_bf16 v[116:119], v[20:23], v[56:59], v[116:119]
    s_lshl_b32 s58, s58, 9
    v_mfma_f32_16x16x32_bf16 v[136:139], v[24:27], v[56:59], v[136:139]
    s_add_u32 s7, s7, s58
    v_mfma_f32_16x16x32_bf16 v[156:159], v[28:31], v[56:59], v[156:159]
    s_and_b32 s58, s59, 2
    s_waitcnt lgkmcnt(2)
    s_barrier
    v_mfma_f32_16x16x32_bf16 v[160:163], v[28:31], v[60:63], v[160:163]
    ds_read_b64_tr_b16 v[48:49], v11 offset:0
    ds_read_b64_tr_b16 v[50:51], v11 offset:512
    s_lshl_b32 s58, s58, 7
    v_mfma_f32_16x16x32_bf16 v[140:143], v[24:27], v[60:63], v[140:143]
    ds_read_b128 v[32:35], v87 offset:16384
    ds_read_b128 v[36:39], v87 offset:18432
    v_mfma_f32_16x16x32_bf16 v[120:123], v[20:23], v[60:63], v[120:123]
    ds_read_b128 v[40:43], v87 offset:20480
    ds_read_b128 v[44:47], v87 offset:22528
    s_add_u32 s7, s7, s58
    v_mfma_f32_16x16x32_bf16 v[100:103], v[16:19], v[60:63], v[100:103]
    ds_read_b64_tr_b16 v[52:53], v12 offset:0
    ds_read_b64_tr_b16 v[54:55], v12 offset:512
    s_waitcnt lgkmcnt(8)
    v_mfma_f32_16x16x32_bf16 v[104:107], v[16:19], v[64:67], v[104:107]
    ds_read_b64_tr_b16 v[56:57], v13 offset:0
    s_branch L_sk_3275
L_pad_mv_1:
    s_branch L_k1_c_qkv
L_sk_3275:
    ds_read_b64_tr_b16 v[58:59], v13 offset:512
    v_mfma_f32_16x16x32_bf16 v[124:127], v[20:23], v[64:67], v[124:127]
    ds_read_b64_tr_b16 v[60:61], v0 offset:0
    ds_read_b64_tr_b16 v[62:63], v0 offset:512
    s_and_b32 s13, s2, 7
    v_mfma_f32_16x16x32_bf16 v[144:147], v[24:27], v[64:67], v[144:147]
    v_mfma_f32_16x16x32_bf16 v[164:167], v[28:31], v[64:67], v[164:167]
    s_lshl_b32 s13, s13, 2
    ds_read_b64_tr_b16 v[64:65], v5 offset:0
    ds_read_b64_tr_b16 v[66:67], v5 offset:512
    s_waitcnt lgkmcnt(8)
    v_mfma_f32_16x16x32_bf16 v[88:91], v[32:35], v[48:51], v[88:91]
    v_mfma_f32_16x16x32_bf16 v[108:111], v[36:39], v[48:51], v[108:111]
    s_and_b32 s34, s34, 3
    v_mfma_f32_16x16x32_bf16 v[128:131], v[40:43], v[48:51], v[128:131]
    v_mfma_f32_16x16x32_bf16 v[148:151], v[44:47], v[48:51], v[148:151]
    s_add_u32 s13, s13, s34
    s_waitcnt lgkmcnt(6)
    v_mfma_f32_16x16x32_bf16 v[152:155], v[44:47], v[52:55], v[152:155]
    s_lshr_b32 s34, s2, 5
    v_mfma_f32_16x16x32_bf16 v[132:135], v[40:43], v[52:55], v[132:135]
    s_barrier
    v_mfma_f32_16x16x32_bf16 v[112:115], v[36:39], v[52:55], v[112:115]
    ds_read_b64_tr_b16 v[48:49], v11 offset:20480
    ds_read_b64_tr_b16 v[50:51], v11 offset:20992
    s_lshr_b32 s38, s36, 2
    v_mfma_f32_16x16x32_bf16 v[92:95], v[32:35], v[52:55], v[92:95]
    ds_read_b128 v[16:19], v86 offset:32768
    ds_read_b128 v[20:23], v86 offset:34816
    s_waitcnt lgkmcnt(8)
    v_mfma_f32_16x16x32_bf16 v[96:99], v[32:35], v[56:59], v[96:99]
    ds_read_b128 v[24:27], v86 offset:36864
    ds_read_b128 v[28:31], v86 offset:38912
    s_mov_b64 s[20:21], 0xffffffff
    v_mfma_f32_16x16x32_bf16 v[116:119], v[36:39], v[56:59], v[116:119]
    ds_read_b64_tr_b16 v[52:53], v12 offset:20480
    ds_read_b64_tr_b16 v[54:55], v12 offset:20992
    s_mov_b32 s22, 0x000fffff
    v_mfma_f32_16x16x32_bf16 v[136:139], v[40:43], v[56:59], v[136:139]
    s_mov_b32 s23, 0x000fffff
    v_mfma_f32_16x16x32_bf16 v[156:159], v[44:47], v[56:59], v[156:159]
    s_not_b64 s[24:25], s[20:21]
    s_waitcnt lgkmcnt(10)
    v_mfma_f32_16x16x32_bf16 v[160:163], v[44:47], v[60:63], v[160:163]
    ds_read_b64_tr_b16 v[56:57], v13 offset:20480
    ds_read_b64_tr_b16 v[58:59], v13 offset:20992
    s_mov_b32 s14, 0
    v_mfma_f32_16x16x32_bf16 v[140:143], v[40:43], v[60:63], v[140:143]
    v_mfma_f32_16x16x32_bf16 v[120:123], v[36:39], v[60:63], v[120:123]
    s_xor_b32 s15, s38, 1
    v_mfma_f32_16x16x32_bf16 v[100:103], v[32:35], v[60:63], v[100:103]
    s_waitcnt lgkmcnt(10)
    s_barrier
    v_mfma_f32_16x16x32_bf16 v[104:107], v[32:35], v[64:67], v[104:107]
    ds_read_b64_tr_b16 v[60:61], v0 offset:20480
    ds_read_b64_tr_b16 v[62:63], v0 offset:20992
    v_mfma_f32_16x16x32_bf16 v[124:127], v[36:39], v[64:67], v[124:127]
    s_mul_i32 s54, s37, 39936
    v_mfma_f32_16x16x32_bf16 v[144:147], v[40:43], v[64:67], v[144:147]
    v_mfma_f32_16x16x32_bf16 v[164:167], v[44:47], v[64:67], v[164:167]
    s_add_u32 s54, s54, 64
    ds_read_b64_tr_b16 v[64:65], v5 offset:20480
    ds_read_b64_tr_b16 v[66:67], v5 offset:20992
    s_waitcnt lgkmcnt(8)
    v_mfma_f32_16x16x32_bf16 v[88:91], v[16:19], v[48:51], v[88:91]
    ds_read_b128 v[32:35], v87 offset:32768
    v_mfma_f32_16x16x32_bf16 v[108:111], v[20:23], v[48:51], v[108:111]
    ds_read_b128 v[36:39], v87 offset:34816
    s_mul_i32 s39, s13, 163840
    v_mfma_f32_16x16x32_bf16 v[128:131], v[24:27], v[48:51], v[128:131]
    ds_read_b128 v[40:43], v87 offset:36864
    v_mfma_f32_16x16x32_bf16 v[148:151], v[28:31], v[48:51], v[148:151]
    ds_read_b128 v[44:47], v87 offset:38912
    s_add_u32 s39, s39, 2621440
    s_waitcnt lgkmcnt(10)
    v_mfma_f32_16x16x32_bf16 v[152:155], v[28:31], v[52:55], v[152:155]
    ds_read_b64_tr_b16 v[48:49], v6 offset:0
    s_sub_u32 s41, s39, s54
    v_mfma_f32_16x16x32_bf16 v[132:135], v[24:27], v[52:55], v[132:135]
    ds_read_b64_tr_b16 v[50:51], v6 offset:512
    v_mfma_f32_16x16x32_bf16 v[112:115], v[20:23], v[52:55], v[112:115]
    s_add_u32 s56, s28, s41
    v_mfma_f32_16x16x32_bf16 v[92:95], v[16:19], v[52:55], v[92:95]
    s_waitcnt lgkmcnt(10)
    v_mfma_f32_16x16x32_bf16 v[96:99], v[16:19], v[56:59], v[96:99]
    ds_read_b64_tr_b16 v[52:53], v7 offset:0
    s_addc_u32 s57, s29, 0
    v_mfma_f32_16x16x32_bf16 v[116:119], v[20:23], v[56:59], v[116:119]
    ds_read_b64_tr_b16 v[54:55], v7 offset:512
    s_add_u32 s58, s54, 163840
    v_mfma_f32_16x16x32_bf16 v[136:139], v[24:27], v[56:59], v[136:139]
    s_mov_b32 s59, 0x00020000
    v_mfma_f32_16x16x32_bf16 v[156:159], v[28:31], v[56:59], v[156:159]
    s_mul_i32 s52, s37, 40960
    s_waitcnt lgkmcnt(10)
    v_mfma_f32_16x16x32_bf16 v[160:163], v[28:31], v[60:63], v[160:163]
    ds_read_b64_tr_b16 v[56:57], v8 offset:0
    s_add_u32 s53, s52, 40960
    v_mfma_f32_16x16x32_bf16 v[140:143], v[24:27], v[60:63], v[140:143]
    ds_read_b64_tr_b16 v[58:59], v8 offset:512
    v_mfma_f32_16x16x32_bf16 v[120:123], v[20:23], v[60:63], v[120:123]
    s_and_b32 s40, s34, 5
    v_mfma_f32_16x16x32_bf16 v[100:103], v[16:19], v[60:63], v[100:103]
    s_waitcnt lgkmcnt(10)
    s_barrier
    v_mfma_f32_16x16x32_bf16 v[104:107], v[16:19], v[64:67], v[104:107]
    ds_read_b64_tr_b16 v[60:61], v9 offset:0
    v_mfma_f32_16x16x32_bf16 v[124:127], v[20:23], v[64:67], v[124:127]
    ds_read_b64_tr_b16 v[62:63], v9 offset:512
    s_mul_i32 s40, s40, 5120
    v_mfma_f32_16x16x32_bf16 v[144:147], v[24:27], v[64:67], v[144:147]
    v_mfma_f32_16x16x32_bf16 v[164:167], v[28:31], v[64:67], v[164:167]
    s_add_u32 s41, s40, s52
    ds_read_b64_tr_b16 v[64:65], v10 offset:0
    ds_read_b64_tr_b16 v[66:67], v10 offset:512
    s_waitcnt lgkmcnt(8)
    v_mfma_f32_16x16x32_bf16 v[88:91], v[32:35], v[48:51], v[88:91]
    ds_read_b128 v[16:19], v86 offset:0
    v_mfma_f32_16x16x32_bf16 v[108:111], v[36:39], v[48:51], v[108:111]
    ds_read_b128 v[20:23], v86 offset:2048
    s_add_u32 s42, s41, 5120
    v_mfma_f32_16x16x32_bf16 v[128:131], v[40:43], v[48:51], v[128:131]
    ds_read_b128 v[24:27], v86 offset:4096
    v_mfma_f32_16x16x32_bf16 v[148:151], v[44:47], v[48:51], v[148:151]
    ds_read_b128 v[28:31], v86 offset:6144
    s_cmp_eq_u32 s42, s53
    s_waitcnt lgkmcnt(10)
    v_mfma_f32_16x16x32_bf16 v[152:155], v[44:47], v[52:55], v[152:155]
    ds_read_b64_tr_b16 v[48:49], v6 offset:20480
    s_cselect_b32 s42, s52, s42
    v_mfma_f32_16x16x32_bf16 v[132:135], v[40:43], v[52:55], v[132:135]
    ds_read_b64_tr_b16 v[50:51], v6 offset:20992
    v_mfma_f32_16x16x32_bf16 v[112:115], v[36:39], v[52:55], v[112:115]
    s_add_u32 s52, s41, s39
    v_mfma_f32_16x16x32_bf16 v[92:95], v[32:35], v[52:55], v[92:95]
    s_waitcnt lgkmcnt(10)
    v_mfma_f32_16x16x32_bf16 v[96:99], v[32:35], v[56:59], v[96:99]
    ds_read_b64_tr_b16 v[52:53], v7 offset:20480
    s_add_u32 s53, s52, 4096
    v_mfma_f32_16x16x32_bf16 v[116:119], v[36:39], v[56:59], v[116:119]
    ds_read_b64_tr_b16 v[54:55], v7 offset:20992
    s_mul_i32 s44, s13, 81920
    v_mfma_f32_16x16x32_bf16 v[136:139], v[40:43], v[56:59], v[136:139]
    s_lshl_b32 s43, s34, 1
    v_mfma_f32_16x16x32_bf16 v[156:159], v[44:47], v[56:59], v[156:159]
    s_add_u32 s43, s43, s38
    s_waitcnt lgkmcnt(10)
    v_mfma_f32_16x16x32_bf16 v[160:163], v[44:47], v[60:63], v[160:163]
    ds_read_b64_tr_b16 v[56:57], v8 offset:20480
    s_mul_i32 s43, s43, 5120
    v_mfma_f32_16x16x32_bf16 v[140:143], v[40:43], v[60:63], v[140:143]
    ds_read_b64_tr_b16 v[58:59], v8 offset:20992
    v_mfma_f32_16x16x32_bf16 v[120:123], v[36:39], v[60:63], v[120:123]
    s_add_u32 s44, s44, s43
    v_mfma_f32_16x16x32_bf16 v[100:103], v[32:35], v[60:63], v[100:103]
    s_waitcnt lgkmcnt(10)
    s_barrier
    v_mfma_f32_16x16x32_bf16 v[104:107], v[32:35], v[64:67], v[104:107]
    ds_read_b64_tr_b16 v[60:61], v9 offset:20480
    v_mfma_f32_16x16x32_bf16 v[124:127], v[36:39], v[64:67], v[124:127]
    ds_read_b64_tr_b16 v[62:63], v9 offset:20992
    s_lshl_b32 s49, s36, 7
    v_mfma_f32_16x16x32_bf16 v[144:147], v[40:43], v[64:67], v[144:147]
    v_mfma_f32_16x16x32_bf16 v[164:167], v[44:47], v[64:67], v[164:167]
    s_add_u32 s49, s49, 159808
    ds_read_b64_tr_b16 v[64:65], v10 offset:20480
    ds_read_b64_tr_b16 v[66:67], v10 offset:20992
    s_waitcnt lgkmcnt(8)
    v_mfma_f32_16x16x32_bf16 v[88:91], v[16:19], v[48:51], v[88:91]
    ds_read_b128 v[32:35], v87 offset:0
    v_mfma_f32_16x16x32_bf16 v[108:111], v[20:23], v[48:51], v[108:111]
    ds_read_b128 v[36:39], v87 offset:2048
    s_cmp_eq_u32 s38, 0
    v_mfma_f32_16x16x32_bf16 v[128:131], v[24:27], v[48:51], v[128:131]
    ds_read_b128 v[40:43], v87 offset:4096
    v_mfma_f32_16x16x32_bf16 v[148:151], v[28:31], v[48:51], v[148:151]
    ds_read_b128 v[44:47], v87 offset:6144
    s_mov_b32 s35, 161028
    s_waitcnt lgkmcnt(10)
    v_mfma_f32_16x16x32_bf16 v[152:155], v[28:31], v[52:55], v[152:155]
    ds_read_b64_tr_b16 v[48:49], v6 offset:40960
    s_cselect_b32 s35, 4, s35
    v_mfma_f32_16x16x32_bf16 v[132:135], v[24:27], v[52:55], v[132:135]
    ds_read_b64_tr_b16 v[50:51], v6 offset:41472
    v_mfma_f32_16x16x32_bf16 v[112:115], v[20:23], v[52:55], v[112:115]
    s_cselect_b32 s26, 12, 4
    v_mfma_f32_16x16x32_bf16 v[92:95], v[16:19], v[52:55], v[92:95]
    s_waitcnt lgkmcnt(10)
    v_mfma_f32_16x16x32_bf16 v[96:99], v[16:19], v[56:59], v[96:99]
    ds_read_b64_tr_b16 v[52:53], v7 offset:40960
    s_mul_i32 s27, s38, 20480
    v_mfma_f32_16x16x32_bf16 v[116:119], v[20:23], v[56:59], v[116:119]
    ds_read_b64_tr_b16 v[54:55], v7 offset:41472
    s_add_u32 s27, s27, 64
    v_mfma_f32_16x16x32_bf16 v[136:139], v[24:27], v[56:59], v[136:139]
    s_lshl_b32 s55, s38, 2
    v_mfma_f32_16x16x32_bf16 v[156:159], v[28:31], v[56:59], v[156:159]
    s_add_u32 s55, s55, 161028
    s_waitcnt lgkmcnt(10)
    v_mfma_f32_16x16x32_bf16 v[160:163], v[28:31], v[60:63], v[160:163]
    ds_read_b64_tr_b16 v[56:57], v8 offset:40960
    s_lshl_b32 s11, s34, 2
    v_mfma_f32_16x16x32_bf16 v[140:143], v[24:27], v[60:63], v[140:143]
    ds_read_b64_tr_b16 v[58:59], v8 offset:41472
    v_mfma_f32_16x16x32_bf16 v[120:123], v[20:23], v[60:63], v[120:123]
    s_add_u32 s11, s11, s37
    v_mfma_f32_16x16x32_bf16 v[100:103], v[16:19], v[60:63], v[100:103]
    s_waitcnt lgkmcnt(10)
    s_barrier
    v_mfma_f32_16x16x32_bf16 v[104:107], v[16:19], v[64:67], v[104:107]
    ds_read_b64_tr_b16 v[60:61], v9 offset:40960
    v_mfma_f32_16x16x32_bf16 v[124:127], v[20:23], v[64:67], v[124:127]
    ds_read_b64_tr_b16 v[62:63], v9 offset:41472
    s_lshl_b32 s11, s11, 2
    v_mfma_f32_16x16x32_bf16 v[144:147], v[24:27], v[64:67], v[144:147]
    v_mfma_f32_16x16x32_bf16 v[164:167], v[28:31], v[64:67], v[164:167]
    s_lshr_b32 s12, s13, 3
    ds_read_b64_tr_b16 v[64:65], v10 offset:40960
    ds_read_b64_tr_b16 v[66:67], v10 offset:41472
    s_waitcnt lgkmcnt(8)
    v_mfma_f32_16x16x32_bf16 v[88:91], v[32:35], v[48:51], v[88:91]
    ds_read_b128 v[16:19], v86 offset:16384
    v_mfma_f32_16x16x32_bf16 v[108:111], v[36:39], v[48:51], v[108:111]
    ds_read_b128 v[20:23], v86 offset:18432
    s_add_u32 s11, s11, s12
    v_mfma_f32_16x16x32_bf16 v[128:131], v[40:43], v[48:51], v[128:131]
    ds_read_b128 v[24:27], v86 offset:20480
    v_mfma_f32_16x16x32_bf16 v[148:151], v[44:47], v[48:51], v[148:151]
    ds_read_b128 v[28:31], v86 offset:22528
    s_lshl_b32 s11, s11, 9
    s_waitcnt lgkmcnt(10)
    v_mfma_f32_16x16x32_bf16 v[152:155], v[44:47], v[52:55], v[152:155]
    ds_read_b64_tr_b16 v[48:49], v11 offset:0
    s_lshl_b32 s12, s38, 16
    v_mfma_f32_16x16x32_bf16 v[132:135], v[40:43], v[52:55], v[132:135]
    ds_read_b64_tr_b16 v[50:51], v11 offset:512
    v_mfma_f32_16x16x32_bf16 v[112:115], v[36:39], v[52:55], v[112:115]
    s_sub_u32 s11, s11, s12
    v_mfma_f32_16x16x32_bf16 v[92:95], v[32:35], v[52:55], v[92:95]
    s_waitcnt lgkmcnt(10)
    v_mfma_f32_16x16x32_bf16 v[96:99], v[32:35], v[56:59], v[96:99]
    ds_read_b64_tr_b16 v[52:53], v12 offset:0
    s_add_u32 s11, s11, 17891328
    v_mfma_f32_16x16x32_bf16 v[116:119], v[36:39], v[56:59], v[116:119]
    ds_read_b64_tr_b16 v[54:55], v12 offset:512
    s_and_b32 s12, s13, 6
    v_mfma_f32_16x16x32_bf16 v[136:139], v[40:43], v[56:59], v[136:139]
    s_lshl_b32 s12, 1, s12
    v_mfma_f32_16x16x32_bf16 v[156:159], v[44:47], v[56:59], v[156:159]
    s_add_u32 s12, s12, 256
    s_waitcnt lgkmcnt(10)
    v_mfma_f32_16x16x32_bf16 v[160:163], v[44:47], v[60:63], v[160:163]
    ds_read_b64_tr_b16 v[56:57], v13 offset:0
    s_xor_b32 s43, s37, 1
    v_mfma_f32_16x16x32_bf16 v[140:143], v[40:43], v[60:63], v[140:143]
    ds_read_b64_tr_b16 v[58:59], v13 offset:512
    v_mfma_f32_16x16x32_bf16 v[120:123], v[36:39], v[60:63], v[120:123]
    s_mul_i32 s39, s43, 1280
    v_mfma_f32_16x16x32_bf16 v[100:103], v[32:35], v[60:63], v[100:103]
    s_waitcnt lgkmcnt(10)
    s_barrier
    v_mfma_f32_16x16x32_bf16 v[104:107], v[32:35], v[64:67], v[104:107]
    ds_read_b64_tr_b16 v[60:61], v0 offset:0
    v_mfma_f32_16x16x32_bf16 v[124:127], v[36:39], v[64:67], v[124:127]
    ds_read_b64_tr_b16 v[62:63], v0 offset:512
    s_add_u32 s45, s39, s44
    v_mfma_f32_16x16x32_bf16 v[144:147], v[40:43], v[64:67], v[144:147]
    v_mfma_f32_16x16x32_bf16 v[164:167], v[44:47], v[64:67], v[164:167]
    s_mul_i32 s16, s43, 39936
    ds_read_b64_tr_b16 v[64:65], v5 offset:0
    ds_read_b64_tr_b16 v[66:67], v5 offset:512
    s_waitcnt lgkmcnt(8)
    v_mfma_f32_16x16x32_bf16 v[88:91], v[16:19], v[48:51], v[88:91]
    ds_read_b128 v[32:35], v87 offset:16384
    v_mfma_f32_16x16x32_bf16 v[108:111], v[20:23], v[48:51], v[108:111]
    ds_read_b128 v[36:39], v87 offset:18432
    s_xor_b32 s43, s37, 2
    v_mfma_f32_16x16x32_bf16 v[128:131], v[24:27], v[48:51], v[128:131]
    ds_read_b128 v[40:43], v87 offset:20480
    v_mfma_f32_16x16x32_bf16 v[148:151], v[28:31], v[48:51], v[148:151]
    ds_read_b128 v[44:47], v87 offset:22528
    s_mul_i32 s39, s43, 1280
    s_waitcnt lgkmcnt(10)
    v_mfma_f32_16x16x32_bf16 v[152:155], v[28:31], v[52:55], v[152:155]
    ds_read_b64_tr_b16 v[48:49], v11 offset:20480
    s_add_u32 s46, s39, s44
    v_mfma_f32_16x16x32_bf16 v[132:135], v[24:27], v[52:55], v[132:135]
    ds_read_b64_tr_b16 v[50:51], v11 offset:20992
    v_mfma_f32_16x16x32_bf16 v[112:115], v[20:23], v[52:55], v[112:115]
    s_mul_i32 s17, s43, 39936
    v_mfma_f32_16x16x32_bf16 v[92:95], v[16:19], v[52:55], v[92:95]
    s_waitcnt lgkmcnt(10)
    v_mfma_f32_16x16x32_bf16 v[96:99], v[16:19], v[56:59], v[96:99]
    ds_read_b64_tr_b16 v[52:53], v12 offset:20480
    s_xor_b32 s43, s37, 3
    v_mfma_f32_16x16x32_bf16 v[116:119], v[20:23], v[56:59], v[116:119]
    ds_read_b64_tr_b16 v[54:55], v12 offset:20992
    s_mul_i32 s39, s43, 1280
    v_mfma_f32_16x16x32_bf16 v[136:139], v[24:27], v[56:59], v[136:139]
    s_add_u32 s47, s39, s44
    v_mfma_f32_16x16x32_bf16 v[156:159], v[28:31], v[56:59], v[156:159]
    s_mul_i32 s18, s43, 39936
    s_waitcnt lgkmcnt(10)
    v_mfma_f32_16x16x32_bf16 v[160:163], v[28:31], v[60:63], v[160:163]
    ds_read_b64_tr_b16 v[56:57], v13 offset:20480
    s_xor_b32 s43, s37, 0
    v_mfma_f32_16x16x32_bf16 v[140:143], v[24:27], v[60:63], v[140:143]
    ds_read_b64_tr_b16 v[58:59], v13 offset:20992
    v_mfma_f32_16x16x32_bf16 v[120:123], v[20:23], v[60:63], v[120:123]
    s_mul_i32 s39, s43, 1280
    v_mfma_f32_16x16x32_bf16 v[100:103], v[16:19], v[60:63], v[100:103]
    s_waitcnt lgkmcnt(10)
    s_barrier
    v_mfma_f32_16x16x32_bf16 v[104:107], v[16:19], v[64:67], v[104:107]
    ds_read_b64_tr_b16 v[60:61], v0 offset:20480
    v_mfma_f32_16x16x32_bf16 v[124:127], v[20:23], v[64:67], v[124:127]
    ds_read_b64_tr_b16 v[62:63], v0 offset:20992
    s_add_u32 s48, s39, s44
    v_mfma_f32_16x16x32_bf16 v[144:147], v[24:27], v[64:67], v[144:147]
    v_mfma_f32_16x16x32_bf16 v[164:167], v[28:31], v[64:67], v[164:167]
    s_mul_i32 s19, s43, 39936
    ds_read_b64_tr_b16 v[64:65], v5 offset:20480
    ds_read_b64_tr_b16 v[66:67], v5 offset:20992
    s_waitcnt lgkmcnt(8)
    v_mfma_f32_16x16x32_bf16 v[88:91], v[32:35], v[48:51], v[88:91]
    ds_read_b128 v[16:19], v86 offset:32768
    v_mfma_f32_16x16x32_bf16 v[108:111], v[36:39], v[48:51], v[108:111]
    ds_read_b128 v[20:23], v86 offset:34816
    s_waitcnt vmcnt(0)
    v_mfma_f32_16x16x32_bf16 v[128:131], v[40:43], v[48:51], v[128:131]
    ds_read_b128 v[24:27], v86 offset:36864
    v_mfma_f32_16x16x32_bf16 v[148:151], v[44:47], v[48:51], v[148:151]
    ds_read_b128 v[28:31], v86 offset:38912
    v_lshlrev_b32 v2, 4, v1
    s_waitcnt lgkmcnt(10)
    v_mfma_f32_16x16x32_bf16 v[152:155], v[44:47], v[52:55], v[152:155]
    ds_read_b64_tr_b16 v[48:49], v6 offset:0
    v_and_b32 v70, 31, v1
    v_mfma_f32_16x16x32_bf16 v[132:135], v[40:43], v[52:55], v[132:135]
    ds_read_b64_tr_b16 v[50:51], v6 offset:512
    v_mfma_f32_16x16x32_bf16 v[112:115], v[36:39], v[52:55], v[112:115]
    v_lshrrev_b32 v71, 5, v1
    v_mfma_f32_16x16x32_bf16 v[92:95], v[32:35], v[52:55], v[92:95]
    s_waitcnt lgkmcnt(10)
    v_mfma_f32_16x16x32_bf16 v[96:99], v[32:35], v[56:59], v[96:99]
    ds_read_b64_tr_b16 v[52:53], v7 offset:0
    v_lshrrev_b32 v4, 2, v70
    v_mfma_f32_16x16x32_bf16 v[116:119], v[36:39], v[56:59], v[116:119]
    ds_read_b64_tr_b16 v[54:55], v7 offset:512
    v_lshl_add_u32 v4, v4, 8, s54
    v_mfma_f32_16x16x32_bf16 v[136:139], v[40:43], v[56:59], v[136:139]
    v_lshl_add_u32 v4, v71, 6, v4
    v_mfma_f32_16x16x32_bf16 v[156:159], v[44:47], v[56:59], v[156:159]
    v_and_b32 v72, 3, v70
    s_waitcnt lgkmcnt(10)
    v_mfma_f32_16x16x32_bf16 v[160:163], v[44:47], v[60:63], v[160:163]
    ds_read_b64_tr_b16 v[56:57], v8 offset:0
    v_lshl_add_u32 v4, v72, 4, v4
    v_mfma_f32_16x16x32_bf16 v[140:143], v[40:43], v[60:63], v[140:143]
    ds_read_b64_tr_b16 v[58:59], v8 offset:512
    v_mfma_f32_16x16x32_bf16 v[120:123], v[36:39], v[60:63], v[120:123]
    v_lshrrev_b32 v73, 3, v70
    v_mfma_f32_16x16x32_bf16 v[100:103], v[32:35], v[60:63], v[100:103]
    s_waitcnt lgkmcnt(10)
    s_barrier
    v_mfma_f32_16x16x32_bf16 v[104:107], v[32:35], v[64:67], v[104:107]
    ds_read_b64_tr_b16 v[60:61], v9 offset:0
    v_mfma_f32_16x16x32_bf16 v[124:127], v[36:39], v[64:67], v[124:127]
    ds_read_b64_tr_b16 v[62:63], v9 offset:512
    v_lshl_add_u32 v72, v73, 2, v72
    v_mfma_f32_16x16x32_bf16 v[144:147], v[40:43], v[64:67], v[144:147]
    v_mfma_f32_16x16x32_bf16 v[164:167], v[44:47], v[64:67], v[164:167]
    v_lshl_add_u32 v72, v72, 4, s54
    ds_read_b64_tr_b16 v[64:65], v10 offset:0
    ds_read_b64_tr_b16 v[66:67], v10 offset:512
    s_waitcnt lgkmcnt(8)
    v_mfma_f32_16x16x32_bf16 v[88:91], v[16:19], v[48:51], v[88:91]
    ds_read_b128 v[32:35], v87 offset:32768
    v_mfma_f32_16x16x32_bf16 v[108:111], v[20:23], v[48:51], v[108:111]
    ds_read_b128 v[36:39], v87 offset:34816
    v_lshrrev_b32 v73, 4, v70
    v_mfma_f32_16x16x32_bf16 v[128:131], v[24:27], v[48:51], v[128:131]
    ds_read_b128 v[40:43], v87 offset:36864
    v_mfma_f32_16x16x32_bf16 v[148:151], v[28:31], v[48:51], v[148:151]
    ds_read_b128 v[44:47], v87 offset:38912
    v_bfe_u32 v74, v70, 2, 1
    s_waitcnt lgkmcnt(10)
    v_mfma_f32_16x16x32_bf16 v[152:155], v[28:31], v[52:55], v[152:155]
    ds_read_b64_tr_b16 v[48:49], v6 offset:20480
    v_lshl_add_u32 v3, v74, 3, v72
    v_mfma_f32_16x16x32_bf16 v[132:135], v[24:27], v[52:55], v[132:135]
    ds_read_b64_tr_b16 v[50:51], v6 offset:20992
    v_mfma_f32_16x16x32_bf16 v[112:115], v[20:23], v[52:55], v[112:115]
    v_lshl_add_u32 v14, v74, 8, v72
    v_mfma_f32_16x16x32_bf16 v[92:95], v[16:19], v[52:55], v[92:95]
    s_waitcnt lgkmcnt(10)
    v_mfma_f32_16x16x32_bf16 v[96:99], v[16:19], v[56:59], v[96:99]
    ds_read_b64_tr_b16 v[52:53], v7 offset:20480
    v_lshl_add_u32 v14, v71, 9, v14
    v_mfma_f32_16x16x32_bf16 v[116:119], v[20:23], v[56:59], v[116:119]
    ds_read_b64_tr_b16 v[54:55], v7 offset:20992
    v_and_b32 v15, 15, v70
    v_mfma_f32_16x16x32_bf16 v[136:139], v[24:27], v[56:59], v[136:139]
    v_lshlrev_b32 v15, 4, v15
    v_mfma_f32_16x16x32_bf16 v[156:159], v[28:31], v[56:59], v[156:159]
    v_lshl_add_u32 v15, v73, 3, v15
    s_waitcnt lgkmcnt(10)
    v_mfma_f32_16x16x32_bf16 v[160:163], v[28:31], v[60:63], v[160:163]
    ds_read_b64_tr_b16 v[56:57], v8 offset:20480
    v_mfma_f32_16x16x32_bf16 v[140:143], v[24:27], v[60:63], v[140:143]
    ds_read_b64_tr_b16 v[58:59], v8 offset:20992
    v_mfma_f32_16x16x32_bf16 v[120:123], v[20:23], v[60:63], v[120:123]
    v_mfma_f32_16x16x32_bf16 v[100:103], v[16:19], v[60:63], v[100:103]
    s_waitcnt lgkmcnt(10)
    s_barrier
    v_mfma_f32_16x16x32_bf16 v[104:107], v[16:19], v[64:67], v[104:107]
    ds_read_b64_tr_b16 v[60:61], v9 offset:20480
    v_mfma_f32_16x16x32_bf16 v[124:127], v[20:23], v[64:67], v[124:127]
    ds_read_b64_tr_b16 v[62:63], v9 offset:20992
    v_mfma_f32_16x16x32_bf16 v[144:147], v[24:27], v[64:67], v[144:147]
    v_mfma_f32_16x16x32_bf16 v[164:167], v[28:31], v[64:67], v[164:167]
    ds_read_b64_tr_b16 v[64:65], v10 offset:20480
    ds_read_b64_tr_b16 v[66:67], v10 offset:20992
    s_waitcnt lgkmcnt(8)
    v_mfma_f32_16x16x32_bf16 v[88:91], v[32:35], v[48:51], v[88:91]
    ds_read_b128 v[16:19], v86 offset:0
    v_mfma_f32_16x16x32_bf16 v[108:111], v[36:39], v[48:51], v[108:111]
    ds_read_b128 v[20:23], v86 offset:2048
    v_mfma_f32_16x16x32_bf16 v[128:131], v[40:43], v[48:51], v[128:131]
    ds_read_b128 v[24:27], v86 offset:4096
    v_mfma_f32_16x16x32_bf16 v[148:151], v[44:47], v[48:51], v[148:151]
    ds_read_b128 v[28:31], v86 offset:6144
    s_waitcnt lgkmcnt(10)
    v_mfma_f32_16x16x32_bf16 v[152:155], v[44:47], v[52:55], v[152:155]
    ds_read_b64_tr_b16 v[48:49], v6 offset:40960
    v_mfma_f32_16x16x32_bf16 v[132:135], v[40:43], v[52:55], v[132:135]
    ds_read_b64_tr_b16 v[50:51], v6 offset:41472
    v_mfma_f32_16x16x32_bf16 v[112:115], v[36:39], v[52:55], v[112:115]
    v_mfma_f32_16x16x32_bf16 v[92:95], v[32:35], v[52:55], v[92:95]
    s_waitcnt lgkmcnt(10)
    v_mfma_f32_16x16x32_bf16 v[96:99], v[32:35], v[56:59], v[96:99]
    ds_read_b64_tr_b16 v[52:53], v7 offset:40960
    v_mfma_f32_16x16x32_bf16 v[116:119], v[36:39], v[56:59], v[116:119]
    ds_read_b64_tr_b16 v[54:55], v7 offset:41472
    v_mfma_f32_16x16x32_bf16 v[136:139], v[40:43], v[56:59], v[136:139]
    v_mfma_f32_16x16x32_bf16 v[156:159], v[44:47], v[56:59], v[156:159]
    s_waitcnt lgkmcnt(10)
    v_mfma_f32_16x16x32_bf16 v[160:163], v[44:47], v[60:63], v[160:163]
    ds_read_b64_tr_b16 v[56:57], v8 offset:40960
    v_mfma_f32_16x16x32_bf16 v[140:143], v[40:43], v[60:63], v[140:143]
    ds_read_b64_tr_b16 v[58:59], v8 offset:41472
    v_mfma_f32_16x16x32_bf16 v[120:123], v[36:39], v[60:63], v[120:123]
    v_mfma_f32_16x16x32_bf16 v[100:103], v[32:35], v[60:63], v[100:103]
    s_waitcnt lgkmcnt(10)
    s_barrier
    v_mfma_f32_16x16x32_bf16 v[104:107], v[32:35], v[64:67], v[104:107]
    ds_read_b64_tr_b16 v[60:61], v9 offset:40960
    v_mfma_f32_16x16x32_bf16 v[124:127], v[36:39], v[64:67], v[124:127]
    ds_read_b64_tr_b16 v[62:63], v9 offset:41472
    v_mfma_f32_16x16x32_bf16 v[144:147], v[40:43], v[64:67], v[144:147]
    v_mfma_f32_16x16x32_bf16 v[164:167], v[44:47], v[64:67], v[164:167]
    ds_read_b64_tr_b16 v[64:65], v10 offset:40960
    ds_read_b64_tr_b16 v[66:67], v10 offset:41472
    s_waitcnt lgkmcnt(8)
    v_mfma_f32_16x16x32_bf16 v[88:91], v[16:19], v[48:51], v[88:91]
    ds_read_b128 v[32:35], v87 offset:0
    v_mfma_f32_16x16x32_bf16 v[108:111], v[20:23], v[48:51], v[108:111]
    ds_read_b128 v[36:39], v87 offset:2048
    v_mfma_f32_16x16x32_bf16 v[128:131], v[24:27], v[48:51], v[128:131]
    ds_read_b128 v[40:43], v87 offset:4096
    v_mfma_f32_16x16x32_bf16 v[148:151], v[28:31], v[48:51], v[148:151]
    ds_read_b128 v[44:47], v87 offset:6144
    s_waitcnt lgkmcnt(10)
    v_mfma_f32_16x16x32_bf16 v[152:155], v[28:31], v[52:55], v[152:155]
    ds_read_b64_tr_b16 v[48:49], v11 offset:0
    v_mfma_f32_16x16x32_bf16 v[132:135], v[24:27], v[52:55], v[132:135]
    ds_read_b64_tr_b16 v[50:51], v11 offset:512
    v_mfma_f32_16x16x32_bf16 v[112:115], v[20:23], v[52:55], v[112:115]
    v_mfma_f32_16x16x32_bf16 v[92:95], v[16:19], v[52:55], v[92:95]
    s_waitcnt lgkmcnt(10)
    v_mfma_f32_16x16x32_bf16 v[96:99], v[16:19], v[56:59], v[96:99]
    ds_read_b64_tr_b16 v[52:53], v12 offset:0
    v_mfma_f32_16x16x32_bf16 v[116:119], v[20:23], v[56:59], v[116:119]
    ds_read_b64_tr_b16 v[54:55], v12 offset:512
    v_mfma_f32_16x16x32_bf16 v[136:139], v[24:27], v[56:59], v[136:139]
    v_mfma_f32_16x16x32_bf16 v[156:159], v[28:31], v[56:59], v[156:159]
    s_waitcnt lgkmcnt(10)
    v_mfma_f32_16x16x32_bf16 v[160:163], v[28:31], v[60:63], v[160:163]
    ds_read_b64_tr_b16 v[56:57], v13 offset:0
    v_mfma_f32_16x16x32_bf16 v[140:143], v[24:27], v[60:63], v[140:143]
    ds_read_b64_tr_b16 v[58:59], v13 offset:512
    v_mfma_f32_16x16x32_bf16 v[120:123], v[20:23], v[60:63], v[120:123]
    v_mfma_f32_16x16x32_bf16 v[100:103], v[16:19], v[60:63], v[100:103]
    s_waitcnt lgkmcnt(10)
    s_barrier
    v_mfma_f32_16x16x32_bf16 v[104:107], v[16:19], v[64:67], v[104:107]
    ds_read_b64_tr_b16 v[60:61], v0 offset:0
    v_mfma_f32_16x16x32_bf16 v[124:127], v[20:23], v[64:67], v[124:127]
    ds_read_b64_tr_b16 v[62:63], v0 offset:512
    v_mfma_f32_16x16x32_bf16 v[144:147], v[24:27], v[64:67], v[144:147]
    v_mfma_f32_16x16x32_bf16 v[164:167], v[28:31], v[64:67], v[164:167]
    ds_read_b64_tr_b16 v[64:65], v5 offset:0
    ds_read_b64_tr_b16 v[66:67], v5 offset:512
    s_waitcnt lgkmcnt(8)
    v_mfma_f32_16x16x32_bf16 v[88:91], v[32:35], v[48:51], v[88:91]
    ds_read_b128 v[16:19], v86 offset:16384
    v_mfma_f32_16x16x32_bf16 v[108:111], v[36:39], v[48:51], v[108:111]
    ds_read_b128 v[20:23], v86 offset:18432
    v_mfma_f32_16x16x32_bf16 v[128:131], v[40:43], v[48:51], v[128:131]
    ds_read_b128 v[24:27], v86 offset:20480
    v_mfma_f32_16x16x32_bf16 v[148:151], v[44:47], v[48:51], v[148:151]
    ds_read_b128 v[28:31], v86 offset:22528
    s_waitcnt lgkmcnt(10)
    v_mfma_f32_16x16x32_bf16 v[152:155], v[44:47], v[52:55], v[152:155]
    ds_read_b64_tr_b16 v[48:49], v11 offset:20480
    v_mfma_f32_16x16x32_bf16 v[132:135], v[40:43], v[52:55], v[132:135]
    ds_read_b64_tr_b16 v[50:51], v11 offset:20992
    v_mfma_f32_16x16x32_bf16 v[112:115], v[36:39], v[52:55], v[112:115]
    v_mfma_f32_16x16x32_bf16 v[92:95], v[32:35], v[52:55], v[92:95]
    s_waitcnt lgkmcnt(10)
    v_mfma_f32_16x16x32_bf16 v[96:99], v[32:35], v[56:59], v[96:99]
    ds_read_b64_tr_b16 v[52:53], v12 offset:20480
    v_mfma_f32_16x16x32_bf16 v[116:119], v[36:39], v[56:59], v[116:119]
    ds_read_b64_tr_b16 v[54:55], v12 offset:20992
    v_mfma_f32_16x16x32_bf16 v[136:139], v[40:43], v[56:59], v[136:139]
    v_mfma_f32_16x16x32_bf16 v[156:159], v[44:47], v[56:59], v[156:159]
    s_waitcnt lgkmcnt(10)
    v_mfma_f32_16x16x32_bf16 v[160:163], v[44:47], v[60:63], v[160:163]
    ds_read_b64_tr_b16 v[56:57], v13 offset:20480
    v_mfma_f32_16x16x32_bf16 v[140:143], v[40:43], v[60:63], v[140:143]
    ds_read_b64_tr_b16 v[58:59], v13 offset:20992
    v_mfma_f32_16x16x32_bf16 v[120:123], v[36:39], v[60:63], v[120:123]
    v_mfma_f32_16x16x32_bf16 v[100:103], v[32:35], v[60:63], v[100:103]
    s_waitcnt lgkmcnt(10)
    s_barrier
    v_mfma_f32_16x16x32_bf16 v[104:107], v[32:35], v[64:67], v[104:107]
    ds_read_b64_tr_b16 v[60:61], v0 offset:20480
    v_mfma_f32_16x16x32_bf16 v[124:127], v[36:39], v[64:67], v[124:127]
    ds_read_b64_tr_b16 v[62:63], v0 offset:20992
    v_mfma_f32_16x16x32_bf16 v[144:147], v[40:43], v[64:67], v[144:147]
    v_mfma_f32_16x16x32_bf16 v[164:167], v[44:47], v[64:67], v[164:167]
    ds_read_b64_tr_b16 v[64:65], v5 offset:20480
    ds_read_b64_tr_b16 v[66:67], v5 offset:20992
    s_waitcnt lgkmcnt(8)
    v_mfma_f32_16x16x32_bf16 v[88:91], v[16:19], v[48:51], v[88:91]
    ds_read_b128 v[32:35], v87 offset:16384
    v_mfma_f32_16x16x32_bf16 v[108:111], v[20:23], v[48:51], v[108:111]
    ds_read_b128 v[36:39], v87 offset:18432
    v_mfma_f32_16x16x32_bf16 v[128:131], v[24:27], v[48:51], v[128:131]
    ds_read_b128 v[40:43], v87 offset:20480
    v_mfma_f32_16x16x32_bf16 v[148:151], v[28:31], v[48:51], v[148:151]
    ds_read_b128 v[44:47], v87 offset:22528
    s_waitcnt lgkmcnt(10)
    v_mfma_f32_16x16x32_bf16 v[152:155], v[28:31], v[52:55], v[152:155]
    ds_read_b64_tr_b16 v[48:49], v6 offset:0
    v_mfma_f32_16x16x32_bf16 v[132:135], v[24:27], v[52:55], v[132:135]
    ds_read_b64_tr_b16 v[50:51], v6 offset:512
    v_mfma_f32_16x16x32_bf16 v[112:115], v[20:23], v[52:55], v[112:115]
    v_mfma_f32_16x16x32_bf16 v[92:95], v[16:19], v[52:55], v[92:95]
    s_waitcnt lgkmcnt(10)
    v_mfma_f32_16x16x32_bf16 v[96:99], v[16:19], v[56:59], v[96:99]
    ds_read_b64_tr_b16 v[52:53], v7 offset:0
    v_mfma_f32_16x16x32_bf16 v[116:119], v[20:23], v[56:59], v[116:119]
    ds_read_b64_tr_b16 v[54:55], v7 offset:512
    v_mfma_f32_16x16x32_bf16 v[136:139], v[24:27], v[56:59], v[136:139]
    v_mfma_f32_16x16x32_bf16 v[156:159], v[28:31], v[56:59], v[156:159]
    s_waitcnt lgkmcnt(10)
    v_mfma_f32_16x16x32_bf16 v[160:163], v[28:31], v[60:63], v[160:163]
    ds_read_b64_tr_b16 v[56:57], v8 offset:0
    v_mfma_f32_16x16x32_bf16 v[140:143], v[24:27], v[60:63], v[140:143]
    ds_read_b64_tr_b16 v[58:59], v8 offset:512
    v_mfma_f32_16x16x32_bf16 v[120:123], v[20:23], v[60:63], v[120:123]
    v_mfma_f32_16x16x32_bf16 v[100:103], v[16:19], v[60:63], v[100:103]
    s_waitcnt lgkmcnt(10)
    s_branch L_sk_3853
L_pad_mv_2:
    s_branch L_k1_c_qkv
L_sk_3853:
    s_barrier
    v_mfma_f32_16x16x32_bf16 v[104:107], v[16:19], v[64:67], v[104:107]
    ds_read_b64_tr_b16 v[60:61], v9 offset:0
    v_mfma_f32_16x16x32_bf16 v[124:127], v[20:23], v[64:67], v[124:127]
    ds_read_b64_tr_b16 v[62:63], v9 offset:512
    v_mfma_f32_16x16x32_bf16 v[144:147], v[24:27], v[64:67], v[144:147]
    v_mfma_f32_16x16x32_bf16 v[164:167], v[28:31], v[64:67], v[164:167]
    ds_read_b64_tr_b16 v[64:65], v10 offset:0
    ds_read_b64_tr_b16 v[66:67], v10 offset:512
    s_waitcnt lgkmcnt(8)
    v_mfma_f32_16x16x32_bf16 v[88:91], v[32:35], v[48:51], v[88:91]
    ds_read_b128 v[16:19], v86 offset:32768
    v_mfma_f32_16x16x32_bf16 v[108:111], v[36:39], v[48:51], v[108:111]
    ds_read_b128 v[20:23], v86 offset:34816
    v_mfma_f32_16x16x32_bf16 v[128:131], v[40:43], v[48:51], v[128:131]
    ds_read_b128 v[24:27], v86 offset:36864
    v_mfma_f32_16x16x32_bf16 v[148:151], v[44:47], v[48:51], v[148:151]
    ds_read_b128 v[28:31], v86 offset:38912
    s_waitcnt lgkmcnt(10)
    v_mfma_f32_16x16x32_bf16 v[152:155], v[44:47], v[52:55], v[152:155]
    ds_read_b64_tr_b16 v[48:49], v6 offset:20480
    v_mfma_f32_16x16x32_bf16 v[132:135], v[40:43], v[52:55], v[132:135]
    ds_read_b64_tr_b16 v[50:51], v6 offset:20992
    v_mfma_f32_16x16x32_bf16 v[112:115], v[36:39], v[52:55], v[112:115]
    v_mfma_f32_16x16x32_bf16 v[92:95], v[32:35], v[52:55], v[92:95]
    s_waitcnt lgkmcnt(10)
    v_mfma_f32_16x16x32_bf16 v[96:99], v[32:35], v[56:59], v[96:99]
    ds_read_b64_tr_b16 v[52:53], v7 offset:20480
    v_mfma_f32_16x16x32_bf16 v[116:119], v[36:39], v[56:59], v[116:119]
    ds_read_b64_tr_b16 v[54:55], v7 offset:20992
    v_mfma_f32_16x16x32_bf16 v[136:139], v[40:43], v[56:59], v[136:139]
    v_mfma_f32_16x16x32_bf16 v[156:159], v[44:47], v[56:59], v[156:159]
    s_waitcnt lgkmcnt(10)
    v_mfma_f32_16x16x32_bf16 v[160:163], v[44:47], v[60:63], v[160:163]
    ds_read_b64_tr_b16 v[56:57], v8 offset:20480
    v_mfma_f32_16x16x32_bf16 v[140:143], v[40:43], v[60:63], v[140:143]
    ds_read_b64_tr_b16 v[58:59], v8 offset:20992
    v_mfma_f32_16x16x32_bf16 v[120:123], v[36:39], v[60:63], v[120:123]
    v_mfma_f32_16x16x32_bf16 v[100:103], v[32:35], v[60:63], v[100:103]
    s_waitcnt lgkmcnt(10)
    s_barrier
    v_mfma_f32_16x16x32_bf16 v[104:107], v[32:35], v[64:67], v[104:107]
    ds_read_b64_tr_b16 v[60:61], v9 offset:20480
    v_mfma_f32_16x16x32_bf16 v[124:127], v[36:39], v[64:67], v[124:127]
    ds_read_b64_tr_b16 v[62:63], v9 offset:20992
    v_mfma_f32_16x16x32_bf16 v[144:147], v[40:43], v[64:67], v[144:147]
    v_mfma_f32_16x16x32_bf16 v[164:167], v[44:47], v[64:67], v[164:167]
    ds_read_b64_tr_b16 v[64:65], v10 offset:20480
    ds_read_b64_tr_b16 v[66:67], v10 offset:20992
    s_branch L_sk_3906
L_gp_4:
    s_branch L_k1_c_qkv
L_sk_3906:
    s_setprio 1
    s_waitcnt lgkmcnt(8)
    v_mfma_f32_16x16x32_bf16 v[88:91], v[16:19], v[48:51], v[88:91]
    ds_read_b64_tr_b16 v[32:33], v6 offset:40960
    ds_read_b64_tr_b16 v[34:35], v6 offset:41472
    s_mul_i32 s64, s64, 163840
    s_mul_i32 s66, s66, 2560
    s_add_u32 s64, s64, s66
    s_add_u32 s64, s64, 2621440
    s_add_u32 s65, s64, 10240
    v_lshrrev_b32 v1, 2, v68
    v_mul_u32_u24 v1, 163840, v1
    v_lshl_add_u32 v1, v69, 6, v1
    v_mfma_f32_16x16x32_bf16 v[108:111], v[20:23], v[48:51], v[108:111]
    ds_read_b128 v[36:39], v87 offset:32768
    ds_read_b128 v[40:43], v87 offset:34816
    v_and_b32 v68, 3, v68
    v_lshl_add_u32 v68, v68, 4, v1
    v_mov_b32 v69, 161044
    s_waitcnt lgkmcnt(10)
    v_mfma_f32_16x16x32_bf16 v[112:115], v[20:23], v[52:55], v[112:115]
    ds_read_b64_tr_b16 v[44:45], v7 offset:40960
    ds_read_b64_tr_b16 v[46:47], v7 offset:41472
    v_mfma_f32_16x16x32_bf16 v[92:95], v[16:19], v[52:55], v[92:95]
    ds_read_b64_tr_b16 v[70:71], v8 offset:40960
    s_waitcnt lgkmcnt(11)
    v_mfma_f32_16x16x32_bf16 v[96:99], v[16:19], v[56:59], v[96:99]
    ds_read_b64_tr_b16 v[72:73], v8 offset:41472
    ds_read_b64_tr_b16 v[74:75], v9 offset:40960
    v_mfma_f32_16x16x32_bf16 v[116:119], v[20:23], v[56:59], v[116:119]
    s_waitcnt lgkmcnt(11)
    s_barrier
    v_mfma_f32_16x16x32_bf16 v[120:123], v[20:23], v[60:63], v[120:123]
    ds_read_b64_tr_b16 v[76:77], v9 offset:41472
    ds_read_b64_tr_b16 v[78:79], v10 offset:40960
    v_mfma_f32_16x16x32_bf16 v[100:103], v[16:19], v[60:63], v[100:103]
    s_waitcnt lgkmcnt(11)
    v_mfma_f32_16x16x32_bf16 v[104:107], v[16:19], v[64:67], v[104:107]
    ds_read_b64_tr_b16 v[80:81], v10 offset:41472
    ds_read_b64_tr_b16 v[82:83], v12 offset:0
    v_mfma_f32_16x16x32_bf16 v[124:127], v[20:23], v[64:67], v[124:127]
    s_waitcnt lgkmcnt(10)
    v_mfma_f32_16x16x32_bf16 v[88:91], v[36:39], v[32:35], v[88:91]
    ds_read_b64_tr_b16 v[84:85], v12 offset:512
    ds_read_b128 v[48:51], v86 offset:0
    s_waitcnt lgkmcnt(11)
    v_mfma_f32_16x16x32_bf16 v[108:111], v[40:43], v[32:35], v[108:111]
    ds_read_b64_tr_b16 v[52:53], v13 offset:0
    ds_read_b64_tr_b16 v[54:55], v13 offset:512
    s_waitcnt lgkmcnt(11)
    s_barrier
    v_mfma_f32_16x16x32_bf16 v[112:115], v[40:43], v[44:47], v[112:115]
    ds_read_b64_tr_b16 v[56:57], v0 offset:0
    ds_read_b64_tr_b16 v[58:59], v0 offset:512
    v_mfma_f32_16x16x32_bf16 v[92:95], v[36:39], v[44:47], v[92:95]
    s_waitcnt lgkmcnt(11)
    v_mfma_f32_16x16x32_bf16 v[96:99], v[36:39], v[70:73], v[96:99]
    ds_read_b64_tr_b16 v[60:61], v5 offset:0
    ds_read_b64_tr_b16 v[62:63], v5 offset:512
    v_mfma_f32_16x16x32_bf16 v[116:119], v[40:43], v[70:73], v[116:119]
    s_waitcnt lgkmcnt(11)
    v_mfma_f32_16x16x32_bf16 v[120:123], v[40:43], v[74:77], v[120:123]
    ds_read_b64_tr_b16 v[16:17], v11 offset:0
    ds_read_b64_tr_b16 v[18:19], v11 offset:512
    v_mfma_f32_16x16x32_bf16 v[100:103], v[36:39], v[74:77], v[100:103]
    s_waitcnt lgkmcnt(11)
    v_mfma_f32_16x16x32_bf16 v[104:107], v[36:39], v[78:81], v[104:107]
    ds_read_b64_tr_b16 v[64:65], v12 offset:20480
    ds_read_b64_tr_b16 v[66:67], v12 offset:20992
    v_mfma_f32_16x16x32_bf16 v[124:127], v[40:43], v[78:81], v[124:127]
    s_waitcnt lgkmcnt(10)
    v_mfma_f32_16x16x32_bf16 v[92:95], v[48:51], v[82:85], v[92:95]
    ds_read_b128 v[20:23], v87 offset:0
    ds_read_b64_tr_b16 v[32:33], v13 offset:20480
    s_waitcnt lgkmcnt(10)
    v_mfma_f32_16x16x32_bf16 v[96:99], v[48:51], v[52:55], v[96:99]
    ds_read_b64_tr_b16 v[34:35], v13 offset:20992
    ds_read_b64_tr_b16 v[44:45], v0 offset:20480
    s_waitcnt lgkmcnt(10)
    v_mfma_f32_16x16x32_bf16 v[100:103], v[48:51], v[56:59], v[100:103]
    ds_read_b64_tr_b16 v[46:47], v0 offset:20992
    ds_read_b64_tr_b16 v[70:71], v5 offset:20480
    s_waitcnt lgkmcnt(10)
    v_mfma_f32_16x16x32_bf16 v[104:107], v[48:51], v[60:63], v[104:107]
    ds_read_b64_tr_b16 v[72:73], v5 offset:20992
    ds_read_b64_tr_b16 v[74:75], v11 offset:20480
    s_waitcnt lgkmcnt(10)
    v_mfma_f32_16x16x32_bf16 v[88:91], v[48:51], v[16:19], v[88:91]
    ds_read_b64_tr_b16 v[76:77], v11 offset:20992
    ds_read_b128 v[36:39], v86 offset:2048
    s_waitcnt lgkmcnt(9)
    v_mfma_f32_16x16x32_bf16 v[92:95], v[20:23], v[64:67], v[92:95]
    ds_read_b128 v[78:81], v87 offset:2048
    ds_read_b128 v[40:43], v86 offset:4096
    s_waitcnt lgkmcnt(9)
    v_mfma_f32_16x16x32_bf16 v[96:99], v[20:23], v[32:35], v[96:99]
    ds_read_b128 v[48:51], v86 offset:6144
    s_waitcnt lgkmcnt(8)
    v_mfma_f32_16x16x32_bf16 v[100:103], v[20:23], v[44:47], v[100:103]
    s_waitcnt lgkmcnt(6)
    v_mfma_f32_16x16x32_bf16 v[104:107], v[20:23], v[70:73], v[104:107]
    s_waitcnt lgkmcnt(4)
    v_mfma_f32_16x16x32_bf16 v[88:91], v[20:23], v[74:77], v[88:91]
    ds_read_b128 v[20:23], v87 offset:4096
    s_waitcnt lgkmcnt(4)
    v_mfma_f32_16x16x32_bf16 v[112:115], v[36:39], v[82:85], v[112:115]
    v_mfma_f32_16x16x32_bf16 v[116:119], v[36:39], v[52:55], v[116:119]
    v_cvt_pk_bf16_f32 v92, v92, v93
    v_cvt_pk_bf16_f32 v93, v94, v95
    v_cvt_pk_bf16_f32 v96, v96, v97
    v_mfma_f32_16x16x32_bf16 v[120:123], v[36:39], v[56:59], v[120:123]
    v_cvt_pk_bf16_f32 v97, v98, v99
    v_cvt_pk_bf16_f32 v100, v100, v101
    v_cvt_pk_bf16_f32 v101, v102, v103
    v_mfma_f32_16x16x32_bf16 v[124:127], v[36:39], v[60:63], v[124:127]
    v_cvt_pk_bf16_f32 v104, v104, v105
    v_cvt_pk_bf16_f32 v105, v106, v107
    v_cvt_pk_bf16_f32 v88, v88, v89
    v_mfma_f32_16x16x32_bf16 v[108:111], v[36:39], v[16:19], v[108:111]
    ds_read_b128 v[36:39], v87 offset:6144
    v_cvt_pk_bf16_f32 v89, v90, v91
    s_waitcnt lgkmcnt(4)
    v_mfma_f32_16x16x32_bf16 v[112:115], v[78:81], v[64:67], v[112:115]
    v_mfma_f32_16x16x32_bf16 v[116:119], v[78:81], v[32:35], v[116:119]
    v_mfma_f32_16x16x32_bf16 v[120:123], v[78:81], v[44:47], v[120:123]
    v_mfma_f32_16x16x32_bf16 v[124:127], v[78:81], v[70:73], v[124:127]
    v_mfma_f32_16x16x32_bf16 v[108:111], v[78:81], v[74:77], v[108:111]
    ds_read_b64_tr_b16 v[78:79], v7 offset:20480
    ds_read_b64_tr_b16 v[80:81], v7 offset:20992
    s_waitcnt lgkmcnt(5)
    v_mfma_f32_16x16x32_bf16 v[128:131], v[40:43], v[16:19], v[128:131]
    s_waitcnt lgkmcnt(4)
    v_mfma_f32_16x16x32_bf16 v[148:151], v[48:51], v[16:19], v[148:151]
    ds_read_b64_tr_b16 v[16:17], v8 offset:20480
    ds_read_b64_tr_b16 v[18:19], v8 offset:20992
    v_cvt_pk_bf16_f32 v94, v112, v113
    v_cvt_pk_bf16_f32 v95, v114, v115
    buffer_store_dwordx4 v[92:95], v68, s[28:31], s64 offen offset:1536 sc1
    v_mfma_f32_16x16x32_bf16 v[152:155], v[48:51], v[82:85], v[152:155]
    v_cvt_pk_bf16_f32 v98, v116, v117
    v_cvt_pk_bf16_f32 v99, v118, v119
    buffer_store_dwordx4 v[96:99], v68, s[28:31], s64 offen offset:1792 sc1
    v_mfma_f32_16x16x32_bf16 v[132:135], v[40:43], v[82:85], v[132:135]
    ds_read_b64_tr_b16 v[82:83], v9 offset:20480
    s_branch L_sk_4054
L_gp_5:
    s_branch L_k1_c_qkv
L_sk_4054:
    ds_read_b64_tr_b16 v[84:85], v9 offset:20992
    v_cvt_pk_bf16_f32 v102, v120, v121
    v_cvt_pk_bf16_f32 v103, v122, v123
    buffer_store_dwordx4 v[100:103], v68, s[28:31], s64 offen offset:2048 sc1
    v_mfma_f32_16x16x32_bf16 v[136:139], v[40:43], v[52:55], v[136:139]
    v_cvt_pk_bf16_f32 v106, v124, v125
    v_cvt_pk_bf16_f32 v107, v126, v127
    buffer_store_dwordx4 v[104:107], v68, s[28:31], s64 offen offset:2304 sc1
    v_mfma_f32_16x16x32_bf16 v[156:159], v[48:51], v[52:55], v[156:159]
    ds_read_b64_tr_b16 v[52:53], v10 offset:20480
    ds_read_b64_tr_b16 v[54:55], v10 offset:20992
    v_cvt_pk_bf16_f32 v90, v108, v109
    v_cvt_pk_bf16_f32 v91, v110, v111
    buffer_store_dwordx4 v[88:91], v68, s[28:31], s64 offen offset:1280 sc1
    v_mfma_f32_16x16x32_bf16 v[160:163], v[48:51], v[56:59], v[160:163]
    s_setprio 0
    v_mfma_f32_16x16x32_bf16 v[140:143], v[40:43], v[56:59], v[140:143]
    ds_read_b64_tr_b16 v[56:57], v6 offset:20480
    ds_read_b64_tr_b16 v[58:59], v6 offset:20992
    v_mfma_f32_16x16x32_bf16 v[144:147], v[40:43], v[60:63], v[144:147]
    ds_read_b64_tr_b16 v[40:41], v7 offset:40960
    v_mfma_f32_16x16x32_bf16 v[164:167], v[48:51], v[60:63], v[164:167]
    s_waitcnt lgkmcnt(12)
    v_mfma_f32_16x16x32_bf16 v[128:131], v[20:23], v[74:77], v[128:131]
    ds_read_b64_tr_b16 v[42:43], v7 offset:41472
    s_waitcnt lgkmcnt(12)
    v_mfma_f32_16x16x32_bf16 v[148:151], v[36:39], v[74:77], v[148:151]
    ds_read_b128 v[60:63], v87 offset:36864
    v_mfma_f32_16x16x32_bf16 v[152:155], v[36:39], v[64:67], v[152:155]
    v_mfma_f32_16x16x32_bf16 v[132:135], v[20:23], v[64:67], v[132:135]
    v_mfma_f32_16x16x32_bf16 v[136:139], v[20:23], v[32:35], v[136:139]
    v_mfma_f32_16x16x32_bf16 v[156:159], v[36:39], v[32:35], v[156:159]
    v_mfma_f32_16x16x32_bf16 v[160:163], v[36:39], v[44:47], v[160:163]
    v_mfma_f32_16x16x32_bf16 v[140:143], v[20:23], v[44:47], v[140:143]
    v_mfma_f32_16x16x32_bf16 v[144:147], v[20:23], v[70:73], v[144:147]
    v_mfma_f32_16x16x32_bf16 v[164:167], v[36:39], v[70:73], v[164:167]
    s_waitcnt lgkmcnt(11)
    v_mfma_f32_16x16x32_bf16 v[132:135], v[24:27], v[78:81], v[132:135]
    ds_read_b64_tr_b16 v[48:49], v8 offset:40960
    ds_read_b64_tr_b16 v[50:51], v8 offset:41472
    s_waitcnt lgkmcnt(11)
    v_mfma_f32_16x16x32_bf16 v[136:139], v[24:27], v[16:19], v[136:139]
    ds_read_b64_tr_b16 v[74:75], v9 offset:40960
    ds_read_b64_tr_b16 v[76:77], v9 offset:41472
    s_waitcnt lgkmcnt(11)
    v_mfma_f32_16x16x32_bf16 v[140:143], v[24:27], v[82:85], v[140:143]
    ds_read_b64_tr_b16 v[64:65], v10 offset:40960
    ds_read_b64_tr_b16 v[66:67], v10 offset:41472
    s_waitcnt lgkmcnt(11)
    v_mfma_f32_16x16x32_bf16 v[144:147], v[24:27], v[52:55], v[144:147]
    ds_read_b64_tr_b16 v[32:33], v6 offset:40960
    ds_read_b64_tr_b16 v[34:35], v6 offset:41472
    s_waitcnt lgkmcnt(11)
    v_mfma_f32_16x16x32_bf16 v[128:131], v[24:27], v[56:59], v[128:131]
    ds_read_b128 v[44:47], v87 offset:38912
    s_waitcnt lgkmcnt(9)
    v_mfma_f32_16x16x32_bf16 v[132:135], v[60:63], v[40:43], v[132:135]
    s_waitcnt lgkmcnt(7)
    v_mfma_f32_16x16x32_bf16 v[136:139], v[60:63], v[48:51], v[136:139]
    s_waitcnt lgkmcnt(5)
    v_mfma_f32_16x16x32_bf16 v[140:143], v[60:63], v[74:77], v[140:143]
    s_waitcnt lgkmcnt(3)
    v_mfma_f32_16x16x32_bf16 v[144:147], v[60:63], v[64:67], v[144:147]
    s_waitcnt lgkmcnt(1)
    v_mfma_f32_16x16x32_bf16 v[128:131], v[60:63], v[32:35], v[128:131]
    v_mfma_f32_16x16x32_bf16 v[152:155], v[28:31], v[78:81], v[152:155]
    v_mfma_f32_16x16x32_bf16 v[156:159], v[28:31], v[16:19], v[156:159]
    v_cvt_pk_bf16_f32 v132, v132, v133
    v_cvt_pk_bf16_f32 v133, v134, v135
    v_cvt_pk_bf16_f32 v136, v136, v137
    v_mfma_f32_16x16x32_bf16 v[160:163], v[28:31], v[82:85], v[160:163]
    v_cvt_pk_bf16_f32 v137, v138, v139
    v_cvt_pk_bf16_f32 v140, v140, v141
    v_cvt_pk_bf16_f32 v141, v142, v143
    v_mfma_f32_16x16x32_bf16 v[164:167], v[28:31], v[52:55], v[164:167]
    v_cvt_pk_bf16_f32 v144, v144, v145
    v_cvt_pk_bf16_f32 v145, v146, v147
    v_cvt_pk_bf16_f32 v128, v128, v129
    v_mfma_f32_16x16x32_bf16 v[148:151], v[28:31], v[56:59], v[148:151]
    s_mov_b64 exec, 1
    s_waitcnt vmcnt(0)
    ds_add_u32 v69, v69
    s_mov_b64 exec, -1
    v_cvt_pk_bf16_f32 v129, v130, v131
    s_waitcnt lgkmcnt(1)
    v_mfma_f32_16x16x32_bf16 v[152:155], v[44:47], v[40:43], v[152:155]
    v_mfma_f32_16x16x32_bf16 v[156:159], v[44:47], v[48:51], v[156:159]
    v_mfma_f32_16x16x32_bf16 v[160:163], v[44:47], v[74:77], v[160:163]
    v_mfma_f32_16x16x32_bf16 v[164:167], v[44:47], v[64:67], v[164:167]
    v_mfma_f32_16x16x32_bf16 v[148:151], v[44:47], v[32:35], v[148:151]
    s_nop 7
    v_cvt_pk_bf16_f32 v134, v152, v153
    v_cvt_pk_bf16_f32 v135, v154, v155
    buffer_store_dwordx4 v[132:135], v68, s[28:31], s65 offen offset:1536 sc1
    v_cvt_pk_bf16_f32 v138, v156, v157
    v_cvt_pk_bf16_f32 v139, v158, v159
    buffer_store_dwordx4 v[136:139], v68, s[28:31], s65 offen offset:1792 sc1
    v_cvt_pk_bf16_f32 v142, v160, v161
    v_cvt_pk_bf16_f32 v143, v162, v163
    buffer_store_dwordx4 v[140:143], v68, s[28:31], s65 offen offset:2048 sc1
    v_cvt_pk_bf16_f32 v146, v164, v165
    v_cvt_pk_bf16_f32 v147, v166, v167
    buffer_store_dwordx4 v[144:147], v68, s[28:31], s65 offen offset:2304 sc1
    v_cvt_pk_bf16_f32 v130, v148, v149
    v_cvt_pk_bf16_f32 v131, v150, v151
    buffer_store_dwordx4 v[128:131], v68, s[28:31], s65 offen offset:1280 sc1
    s_branch L_cdone
L_k1_c_ffn:
    s_mov_b32 s18, 2621440
    s_mov_b32 s19, 0x00020000
    s_mov_b32 s22, 1966080
    s_mov_b32 s23, 0x00020000
    s_mov_b32 s26, 1966080
    s_mov_b32 s27, 0x00020000
    s_waitcnt lgkmcnt(0)
    s_mov_b64 s[16:17], s[4:5]
    s_mov_b64 s[20:21], s[8:9]
    s_mov_b64 s[24:25], s[10:11]
    s_mov_b32 s28, s14
    s_mov_b32 s29, s15
    s_mov_b32 s30, 22020096
    s_mov_b32 s31, 0x00020000
    s_mov_b32 s74, s76
    s_mov_b32 s75, s77
    s_mov_b32 s76, s78
    s_mov_b32 s77, s79
    s_mov_b32 s78, 256
    s_mov_b32 s79, 0x00020000
    s_cmp_gt_u32 s36, 3
    s_cbranch_scc1 L_npf
    s_mul_i32 s56, s39, 10
    s_mul_i32 s57, s38, 14
    s_add_u32 s57, s57, s45
    s_mul_i32 s58, s39, 12
    s_add_u32 s58, s58, s38
    s_mul_i32 s58, s58, 3840
    s_cmp_eq_u32 s36, 0
    s_cselect_b64 s[64:65], s[16:17], s[20:21]
    s_cselect_b32 s66, s18, s22
    s_cselect_b32 s56, s57, s56
    s_cselect_b32 s57, 1280, s47
    s_cselect_b32 s59, 28, 20
    s_cselect_b32 s68, 0, s43
    s_mov_b32 s69, 393216
    s_cselect_b32 s69, 256, s69
    s_mov_b32 s67, 0x00020000
    s_cmp_eq_u32 s36, 2
    s_cselect_b64 s[64:65], s[24:25], s[64:65]
    s_cmp_eq_u32 s36, 3
    s_cselect_b64 s[64:65], s[6:7], s[64:65]
    s_cselect_b32 s66, 2457600, s66
    s_cselect_b32 s56, 0, s56
    s_cselect_b32 s57, 256, s57
    s_cselect_b32 s68, s58, s68
    s_cselect_b32 s69, 491520, s69
    s_cselect_b32 s59, 30, s59
    s_cselect_b32 s58, s58, 0
    s_cmp_ge_u32 s58, 491520
    s_cselect_b32 s59, 0, s59
    v_lshrrev_b32 v14, 1, v1
    v_and_b32 v15, 1, v1
    v_add_u32 v14, s56, v14
    v_mul_lo_u32 v14, v14, s57
    v_cmp_gt_u32 vcc, s59, v1
    v_lshl_add_u32 v14, v15, 7, v14
    v_mov_b32 v15, 0x7fffffff
    v_cndmask_b32 v14, v15, v14, vcc
    buffer_load_dword v15, v14, s[64:67], s68 offen sc1
    s_add_u32 s68, s68, s69
    buffer_load_dword v15, v14, s[64:67], s68 offen sc1
    s_add_u32 s68, s68, s69
L_npf:
    s_and_b32 s50, s36, 1
    s_lshr_b32 s51, s36, 1
    s_mul_i32 s48, s50, 10240
    s_add_u32 s48, s48, 98304
    v_and_b32 v68, 15, v1
    v_lshrrev_b32 v69, 4, v1
    v_lshrrev_b32 v70, 1, v68
    v_xor_b32 v70, v70, v69
    v_lshlrev_b32 v70, 4, v70
    v_lshl_add_u32 v70, v68, 7, v70
    v_add_u32 v86, s48, v70
    v_xor_b32 v87, 64, v86
    v_lshrrev_b32 v70, 2, v68
    v_lshl_add_u32 v71, v69, 3, v70
    v_lshlrev_b32 v71, 7, v71
    v_lshrrev_b32 v70, 1, v70
    v_and_b32 v72, 1, v69
    v_lshlrev_b32 v72, 2, v72
    v_and_b32 v73, 3, v68
    v_or_b32 v72, v70, v72
    v_and_b32 v74, 2, v73
    s_and_b32 s48, s51, 1
    s_lshl_b32 s48, s48, 2
    v_or_b32 v74, s48, v74
    v_xor_b32 v74, v74, v72
    v_lshl_add_u32 v71, v74, 4, v71
    v_and_b32 v74, 1, v73
    v_lshl_add_u32 v71, v74, 3, v71
    s_lshr_b32 s48, s51, 1
    s_lshl_b32 s48, s48, 12
    v_add_u32 v6, s48, v71
    v_xor_b32 v7, 16, v6
    v_add_u32 v8, 49152, v6
    v_add_u32 v9, 49152, v7
    s_barrier
    ds_read_b128 v[48:51], v86 offset:0
    ds_read_b64_tr_b16 v[16:17], v6 offset:0
    ds_read_b64_tr_b16 v[18:19], v6 offset:512
    ds_read_b64_tr_b16 v[20:21], v7 offset:0
    ds_read_b64_tr_b16 v[22:23], v7 offset:512
    ds_read_b64_tr_b16 v[24:25], v6 offset:8192
    ds_read_b64_tr_b16 v[26:27], v6 offset:8704
    ds_read_b64_tr_b16 v[28:29], v7 offset:8192
    ds_read_b64_tr_b16 v[30:31], v7 offset:8704
    ds_read_b128 v[52:55], v86 offset:2048
    ds_read_b128 v[56:59], v86 offset:4096
    ds_read_b128 v[60:63], v86 offset:6144
    ds_read_b128 v[64:67], v86 offset:8192
    s_waitcnt lgkmcnt(4)
    v_mfma_f32_16x16x32_bf16 v[152:155], v[16:19], v[48:51], 0
    v_mfma_f32_16x16x32_bf16 v[156:159], v[20:23], v[48:51], 0
    v_mfma_f32_16x16x32_bf16 v[160:163], v[24:27], v[48:51], 0
    v_mfma_f32_16x16x32_bf16 v[164:167], v[28:31], v[48:51], 0
    s_waitcnt lgkmcnt(3)
    v_mfma_f32_16x16x32_bf16 v[148:151], v[28:31], v[52:55], 0
    v_mfma_f32_16x16x32_bf16 v[144:147], v[24:27], v[52:55], 0
    v_mfma_f32_16x16x32_bf16 v[140:143], v[20:23], v[52:55], 0
    v_mfma_f32_16x16x32_bf16 v[136:139], v[16:19], v[52:55], 0
    s_waitcnt lgkmcnt(2)
    v_mfma_f32_16x16x32_bf16 v[120:123], v[16:19], v[56:59], 0
    v_mfma_f32_16x16x32_bf16 v[124:127], v[20:23], v[56:59], 0
    v_mfma_f32_16x16x32_bf16 v[128:131], v[24:27], v[56:59], 0
    v_mfma_f32_16x16x32_bf16 v[132:135], v[28:31], v[56:59], 0
    s_waitcnt lgkmcnt(1)
    s_barrier
    v_mfma_f32_16x16x32_bf16 v[116:119], v[28:31], v[60:63], 0
    ds_read_b128 v[48:51], v87 offset:0
    ds_read_b64_tr_b16 v[32:33], v6 offset:16384
    v_mfma_f32_16x16x32_bf16 v[112:115], v[24:27], v[60:63], 0
    ds_read_b64_tr_b16 v[34:35], v6 offset:16896
    ds_read_b64_tr_b16 v[36:37], v7 offset:16384
    v_mfma_f32_16x16x32_bf16 v[108:111], v[20:23], v[60:63], 0
    ds_read_b64_tr_b16 v[38:39], v7 offset:16896
    ds_read_b64_tr_b16 v[40:41], v6 offset:24576
    v_mfma_f32_16x16x32_bf16 v[104:107], v[16:19], v[60:63], 0
    ds_read_b64_tr_b16 v[42:43], v6 offset:25088
    ds_read_b64_tr_b16 v[44:45], v7 offset:24576
    s_waitcnt lgkmcnt(8)
    v_mfma_f32_16x16x32_bf16 v[88:91], v[16:19], v[64:67], 0
    ds_read_b64_tr_b16 v[46:47], v7 offset:25088
    ds_read_b128 v[52:55], v87 offset:2048
    v_mfma_f32_16x16x32_bf16 v[92:95], v[20:23], v[64:67], 0
    ds_read_b128 v[56:59], v87 offset:4096
    ds_read_b128 v[60:63], v87 offset:6144
    v_mfma_f32_16x16x32_bf16 v[96:99], v[24:27], v[64:67], 0
    v_mfma_f32_16x16x32_bf16 v[100:103], v[28:31], v[64:67], 0
    ds_read_b128 v[64:67], v87 offset:8192
    s_waitcnt lgkmcnt(4)
    v_mfma_f32_16x16x32_bf16 v[152:155], v[32:35], v[48:51], v[152:155]
    v_mfma_f32_16x16x32_bf16 v[156:159], v[36:39], v[48:51], v[156:159]
    s_lshr_b32 s34, s2, 3
    v_mfma_f32_16x16x32_bf16 v[160:163], v[40:43], v[48:51], v[160:163]
    v_mfma_f32_16x16x32_bf16 v[164:167], v[44:47], v[48:51], v[164:167]
    s_and_b32 s58, s2, 7
    s_waitcnt lgkmcnt(3)
    v_mfma_f32_16x16x32_bf16 v[148:151], v[44:47], v[52:55], v[148:151]
    s_lshl_b32 s58, s58, 2
    v_mfma_f32_16x16x32_bf16 v[144:147], v[40:43], v[52:55], v[144:147]
    v_mfma_f32_16x16x32_bf16 v[140:143], v[36:39], v[52:55], v[140:143]
    s_bfe_u32 s59, s2, 0x20003
    v_mfma_f32_16x16x32_bf16 v[136:139], v[32:35], v[52:55], v[136:139]
    s_waitcnt lgkmcnt(2)
    v_mfma_f32_16x16x32_bf16 v[120:123], v[32:35], v[56:59], v[120:123]
    s_add_u32 s58, s58, s59
    v_mfma_f32_16x16x32_bf16 v[124:127], v[36:39], v[56:59], v[124:127]
    s_lshr_b32 s7, s2, 5
    v_mfma_f32_16x16x32_bf16 v[128:131], v[40:43], v[56:59], v[128:131]
    s_lshl_b32 s7, s7, 3
    v_mfma_f32_16x16x32_bf16 v[132:135], v[44:47], v[56:59], v[132:135]
    s_add_u32 s7, s7, s36
    s_waitcnt lgkmcnt(1)
    v_mfma_f32_16x16x32_bf16 v[116:119], v[44:47], v[60:63], v[116:119]
    s_mul_i32 s7, s7, 40
    v_mfma_f32_16x16x32_bf16 v[112:115], v[40:43], v[60:63], v[112:115]
    v_mfma_f32_16x16x32_bf16 v[108:111], v[36:39], v[60:63], v[108:111]
    s_add_u32 s6, s7, s58
    v_mfma_f32_16x16x32_bf16 v[104:107], v[32:35], v[60:63], v[104:107]
    s_waitcnt lgkmcnt(0)
    v_mfma_f32_16x16x32_bf16 v[88:91], v[32:35], v[64:67], v[88:91]
    v_mfma_f32_16x16x32_bf16 v[92:95], v[36:39], v[64:67], v[92:95]
    s_lshl_b32 s6, s6, 10
    v_mfma_f32_16x16x32_bf16 v[96:99], v[40:43], v[64:67], v[96:99]
    v_mfma_f32_16x16x32_bf16 v[100:103], v[44:47], v[64:67], v[100:103]
    s_add_u32 s6, s6, 14155776
    s_barrier
    ds_read_b128 v[48:51], v86 offset:20480
    ds_read_b64_tr_b16 v[16:17], v6 offset:32768
    ds_read_b64_tr_b16 v[18:19], v6 offset:33280
    ds_read_b64_tr_b16 v[20:21], v7 offset:32768
    ds_read_b64_tr_b16 v[22:23], v7 offset:33280
    ds_read_b64_tr_b16 v[24:25], v6 offset:40960
    ds_read_b64_tr_b16 v[26:27], v6 offset:41472
    ds_read_b64_tr_b16 v[28:29], v7 offset:40960
    ds_read_b64_tr_b16 v[30:31], v7 offset:41472
    ds_read_b128 v[52:55], v86 offset:22528
    ds_read_b128 v[56:59], v86 offset:24576
    ds_read_b128 v[60:63], v86 offset:26624
    ds_read_b128 v[64:67], v86 offset:28672
    s_waitcnt lgkmcnt(4)
    v_mfma_f32_16x16x32_bf16 v[152:155], v[16:19], v[48:51], v[152:155]
    v_mfma_f32_16x16x32_bf16 v[156:159], v[20:23], v[48:51], v[156:159]
    s_lshr_b32 s58, s58, 2
    v_mfma_f32_16x16x32_bf16 v[160:163], v[24:27], v[48:51], v[160:163]
    v_mfma_f32_16x16x32_bf16 v[164:167], v[28:31], v[48:51], v[164:167]
    s_add_u32 s7, s7, s58
    s_waitcnt lgkmcnt(3)
    v_mfma_f32_16x16x32_bf16 v[148:151], v[28:31], v[52:55], v[148:151]
    s_lshl_b32 s7, s7, 10
    v_mfma_f32_16x16x32_bf16 v[144:147], v[24:27], v[52:55], v[144:147]
    v_mfma_f32_16x16x32_bf16 v[140:143], v[20:23], v[52:55], v[140:143]
    s_add_u32 s7, s7, 14188544
    v_mfma_f32_16x16x32_bf16 v[136:139], v[16:19], v[52:55], v[136:139]
    s_waitcnt lgkmcnt(2)
    v_mfma_f32_16x16x32_bf16 v[120:123], v[16:19], v[56:59], v[120:123]
    s_and_b32 s58, s59, 1
    v_mfma_f32_16x16x32_bf16 v[124:127], v[20:23], v[56:59], v[124:127]
    s_lshl_b32 s58, s58, 9
    v_mfma_f32_16x16x32_bf16 v[128:131], v[24:27], v[56:59], v[128:131]
    s_add_u32 s7, s7, s58
    v_mfma_f32_16x16x32_bf16 v[132:135], v[28:31], v[56:59], v[132:135]
    s_and_b32 s58, s59, 2
    s_waitcnt lgkmcnt(1)
    s_barrier
    v_mfma_f32_16x16x32_bf16 v[116:119], v[28:31], v[60:63], v[116:119]
    ds_read_b128 v[48:51], v87 offset:20480
    ds_read_b64_tr_b16 v[32:33], v8 offset:0
    s_lshl_b32 s58, s58, 7
    v_mfma_f32_16x16x32_bf16 v[112:115], v[24:27], v[60:63], v[112:115]
    ds_read_b64_tr_b16 v[34:35], v8 offset:512
    ds_read_b64_tr_b16 v[36:37], v9 offset:0
    v_mfma_f32_16x16x32_bf16 v[108:111], v[20:23], v[60:63], v[108:111]
    ds_read_b64_tr_b16 v[38:39], v9 offset:512
    ds_read_b64_tr_b16 v[40:41], v8 offset:8192
    s_add_u32 s7, s7, s58
    v_mfma_f32_16x16x32_bf16 v[104:107], v[16:19], v[60:63], v[104:107]
    ds_read_b64_tr_b16 v[42:43], v8 offset:8704
    ds_read_b64_tr_b16 v[44:45], v9 offset:8192
    s_waitcnt lgkmcnt(8)
    v_mfma_f32_16x16x32_bf16 v[88:91], v[16:19], v[64:67], v[88:91]
    ds_read_b64_tr_b16 v[46:47], v9 offset:8704
    ds_read_b128 v[52:55], v87 offset:22528
    v_mfma_f32_16x16x32_bf16 v[92:95], v[20:23], v[64:67], v[92:95]
    ds_read_b128 v[56:59], v87 offset:24576
    ds_read_b128 v[60:63], v87 offset:26624
    s_and_b32 s13, s2, 7
    v_mfma_f32_16x16x32_bf16 v[96:99], v[24:27], v[64:67], v[96:99]
    v_mfma_f32_16x16x32_bf16 v[100:103], v[28:31], v[64:67], v[100:103]
    s_lshl_b32 s13, s13, 2
    ds_read_b128 v[64:67], v87 offset:28672
    s_waitcnt lgkmcnt(4)
    v_mfma_f32_16x16x32_bf16 v[152:155], v[32:35], v[48:51], v[152:155]
    v_mfma_f32_16x16x32_bf16 v[156:159], v[36:39], v[48:51], v[156:159]
    s_and_b32 s34, s34, 3
    v_mfma_f32_16x16x32_bf16 v[160:163], v[40:43], v[48:51], v[160:163]
    v_mfma_f32_16x16x32_bf16 v[164:167], v[44:47], v[48:51], v[164:167]
    s_add_u32 s13, s13, s34
    s_waitcnt lgkmcnt(3)
    v_mfma_f32_16x16x32_bf16 v[148:151], v[44:47], v[52:55], v[148:151]
    s_lshr_b32 s34, s2, 5
    v_mfma_f32_16x16x32_bf16 v[144:147], v[40:43], v[52:55], v[144:147]
    s_barrier
    v_mfma_f32_16x16x32_bf16 v[140:143], v[36:39], v[52:55], v[140:143]
    ds_read_b128 v[48:51], v86 offset:40960
    ds_read_b64_tr_b16 v[16:17], v8 offset:16384
    s_lshr_b32 s38, s36, 2
    v_mfma_f32_16x16x32_bf16 v[136:139], v[32:35], v[52:55], v[136:139]
    ds_read_b64_tr_b16 v[18:19], v8 offset:16896
    ds_read_b64_tr_b16 v[20:21], v9 offset:16384
    s_waitcnt lgkmcnt(6)
    v_mfma_f32_16x16x32_bf16 v[120:123], v[32:35], v[56:59], v[120:123]
    ds_read_b64_tr_b16 v[22:23], v9 offset:16896
    ds_read_b64_tr_b16 v[24:25], v8 offset:24576
    s_mov_b64 s[20:21], 0xffffffff
    v_mfma_f32_16x16x32_bf16 v[124:127], v[36:39], v[56:59], v[124:127]
    ds_read_b64_tr_b16 v[26:27], v8 offset:25088
    ds_read_b64_tr_b16 v[28:29], v9 offset:24576
    s_mov_b32 s22, 0x000fffff
    v_mfma_f32_16x16x32_bf16 v[128:131], v[40:43], v[56:59], v[128:131]
    ds_read_b64_tr_b16 v[30:31], v9 offset:25088
    ds_read_b128 v[52:55], v86 offset:43008
    s_mov_b32 s23, 0x000fffff
    v_mfma_f32_16x16x32_bf16 v[132:135], v[44:47], v[56:59], v[132:135]
    s_not_b64 s[24:25], s[20:21]
    s_waitcnt lgkmcnt(11)
    v_mfma_f32_16x16x32_bf16 v[116:119], v[44:47], v[60:63], v[116:119]
    ds_read_b128 v[56:59], v86 offset:45056
    s_mov_b32 s14, 0
    v_mfma_f32_16x16x32_bf16 v[112:115], v[40:43], v[60:63], v[112:115]
    v_mfma_f32_16x16x32_bf16 v[108:111], v[36:39], v[60:63], v[108:111]
    s_xor_b32 s15, s38, 1
    v_mfma_f32_16x16x32_bf16 v[104:107], v[32:35], v[60:63], v[104:107]
    s_waitcnt lgkmcnt(11)
    s_barrier
    v_mfma_f32_16x16x32_bf16 v[88:91], v[32:35], v[64:67], v[88:91]
    s_branch L_sk_4464
L_pad_mf_0:
    s_branch L_k1_c_ffn
L_sk_4464:
    ds_read_b128 v[60:63], v86 offset:47104
    v_mfma_f32_16x16x32_bf16 v[92:95], v[36:39], v[64:67], v[92:95]
    s_mul_i32 s54, s37, 39936
    v_mfma_f32_16x16x32_bf16 v[96:99], v[40:43], v[64:67], v[96:99]
    v_mfma_f32_16x16x32_bf16 v[100:103], v[44:47], v[64:67], v[100:103]
    s_add_u32 s54, s54, 64
    ds_read_b128 v[64:67], v86 offset:49152
    s_waitcnt lgkmcnt(4)
    v_mfma_f32_16x16x32_bf16 v[152:155], v[16:19], v[48:51], v[152:155]
    ds_read_b64_tr_b16 v[32:33], v8 offset:32768
    v_mfma_f32_16x16x32_bf16 v[156:159], v[20:23], v[48:51], v[156:159]
    ds_read_b64_tr_b16 v[34:35], v8 offset:33280
    s_mul_i32 s39, s13, 163840
    v_mfma_f32_16x16x32_bf16 v[160:163], v[24:27], v[48:51], v[160:163]
    ds_read_b64_tr_b16 v[36:37], v9 offset:32768
    v_mfma_f32_16x16x32_bf16 v[164:167], v[28:31], v[48:51], v[164:167]
    ds_read_b64_tr_b16 v[38:39], v9 offset:33280
    s_add_u32 s39, s39, 2621440
    s_waitcnt lgkmcnt(7)
    v_mfma_f32_16x16x32_bf16 v[148:151], v[28:31], v[52:55], v[148:151]
    ds_read_b128 v[48:51], v87 offset:40960
    s_sub_u32 s41, s39, s54
    v_mfma_f32_16x16x32_bf16 v[144:147], v[24:27], v[52:55], v[144:147]
    ds_read_b64_tr_b16 v[40:41], v8 offset:40960
    v_mfma_f32_16x16x32_bf16 v[140:143], v[20:23], v[52:55], v[140:143]
    ds_read_b64_tr_b16 v[42:43], v8 offset:41472
    s_add_u32 s56, s28, s41
    v_mfma_f32_16x16x32_bf16 v[136:139], v[16:19], v[52:55], v[136:139]
    ds_read_b64_tr_b16 v[44:45], v9 offset:40960
    s_waitcnt lgkmcnt(10)
    v_mfma_f32_16x16x32_bf16 v[120:123], v[16:19], v[56:59], v[120:123]
    ds_read_b128 v[52:55], v87 offset:43008
    s_addc_u32 s57, s29, 0
    v_mfma_f32_16x16x32_bf16 v[124:127], v[20:23], v[56:59], v[124:127]
    ds_read_b64_tr_b16 v[46:47], v9 offset:41472
    s_add_u32 s58, s54, 163840
    v_mfma_f32_16x16x32_bf16 v[128:131], v[24:27], v[56:59], v[128:131]
    s_mov_b32 s59, 0x00020000
    v_mfma_f32_16x16x32_bf16 v[132:135], v[28:31], v[56:59], v[132:135]
    s_mul_i32 s52, s37, 40960
    s_waitcnt lgkmcnt(11)
    v_mfma_f32_16x16x32_bf16 v[116:119], v[28:31], v[60:63], v[116:119]
    ds_read_b128 v[56:59], v87 offset:45056
    s_add_u32 s53, s52, 40960
    v_mfma_f32_16x16x32_bf16 v[112:115], v[24:27], v[60:63], v[112:115]
    v_mfma_f32_16x16x32_bf16 v[108:111], v[20:23], v[60:63], v[108:111]
    s_and_b32 s40, s34, 5
    v_mfma_f32_16x16x32_bf16 v[104:107], v[16:19], v[60:63], v[104:107]
    s_waitcnt lgkmcnt(11)
    s_barrier
    v_mfma_f32_16x16x32_bf16 v[88:91], v[16:19], v[64:67], v[88:91]
    ds_read_b128 v[60:63], v87 offset:47104
    v_mfma_f32_16x16x32_bf16 v[92:95], v[20:23], v[64:67], v[92:95]
    s_mul_i32 s40, s40, 5120
    v_mfma_f32_16x16x32_bf16 v[96:99], v[24:27], v[64:67], v[96:99]
    v_mfma_f32_16x16x32_bf16 v[100:103], v[28:31], v[64:67], v[100:103]
    s_add_u32 s41, s40, s52
    ds_read_b128 v[64:67], v87 offset:49152
    s_waitcnt lgkmcnt(3)
    v_mfma_f32_16x16x32_bf16 v[152:155], v[32:35], v[48:51], v[152:155]
    ds_read_b64_tr_b16 v[16:17], v6 offset:0
    v_mfma_f32_16x16x32_bf16 v[156:159], v[36:39], v[48:51], v[156:159]
    ds_read_b64_tr_b16 v[18:19], v6 offset:512
    s_add_u32 s42, s41, 5120
    v_mfma_f32_16x16x32_bf16 v[160:163], v[40:43], v[48:51], v[160:163]
    ds_read_b64_tr_b16 v[20:21], v7 offset:0
    v_mfma_f32_16x16x32_bf16 v[164:167], v[44:47], v[48:51], v[164:167]
    ds_read_b64_tr_b16 v[22:23], v7 offset:512
    s_cmp_eq_u32 s42, s53
    v_mfma_f32_16x16x32_bf16 v[148:151], v[44:47], v[52:55], v[148:151]
    ds_read_b128 v[48:51], v86 offset:0
    s_cselect_b32 s42, s52, s42
    v_mfma_f32_16x16x32_bf16 v[144:147], v[40:43], v[52:55], v[144:147]
    ds_read_b64_tr_b16 v[24:25], v6 offset:8192
    v_mfma_f32_16x16x32_bf16 v[140:143], v[36:39], v[52:55], v[140:143]
    ds_read_b64_tr_b16 v[26:27], v6 offset:8704
    s_add_u32 s52, s41, s39
    v_mfma_f32_16x16x32_bf16 v[136:139], v[32:35], v[52:55], v[136:139]
    ds_read_b64_tr_b16 v[28:29], v7 offset:8192
    s_waitcnt lgkmcnt(10)
    v_mfma_f32_16x16x32_bf16 v[120:123], v[32:35], v[56:59], v[120:123]
    ds_read_b128 v[52:55], v86 offset:2048
    s_add_u32 s53, s52, 4096
    v_mfma_f32_16x16x32_bf16 v[124:127], v[36:39], v[56:59], v[124:127]
    ds_read_b64_tr_b16 v[30:31], v7 offset:8704
    s_mul_i32 s44, s13, 81920
    v_mfma_f32_16x16x32_bf16 v[128:131], v[40:43], v[56:59], v[128:131]
    s_lshl_b32 s43, s34, 1
    v_mfma_f32_16x16x32_bf16 v[132:135], v[44:47], v[56:59], v[132:135]
    s_add_u32 s43, s43, s38
    s_waitcnt lgkmcnt(11)
    v_mfma_f32_16x16x32_bf16 v[116:119], v[44:47], v[60:63], v[116:119]
    ds_read_b128 v[56:59], v86 offset:4096
    s_mul_i32 s43, s43, 5120
    v_mfma_f32_16x16x32_bf16 v[112:115], v[40:43], v[60:63], v[112:115]
    v_mfma_f32_16x16x32_bf16 v[108:111], v[36:39], v[60:63], v[108:111]
    s_add_u32 s44, s44, s43
    v_mfma_f32_16x16x32_bf16 v[104:107], v[32:35], v[60:63], v[104:107]
    s_waitcnt lgkmcnt(11)
    s_barrier
    v_mfma_f32_16x16x32_bf16 v[88:91], v[32:35], v[64:67], v[88:91]
    ds_read_b128 v[60:63], v86 offset:6144
    v_mfma_f32_16x16x32_bf16 v[92:95], v[36:39], v[64:67], v[92:95]
    s_lshl_b32 s49, s36, 7
    v_mfma_f32_16x16x32_bf16 v[96:99], v[40:43], v[64:67], v[96:99]
    v_mfma_f32_16x16x32_bf16 v[100:103], v[44:47], v[64:67], v[100:103]
    s_add_u32 s49, s49, 159808
    ds_read_b128 v[64:67], v86 offset:8192
    s_waitcnt lgkmcnt(3)
    v_mfma_f32_16x16x32_bf16 v[152:155], v[16:19], v[48:51], v[152:155]
    ds_read_b64_tr_b16 v[32:33], v6 offset:16384
    v_mfma_f32_16x16x32_bf16 v[156:159], v[20:23], v[48:51], v[156:159]
    ds_read_b64_tr_b16 v[34:35], v6 offset:16896
    s_cmp_eq_u32 s38, 0
    v_mfma_f32_16x16x32_bf16 v[160:163], v[24:27], v[48:51], v[160:163]
    ds_read_b64_tr_b16 v[36:37], v7 offset:16384
    v_mfma_f32_16x16x32_bf16 v[164:167], v[28:31], v[48:51], v[164:167]
    ds_read_b64_tr_b16 v[38:39], v7 offset:16896
    s_mov_b32 s35, 161028
    v_mfma_f32_16x16x32_bf16 v[148:151], v[28:31], v[52:55], v[148:151]
    ds_read_b128 v[48:51], v87 offset:0
    s_cselect_b32 s35, 4, s35
    v_mfma_f32_16x16x32_bf16 v[144:147], v[24:27], v[52:55], v[144:147]
    ds_read_b64_tr_b16 v[40:41], v6 offset:24576
    v_mfma_f32_16x16x32_bf16 v[140:143], v[20:23], v[52:55], v[140:143]
    ds_read_b64_tr_b16 v[42:43], v6 offset:25088
    s_cselect_b32 s26, 12, 4
    v_mfma_f32_16x16x32_bf16 v[136:139], v[16:19], v[52:55], v[136:139]
    ds_read_b64_tr_b16 v[44:45], v7 offset:24576
    s_waitcnt lgkmcnt(10)
    v_mfma_f32_16x16x32_bf16 v[120:123], v[16:19], v[56:59], v[120:123]
    ds_read_b128 v[52:55], v87 offset:2048
    s_mul_i32 s27, s38, 20480
    v_mfma_f32_16x16x32_bf16 v[124:127], v[20:23], v[56:59], v[124:127]
    ds_read_b64_tr_b16 v[46:47], v7 offset:25088
    s_add_u32 s27, s27, 64
    v_mfma_f32_16x16x32_bf16 v[128:131], v[24:27], v[56:59], v[128:131]
    s_lshl_b32 s55, s38, 2
    v_mfma_f32_16x16x32_bf16 v[132:135], v[28:31], v[56:59], v[132:135]
    s_add_u32 s55, s55, 161028
    s_waitcnt lgkmcnt(11)
    v_mfma_f32_16x16x32_bf16 v[116:119], v[28:31], v[60:63], v[116:119]
    ds_read_b128 v[56:59], v87 offset:4096
    s_lshl_b32 s11, s34, 2
    v_mfma_f32_16x16x32_bf16 v[112:115], v[24:27], v[60:63], v[112:115]
    v_mfma_f32_16x16x32_bf16 v[108:111], v[20:23], v[60:63], v[108:111]
    s_add_u32 s11, s11, s37
    v_mfma_f32_16x16x32_bf16 v[104:107], v[16:19], v[60:63], v[104:107]
    s_waitcnt lgkmcnt(11)
    s_barrier
    v_mfma_f32_16x16x32_bf16 v[88:91], v[16:19], v[64:67], v[88:91]
    ds_read_b128 v[60:63], v87 offset:6144
    v_mfma_f32_16x16x32_bf16 v[92:95], v[20:23], v[64:67], v[92:95]
    s_lshl_b32 s11, s11, 2
    v_mfma_f32_16x16x32_bf16 v[96:99], v[24:27], v[64:67], v[96:99]
    v_mfma_f32_16x16x32_bf16 v[100:103], v[28:31], v[64:67], v[100:103]
    s_lshr_b32 s12, s13, 3
    ds_read_b128 v[64:67], v87 offset:8192
    s_waitcnt lgkmcnt(3)
    v_mfma_f32_16x16x32_bf16 v[152:155], v[32:35], v[48:51], v[152:155]
    ds_read_b64_tr_b16 v[16:17], v6 offset:32768
    v_mfma_f32_16x16x32_bf16 v[156:159], v[36:39], v[48:51], v[156:159]
    ds_read_b64_tr_b16 v[18:19], v6 offset:33280
    s_add_u32 s11, s11, s12
    v_mfma_f32_16x16x32_bf16 v[160:163], v[40:43], v[48:51], v[160:163]
    ds_read_b64_tr_b16 v[20:21], v7 offset:32768
    v_mfma_f32_16x16x32_bf16 v[164:167], v[44:47], v[48:51], v[164:167]
    ds_read_b64_tr_b16 v[22:23], v7 offset:33280
    s_lshl_b32 s11, s11, 9
    v_mfma_f32_16x16x32_bf16 v[148:151], v[44:47], v[52:55], v[148:151]
    ds_read_b128 v[48:51], v86 offset:20480
    s_lshl_b32 s12, s38, 16
    v_mfma_f32_16x16x32_bf16 v[144:147], v[40:43], v[52:55], v[144:147]
    ds_read_b64_tr_b16 v[24:25], v6 offset:40960
    v_mfma_f32_16x16x32_bf16 v[140:143], v[36:39], v[52:55], v[140:143]
    ds_read_b64_tr_b16 v[26:27], v6 offset:41472
    s_sub_u32 s11, s11, s12
    v_mfma_f32_16x16x32_bf16 v[136:139], v[32:35], v[52:55], v[136:139]
    ds_read_b64_tr_b16 v[28:29], v7 offset:40960
    s_waitcnt lgkmcnt(10)
    v_mfma_f32_16x16x32_bf16 v[120:123], v[32:35], v[56:59], v[120:123]
    ds_read_b128 v[52:55], v86 offset:22528
    s_add_u32 s11, s11, 17891328
    v_mfma_f32_16x16x32_bf16 v[124:127], v[36:39], v[56:59], v[124:127]
    ds_read_b64_tr_b16 v[30:31], v7 offset:41472
    s_and_b32 s12, s13, 6
    v_mfma_f32_16x16x32_bf16 v[128:131], v[40:43], v[56:59], v[128:131]
    s_lshl_b32 s12, 1, s12
    v_mfma_f32_16x16x32_bf16 v[132:135], v[44:47], v[56:59], v[132:135]
    s_add_u32 s12, s12, 256
    s_waitcnt lgkmcnt(11)
    v_mfma_f32_16x16x32_bf16 v[116:119], v[44:47], v[60:63], v[116:119]
    ds_read_b128 v[56:59], v86 offset:24576
    s_xor_b32 s43, s37, 1
    v_mfma_f32_16x16x32_bf16 v[112:115], v[40:43], v[60:63], v[112:115]
    v_mfma_f32_16x16x32_bf16 v[108:111], v[36:39], v[60:63], v[108:111]
    s_mul_i32 s39, s43, 1280
    v_mfma_f32_16x16x32_bf16 v[104:107], v[32:35], v[60:63], v[104:107]
    s_waitcnt lgkmcnt(11)
    s_barrier
    v_mfma_f32_16x16x32_bf16 v[88:91], v[32:35], v[64:67], v[88:91]
    ds_read_b128 v[60:63], v86 offset:26624
    v_mfma_f32_16x16x32_bf16 v[92:95], v[36:39], v[64:67], v[92:95]
    s_add_u32 s45, s39, s44
    v_mfma_f32_16x16x32_bf16 v[96:99], v[40:43], v[64:67], v[96:99]
    v_mfma_f32_16x16x32_bf16 v[100:103], v[44:47], v[64:67], v[100:103]
    s_mul_i32 s16, s43, 39936
    ds_read_b128 v[64:67], v86 offset:28672
    s_waitcnt lgkmcnt(3)
    v_mfma_f32_16x16x32_bf16 v[152:155], v[16:19], v[48:51], v[152:155]
    ds_read_b64_tr_b16 v[32:33], v8 offset:0
    v_mfma_f32_16x16x32_bf16 v[156:159], v[20:23], v[48:51], v[156:159]
    ds_read_b64_tr_b16 v[34:35], v8 offset:512
    s_xor_b32 s43, s37, 2
    v_mfma_f32_16x16x32_bf16 v[160:163], v[24:27], v[48:51], v[160:163]
    ds_read_b64_tr_b16 v[36:37], v9 offset:0
    v_mfma_f32_16x16x32_bf16 v[164:167], v[28:31], v[48:51], v[164:167]
    ds_read_b64_tr_b16 v[38:39], v9 offset:512
    s_mul_i32 s39, s43, 1280
    v_mfma_f32_16x16x32_bf16 v[148:151], v[28:31], v[52:55], v[148:151]
    ds_read_b128 v[48:51], v87 offset:20480
    s_add_u32 s46, s39, s44
    v_mfma_f32_16x16x32_bf16 v[144:147], v[24:27], v[52:55], v[144:147]
    ds_read_b64_tr_b16 v[40:41], v8 offset:8192
    v_mfma_f32_16x16x32_bf16 v[140:143], v[20:23], v[52:55], v[140:143]
    ds_read_b64_tr_b16 v[42:43], v8 offset:8704
    s_mul_i32 s17, s43, 39936
    v_mfma_f32_16x16x32_bf16 v[136:139], v[16:19], v[52:55], v[136:139]
    ds_read_b64_tr_b16 v[44:45], v9 offset:8192
    s_waitcnt lgkmcnt(10)
    v_mfma_f32_16x16x32_bf16 v[120:123], v[16:19], v[56:59], v[120:123]
    ds_read_b128 v[52:55], v87 offset:22528
    s_xor_b32 s43, s37, 3
    v_mfma_f32_16x16x32_bf16 v[124:127], v[20:23], v[56:59], v[124:127]
    ds_read_b64_tr_b16 v[46:47], v9 offset:8704
    s_mul_i32 s39, s43, 1280
    v_mfma_f32_16x16x32_bf16 v[128:131], v[24:27], v[56:59], v[128:131]
    s_add_u32 s47, s39, s44
    v_mfma_f32_16x16x32_bf16 v[132:135], v[28:31], v[56:59], v[132:135]
    s_mul_i32 s18, s43, 39936
    s_waitcnt lgkmcnt(11)
    v_mfma_f32_16x16x32_bf16 v[116:119], v[28:31], v[60:63], v[116:119]
    ds_read_b128 v[56:59], v87 offset:24576
    s_xor_b32 s43, s37, 0
    v_mfma_f32_16x16x32_bf16 v[112:115], v[24:27], v[60:63], v[112:115]
    v_mfma_f32_16x16x32_bf16 v[108:111], v[20:23], v[60:63], v[108:111]
    s_mul_i32 s39, s43, 1280
    v_mfma_f32_16x16x32_bf16 v[104:107], v[16:19], v[60:63], v[104:107]
    s_waitcnt lgkmcnt(11)
    s_barrier
    v_mfma_f32_16x16x32_bf16 v[88:91], v[16:19], v[64:67], v[88:91]
    ds_read_b128 v[60:63], v87 offset:26624
    v_mfma_f32_16x16x32_bf16 v[92:95], v[20:23], v[64:67], v[92:95]
    s_add_u32 s48, s39, s44
    v_mfma_f32_16x16x32_bf16 v[96:99], v[24:27], v[64:67], v[96:99]
    v_mfma_f32_16x16x32_bf16 v[100:103], v[28:31], v[64:67], v[100:103]
    s_mul_i32 s19, s43, 39936
    ds_read_b128 v[64:67], v87 offset:28672
    s_waitcnt lgkmcnt(3)
    v_mfma_f32_16x16x32_bf16 v[152:155], v[32:35], v[48:51], v[152:155]
    ds_read_b64_tr_b16 v[16:17], v8 offset:16384
    v_mfma_f32_16x16x32_bf16 v[156:159], v[36:39], v[48:51], v[156:159]
    ds_read_b64_tr_b16 v[18:19], v8 offset:16896
    s_waitcnt vmcnt(0)
    v_mfma_f32_16x16x32_bf16 v[160:163], v[40:43], v[48:51], v[160:163]
    ds_read_b64_tr_b16 v[20:21], v9 offset:16384
    v_mfma_f32_16x16x32_bf16 v[164:167], v[44:47], v[48:51], v[164:167]
    ds_read_b64_tr_b16 v[22:23], v9 offset:16896
    v_lshlrev_b32 v2, 4, v1
    v_mfma_f32_16x16x32_bf16 v[148:151], v[44:47], v[52:55], v[148:151]
    ds_read_b128 v[48:51], v86 offset:40960
    v_and_b32 v70, 31, v1
    v_mfma_f32_16x16x32_bf16 v[144:147], v[40:43], v[52:55], v[144:147]
    ds_read_b64_tr_b16 v[24:25], v8 offset:24576
    v_mfma_f32_16x16x32_bf16 v[140:143], v[36:39], v[52:55], v[140:143]
    ds_read_b64_tr_b16 v[26:27], v8 offset:25088
    v_lshrrev_b32 v71, 5, v1
    v_mfma_f32_16x16x32_bf16 v[136:139], v[32:35], v[52:55], v[136:139]
    ds_read_b64_tr_b16 v[28:29], v9 offset:24576
    s_waitcnt lgkmcnt(10)
    v_mfma_f32_16x16x32_bf16 v[120:123], v[32:35], v[56:59], v[120:123]
    ds_read_b128 v[52:55], v86 offset:43008
    v_lshrrev_b32 v4, 2, v70
    v_mfma_f32_16x16x32_bf16 v[124:127], v[36:39], v[56:59], v[124:127]
    ds_read_b64_tr_b16 v[30:31], v9 offset:25088
    v_lshl_add_u32 v4, v4, 8, s54
    v_mfma_f32_16x16x32_bf16 v[128:131], v[40:43], v[56:59], v[128:131]
    v_lshl_add_u32 v4, v71, 6, v4
    v_mfma_f32_16x16x32_bf16 v[132:135], v[44:47], v[56:59], v[132:135]
    v_and_b32 v72, 3, v70
    s_waitcnt lgkmcnt(11)
    v_mfma_f32_16x16x32_bf16 v[116:119], v[44:47], v[60:63], v[116:119]
    ds_read_b128 v[56:59], v86 offset:45056
    v_lshl_add_u32 v4, v72, 4, v4
    v_mfma_f32_16x16x32_bf16 v[112:115], v[40:43], v[60:63], v[112:115]
    v_mfma_f32_16x16x32_bf16 v[108:111], v[36:39], v[60:63], v[108:111]
    v_lshrrev_b32 v73, 3, v70
    v_mfma_f32_16x16x32_bf16 v[104:107], v[32:35], v[60:63], v[104:107]
    s_waitcnt lgkmcnt(11)
    s_barrier
    v_mfma_f32_16x16x32_bf16 v[88:91], v[32:35], v[64:67], v[88:91]
    ds_read_b128 v[60:63], v86 offset:47104
    v_mfma_f32_16x16x32_bf16 v[92:95], v[36:39], v[64:67], v[92:95]
    v_lshl_add_u32 v72, v73, 2, v72
    v_mfma_f32_16x16x32_bf16 v[96:99], v[40:43], v[64:67], v[96:99]
    v_mfma_f32_16x16x32_bf16 v[100:103], v[44:47], v[64:67], v[100:103]
    v_lshl_add_u32 v72, v72, 4, s54
    ds_read_b128 v[64:67], v86 offset:49152
    s_waitcnt lgkmcnt(3)
    v_mfma_f32_16x16x32_bf16 v[152:155], v[16:19], v[48:51], v[152:155]
    ds_read_b64_tr_b16 v[32:33], v8 offset:32768
    v_mfma_f32_16x16x32_bf16 v[156:159], v[20:23], v[48:51], v[156:159]
    ds_read_b64_tr_b16 v[34:35], v8 offset:33280
    v_lshrrev_b32 v73, 4, v70
    v_mfma_f32_16x16x32_bf16 v[160:163], v[24:27], v[48:51], v[160:163]
    ds_read_b64_tr_b16 v[36:37], v9 offset:32768
    v_mfma_f32_16x16x32_bf16 v[164:167], v[28:31], v[48:51], v[164:167]
    ds_read_b64_tr_b16 v[38:39], v9 offset:33280
    v_bfe_u32 v74, v70, 2, 1
    v_mfma_f32_16x16x32_bf16 v[148:151], v[28:31], v[52:55], v[148:151]
    ds_read_b128 v[48:51], v87 offset:40960
    v_lshl_add_u32 v3, v74, 3, v72
    v_mfma_f32_16x16x32_bf16 v[144:147], v[24:27], v[52:55], v[144:147]
    ds_read_b64_tr_b16 v[40:41], v8 offset:40960
    v_mfma_f32_16x16x32_bf16 v[140:143], v[20:23], v[52:55], v[140:143]
    ds_read_b64_tr_b16 v[42:43], v8 offset:41472
    v_lshl_add_u32 v14, v74, 8, v72
    v_mfma_f32_16x16x32_bf16 v[136:139], v[16:19], v[52:55], v[136:139]
    ds_read_b64_tr_b16 v[44:45], v9 offset:40960
    s_waitcnt lgkmcnt(10)
    v_mfma_f32_16x16x32_bf16 v[120:123], v[16:19], v[56:59], v[120:123]
    ds_read_b128 v[52:55], v87 offset:43008
    v_lshl_add_u32 v14, v71, 9, v14
    v_mfma_f32_16x16x32_bf16 v[124:127], v[20:23], v[56:59], v[124:127]
    ds_read_b64_tr_b16 v[46:47], v9 offset:41472
    v_and_b32 v15, 15, v70
    v_mfma_f32_16x16x32_bf16 v[128:131], v[24:27], v[56:59], v[128:131]
    v_lshlrev_b32 v15, 4, v15
    v_mfma_f32_16x16x32_bf16 v[132:135], v[28:31], v[56:59], v[132:135]
    v_lshl_add_u32 v15, v73, 3, v15
    s_waitcnt lgkmcnt(11)
    v_mfma_f32_16x16x32_bf16 v[116:119], v[28:31], v[60:63], v[116:119]
    ds_read_b128 v[56:59], v87 offset:45056
    v_mfma_f32_16x16x32_bf16 v[112:115], v[24:27], v[60:63], v[112:115]
    v_mfma_f32_16x16x32_bf16 v[108:111], v[20:23], v[60:63], v[108:111]
    v_mfma_f32_16x16x32_bf16 v[104:107], v[16:19], v[60:63], v[104:107]
    s_waitcnt lgkmcnt(11)
    s_barrier
    v_mfma_f32_16x16x32_bf16 v[88:91], v[16:19], v[64:67], v[88:91]
    ds_read_b128 v[60:63], v87 offset:47104
    v_mfma_f32_16x16x32_bf16 v[92:95], v[20:23], v[64:67], v[92:95]
    v_mfma_f32_16x16x32_bf16 v[96:99], v[24:27], v[64:67], v[96:99]
    v_mfma_f32_16x16x32_bf16 v[100:103], v[28:31], v[64:67], v[100:103]
    ds_read_b128 v[64:67], v87 offset:49152
    s_waitcnt lgkmcnt(3)
    v_mfma_f32_16x16x32_bf16 v[152:155], v[32:35], v[48:51], v[152:155]
    ds_read_b64_tr_b16 v[16:17], v6 offset:0
    v_mfma_f32_16x16x32_bf16 v[156:159], v[36:39], v[48:51], v[156:159]
    ds_read_b64_tr_b16 v[18:19], v6 offset:512
    v_mfma_f32_16x16x32_bf16 v[160:163], v[40:43], v[48:51], v[160:163]
    ds_read_b64_tr_b16 v[20:21], v7 offset:0
    v_mfma_f32_16x16x32_bf16 v[164:167], v[44:47], v[48:51], v[164:167]
    ds_read_b64_tr_b16 v[22:23], v7 offset:512
    v_mfma_f32_16x16x32_bf16 v[148:151], v[44:47], v[52:55], v[148:151]
    ds_read_b128 v[48:51], v86 offset:0
    v_mfma_f32_16x16x32_bf16 v[144:147], v[40:43], v[52:55], v[144:147]
    ds_read_b64_tr_b16 v[24:25], v6 offset:8192
    v_mfma_f32_16x16x32_bf16 v[140:143], v[36:39], v[52:55], v[140:143]
    ds_read_b64_tr_b16 v[26:27], v6 offset:8704
    v_mfma_f32_16x16x32_bf16 v[136:139], v[32:35], v[52:55], v[136:139]
    ds_read_b64_tr_b16 v[28:29], v7 offset:8192
    s_waitcnt lgkmcnt(10)
    v_mfma_f32_16x16x32_bf16 v[120:123], v[32:35], v[56:59], v[120:123]
    ds_read_b128 v[52:55], v86 offset:2048
    v_mfma_f32_16x16x32_bf16 v[124:127], v[36:39], v[56:59], v[124:127]
    ds_read_b64_tr_b16 v[30:31], v7 offset:8704
    v_mfma_f32_16x16x32_bf16 v[128:131], v[40:43], v[56:59], v[128:131]
    v_mfma_f32_16x16x32_bf16 v[132:135], v[44:47], v[56:59], v[132:135]
    s_waitcnt lgkmcnt(11)
    v_mfma_f32_16x16x32_bf16 v[116:119], v[44:47], v[60:63], v[116:119]
    ds_read_b128 v[56:59], v86 offset:4096
    v_mfma_f32_16x16x32_bf16 v[112:115], v[40:43], v[60:63], v[112:115]
    v_mfma_f32_16x16x32_bf16 v[108:111], v[36:39], v[60:63], v[108:111]
    v_mfma_f32_16x16x32_bf16 v[104:107], v[32:35], v[60:63], v[104:107]
    s_waitcnt lgkmcnt(11)
    s_barrier
    v_mfma_f32_16x16x32_bf16 v[88:91], v[32:35], v[64:67], v[88:91]
    ds_read_b128 v[60:63], v86 offset:6144
    v_mfma_f32_16x16x32_bf16 v[92:95], v[36:39], v[64:67], v[92:95]
    v_mfma_f32_16x16x32_bf16 v[96:99], v[40:43], v[64:67], v[96:99]
    v_mfma_f32_16x16x32_bf16 v[100:103], v[44:47], v[64:67], v[100:103]
    ds_read_b128 v[64:67], v86 offset:8192
    s_waitcnt lgkmcnt(3)
    v_mfma_f32_16x16x32_bf16 v[152:155], v[16:19], v[48:51], v[152:155]
    ds_read_b64_tr_b16 v[32:33], v6 offset:16384
    v_mfma_f32_16x16x32_bf16 v[156:159], v[20:23], v[48:51], v[156:159]
    ds_read_b64_tr_b16 v[34:35], v6 offset:16896
    v_mfma_f32_16x16x32_bf16 v[160:163], v[24:27], v[48:51], v[160:163]
    ds_read_b64_tr_b16 v[36:37], v7 offset:16384
    v_mfma_f32_16x16x32_bf16 v[164:167], v[28:31], v[48:51], v[164:167]
    ds_read_b64_tr_b16 v[38:39], v7 offset:16896
    v_mfma_f32_16x16x32_bf16 v[148:151], v[28:31], v[52:55], v[148:151]
    ds_read_b128 v[48:51], v87 offset:0
    v_mfma_f32_16x16x32_bf16 v[144:147], v[24:27], v[52:55], v[144:147]
    ds_read_b64_tr_b16 v[40:41], v6 offset:24576
    v_mfma_f32_16x16x32_bf16 v[140:143], v[20:23], v[52:55], v[140:143]
    ds_read_b64_tr_b16 v[42:43], v6 offset:25088
    v_mfma_f32_16x16x32_bf16 v[136:139], v[16:19], v[52:55], v[136:139]
    ds_read_b64_tr_b16 v[44:45], v7 offset:24576
    s_waitcnt lgkmcnt(10)
    v_mfma_f32_16x16x32_bf16 v[120:123], v[16:19], v[56:59], v[120:123]
    ds_read_b128 v[52:55], v87 offset:2048
    v_mfma_f32_16x16x32_bf16 v[124:127], v[20:23], v[56:59], v[124:127]
    ds_read_b64_tr_b16 v[46:47], v7 offset:25088
    v_mfma_f32_16x16x32_bf16 v[128:131], v[24:27], v[56:59], v[128:131]
    v_mfma_f32_16x16x32_bf16 v[132:135], v[28:31], v[56:59], v[132:135]
    s_waitcnt lgkmcnt(11)
    v_mfma_f32_16x16x32_bf16 v[116:119], v[28:31], v[60:63], v[116:119]
    ds_read_b128 v[56:59], v87 offset:4096
    v_mfma_f32_16x16x32_bf16 v[112:115], v[24:27], v[60:63], v[112:115]
    v_mfma_f32_16x16x32_bf16 v[108:111], v[20:23], v[60:63], v[108:111]
    v_mfma_f32_16x16x32_bf16 v[104:107], v[16:19], v[60:63], v[104:107]
    s_waitcnt lgkmcnt(11)
    s_barrier
    v_mfma_f32_16x16x32_bf16 v[88:91], v[16:19], v[64:67], v[88:91]
    ds_read_b128 v[60:63], v87 offset:6144
    v_mfma_f32_16x16x32_bf16 v[92:95], v[20:23], v[64:67], v[92:95]
    v_mfma_f32_16x16x32_bf16 v[96:99], v[24:27], v[64:67], v[96:99]
    v_mfma_f32_16x16x32_bf16 v[100:103], v[28:31], v[64:67], v[100:103]
    ds_read_b128 v[64:67], v87 offset:8192
    s_waitcnt lgkmcnt(3)
    v_mfma_f32_16x16x32_bf16 v[152:155], v[32:35], v[48:51], v[152:155]
    ds_read_b64_tr_b16 v[16:17], v6 offset:32768
    v_mfma_f32_16x16x32_bf16 v[156:159], v[36:39], v[48:51], v[156:159]
    ds_read_b64_tr_b16 v[18:19], v6 offset:33280
    v_mfma_f32_16x16x32_bf16 v[160:163], v[40:43], v[48:51], v[160:163]
    ds_read_b64_tr_b16 v[20:21], v7 offset:32768
    v_mfma_f32_16x16x32_bf16 v[164:167], v[44:47], v[48:51], v[164:167]
    ds_read_b64_tr_b16 v[22:23], v7 offset:33280
    v_mfma_f32_16x16x32_bf16 v[148:151], v[44:47], v[52:55], v[148:151]
    ds_read_b128 v[48:51], v86 offset:20480
    v_mfma_f32_16x16x32_bf16 v[144:147], v[40:43], v[52:55], v[144:147]
    ds_read_b64_tr_b16 v[24:25], v6 offset:40960
    v_mfma_f32_16x16x32_bf16 v[140:143], v[36:39], v[52:55], v[140:143]
    ds_read_b64_tr_b16 v[26:27], v6 offset:41472
    v_mfma_f32_16x16x32_bf16 v[136:139], v[32:35], v[52:55], v[136:139]
    ds_read_b64_tr_b16 v[28:29], v7 offset:40960
    s_waitcnt lgkmcnt(10)
    v_mfma_f32_16x16x32_bf16 v[120:123], v[32:35], v[56:59], v[120:123]
    ds_read_b128 v[52:55], v86 offset:22528
    v_mfma_f32_16x16x32_bf16 v[124:127], v[36:39], v[56:59], v[124:127]
    ds_read_b64_tr_b16 v[30:31], v7 offset:41472
    v_mfma_f32_16x16x32_bf16 v[128:131], v[40:43], v[56:59], v[128:131]
    v_mfma_f32_16x16x32_bf16 v[132:135], v[44:47], v[56:59], v[132:135]
    s_waitcnt lgkmcnt(11)
    v_mfma_f32_16x16x32_bf16 v[116:119], v[44:47], v[60:63], v[116:119]
    ds_read_b128 v[56:59], v86 offset:24576
    v_mfma_f32_16x16x32_bf16 v[112:115], v[40:43], v[60:63], v[112:115]
    v_mfma_f32_16x16x32_bf16 v[108:111], v[36:39], v[60:63], v[108:111]
    v_mfma_f32_16x16x32_bf16 v[104:107], v[32:35], v[60:63], v[104:107]
    s_waitcnt lgkmcnt(11)
    s_barrier
    v_mfma_f32_16x16x32_bf16 v[88:91], v[32:35], v[64:67], v[88:91]
    ds_read_b128 v[60:63], v86 offset:26624
    v_mfma_f32_16x16x32_bf16 v[92:95], v[36:39], v[64:67], v[92:95]
    v_mfma_f32_16x16x32_bf16 v[96:99], v[40:43], v[64:67], v[96:99]
    v_mfma_f32_16x16x32_bf16 v[100:103], v[44:47], v[64:67], v[100:103]
    ds_read_b128 v[64:67], v86 offset:28672
    s_waitcnt lgkmcnt(3)
    v_mfma_f32_16x16x32_bf16 v[152:155], v[16:19], v[48:51], v[152:155]
    ds_read_b64_tr_b16 v[32:33], v8 offset:0
    v_mfma_f32_16x16x32_bf16 v[156:159], v[20:23], v[48:51], v[156:159]
    ds_read_b64_tr_b16 v[34:35], v8 offset:512
    v_mfma_f32_16x16x32_bf16 v[160:163], v[24:27], v[48:51], v[160:163]
    ds_read_b64_tr_b16 v[36:37], v9 offset:0
    v_mfma_f32_16x16x32_bf16 v[164:167], v[28:31], v[48:51], v[164:167]
    ds_read_b64_tr_b16 v[38:39], v9 offset:512
    v_mfma_f32_16x16x32_bf16 v[148:151], v[28:31], v[52:55], v[148:151]
    ds_read_b128 v[48:51], v87 offset:20480
    v_mfma_f32_16x16x32_bf16 v[144:147], v[24:27], v[52:55], v[144:147]
    ds_read_b64_tr_b16 v[40:41], v8 offset:8192
    v_mfma_f32_16x16x32_bf16 v[140:143], v[20:23], v[52:55], v[140:143]
    ds_read_b64_tr_b16 v[42:43], v8 offset:8704
    v_mfma_f32_16x16x32_bf16 v[136:139], v[16:19], v[52:55], v[136:139]
    ds_read_b64_tr_b16 v[44:45], v9 offset:8192
    s_waitcnt lgkmcnt(10)
    v_mfma_f32_16x16x32_bf16 v[120:123], v[16:19], v[56:59], v[120:123]
    ds_read_b128 v[52:55], v87 offset:22528
    v_mfma_f32_16x16x32_bf16 v[124:127], v[20:23], v[56:59], v[124:127]
    ds_read_b64_tr_b16 v[46:47], v9 offset:8704
    v_mfma_f32_16x16x32_bf16 v[128:131], v[24:27], v[56:59], v[128:131]
    v_mfma_f32_16x16x32_bf16 v[132:135], v[28:31], v[56:59], v[132:135]
    s_waitcnt lgkmcnt(11)
    v_mfma_f32_16x16x32_bf16 v[116:119], v[28:31], v[60:63], v[116:119]
    ds_read_b128 v[56:59], v87 offset:24576
    v_mfma_f32_16x16x32_bf16 v[112:115], v[24:27], v[60:63], v[112:115]
    v_mfma_f32_16x16x32_bf16 v[108:111], v[20:23], v[60:63], v[108:111]
    v_mfma_f32_16x16x32_bf16 v[104:107], v[16:19], v[60:63], v[104:107]
    s_waitcnt lgkmcnt(11)
    s_barrier
    v_mfma_f32_16x16x32_bf16 v[88:91], v[16:19], v[64:67], v[88:91]
    ds_read_b128 v[60:63], v87 offset:26624
    v_mfma_f32_16x16x32_bf16 v[92:95], v[20:23], v[64:67], v[92:95]
    v_mfma_f32_16x16x32_bf16 v[96:99], v[24:27], v[64:67], v[96:99]
    v_mfma_f32_16x16x32_bf16 v[100:103], v[28:31], v[64:67], v[100:103]
    ds_read_b128 v[64:67], v87 offset:28672
    s_waitcnt lgkmcnt(3)
    v_mfma_f32_16x16x32_bf16 v[152:155], v[32:35], v[48:51], v[152:155]
    ds_read_b64_tr_b16 v[16:17], v8 offset:16384
    v_mfma_f32_16x16x32_bf16 v[156:159], v[36:39], v[48:51], v[156:159]
    ds_read_b64_tr_b16 v[18:19], v8 offset:16896
    v_mfma_f32_16x16x32_bf16 v[160:163], v[40:43], v[48:51], v[160:163]
    ds_read_b64_tr_b16 v[20:21], v9 offset:16384
    v_mfma_f32_16x16x32_bf16 v[164:167], v[44:47], v[48:51], v[164:167]
    ds_read_b64_tr_b16 v[22:23], v9 offset:16896
    v_mfma_f32_16x16x32_bf16 v[148:151], v[44:47], v[52:55], v[148:151]
    ds_read_b128 v[48:51], v86 offset:40960
    v_mfma_f32_16x16x32_bf16 v[144:147], v[40:43], v[52:55], v[144:147]
    ds_read_b64_tr_b16 v[24:25], v8 offset:24576
    v_mfma_f32_16x16x32_bf16 v[140:143], v[36:39], v[52:55], v[140:143]
    ds_read_b64_tr_b16 v[26:27], v8 offset:25088
    v_mfma_f32_16x16x32_bf16 v[136:139], v[32:35], v[52:55], v[136:139]
    ds_read_b64_tr_b16 v[28:29], v9 offset:24576
    s_waitcnt lgkmcnt(10)
    v_mfma_f32_16x16x32_bf16 v[120:123], v[32:35], v[56:59], v[120:123]
    ds_read_b128 v[52:55], v86 offset:43008
    v_mfma_f32_16x16x32_bf16 v[124:127], v[36:39], v[56:59], v[124:127]
    ds_read_b64_tr_b16 v[30:31], v9 offset:25088
    v_mfma_f32_16x16x32_bf16 v[128:131], v[40:43], v[56:59], v[128:131]
    v_mfma_f32_16x16x32_bf16 v[132:135], v[44:47], v[56:59], v[132:135]
    s_waitcnt lgkmcnt(11)
    v_mfma_f32_16x16x32_bf16 v[116:119], v[44:47], v[60:63], v[116:119]
    ds_read_b128 v[56:59], v86 offset:45056
    v_mfma_f32_16x16x32_bf16 v[112:115], v[40:43], v[60:63], v[112:115]
    v_mfma_f32_16x16x32_bf16 v[108:111], v[36:39], v[60:63], v[108:111]
    v_mfma_f32_16x16x32_bf16 v[104:107], v[32:35], v[60:63], v[104:107]
    s_waitcnt lgkmcnt(11)
    s_barrier
    v_mfma_f32_16x16x32_bf16 v[88:91], v[32:35], v[64:67], v[88:91]
    ds_read_b128 v[60:63], v86 offset:47104
    v_mfma_f32_16x16x32_bf16 v[92:95], v[36:39], v[64:67], v[92:95]
    v_mfma_f32_16x16x32_bf16 v[96:99], v[40:43], v[64:67], v[96:99]
    v_mfma_f32_16x16x32_bf16 v[100:103], v[44:47], v[64:67], v[100:103]
    ds_read_b128 v[64:67], v86 offset:49152
    s_waitcnt lgkmcnt(3)
    v_mfma_f32_16x16x32_bf16 v[152:155], v[16:19], v[48:51], v[152:155]
    ds_read_b64_tr_b16 v[32:33], v8 offset:32768
    v_mfma_f32_16x16x32_bf16 v[156:159], v[20:23], v[48:51], v[156:159]
    ds_read_b64_tr_b16 v[34:35], v8 offset:33280
    v_mfma_f32_16x16x32_bf16 v[160:163], v[24:27], v[48:51], v[160:163]
    ds_read_b64_tr_b16 v[36:37], v9 offset:32768
    v_mfma_f32_16x16x32_bf16 v[164:167], v[28:31], v[48:51], v[164:167]
    ds_read_b64_tr_b16 v[38:39], v9 offset:33280
    v_mfma_f32_16x16x32_bf16 v[148:151], v[28:31], v[52:55], v[148:151]
    ds_read_b128 v[48:51], v87 offset:40960
    v_mfma_f32_16x16x32_bf16 v[144:147], v[24:27], v[52:55], v[144:147]
    ds_read_b64_tr_b16 v[40:41], v8 offset:40960
    v_mfma_f32_16x16x32_bf16 v[140:143], v[20:23], v[52:55], v[140:143]
    ds_read_b64_tr_b16 v[42:43], v8 offset:41472
    v_mfma_f32_16x16x32_bf16 v[136:139], v[16:19], v[52:55], v[136:139]
    ds_read_b64_tr_b16 v[44:45], v9 offset:40960
    s_waitcnt lgkmcnt(10)
    v_mfma_f32_16x16x32_bf16 v[120:123], v[16:19], v[56:59], v[120:123]
    ds_read_b128 v[52:55], v87 offset:43008
    v_mfma_f32_16x16x32_bf16 v[124:127], v[20:23], v[56:59], v[124:127]
    ds_read_b64_tr_b16 v[46:47], v9 offset:41472
    s_branch L_sk_5034
L_pad_mf_1:
    s_branch L_k1_c_ffn
L_sk_5034:
    v_mfma_f32_16x16x32_bf16 v[128:131], v[24:27], v[56:59], v[128:131]
    v_mfma_f32_16x16x32_bf16 v[132:135], v[28:31], v[56:59], v[132:135]
    s_waitcnt lgkmcnt(11)
    v_mfma_f32_16x16x32_bf16 v[116:119], v[28:31], v[60:63], v[116:119]
    ds_read_b128 v[56:59], v87 offset:45056
    v_mfma_f32_16x16x32_bf16 v[112:115], v[24:27], v[60:63], v[112:115]
    v_mfma_f32_16x16x32_bf16 v[108:111], v[20:23], v[60:63], v[108:111]
    v_mfma_f32_16x16x32_bf16 v[104:107], v[16:19], v[60:63], v[104:107]
    s_waitcnt lgkmcnt(11)
    s_barrier
    v_mfma_f32_16x16x32_bf16 v[88:91], v[16:19], v[64:67], v[88:91]
    ds_read_b128 v[60:63], v87 offset:47104
    v_mfma_f32_16x16x32_bf16 v[92:95], v[20:23], v[64:67], v[92:95]
    v_mfma_f32_16x16x32_bf16 v[96:99], v[24:27], v[64:67], v[96:99]
    v_mfma_f32_16x16x32_bf16 v[100:103], v[28:31], v[64:67], v[100:103]
    ds_read_b128 v[64:67], v87 offset:49152
    s_waitcnt lgkmcnt(3)
    v_mfma_f32_16x16x32_bf16 v[152:155], v[32:35], v[48:51], v[152:155]
    ds_read_b64_tr_b16 v[16:17], v6 offset:0
    v_mfma_f32_16x16x32_bf16 v[156:159], v[36:39], v[48:51], v[156:159]
    ds_read_b64_tr_b16 v[18:19], v6 offset:512
    v_mfma_f32_16x16x32_bf16 v[160:163], v[40:43], v[48:51], v[160:163]
    ds_read_b64_tr_b16 v[20:21], v7 offset:0
    v_mfma_f32_16x16x32_bf16 v[164:167], v[44:47], v[48:51], v[164:167]
    ds_read_b64_tr_b16 v[22:23], v7 offset:512
    v_mfma_f32_16x16x32_bf16 v[148:151], v[44:47], v[52:55], v[148:151]
    ds_read_b128 v[48:51], v86 offset:0
    v_mfma_f32_16x16x32_bf16 v[144:147], v[40:43], v[52:55], v[144:147]
    ds_read_b64_tr_b16 v[24:25], v6 offset:8192
    v_mfma_f32_16x16x32_bf16 v[140:143], v[36:39], v[52:55], v[140:143]
    ds_read_b64_tr_b16 v[26:27], v6 offset:8704
    v_mfma_f32_16x16x32_bf16 v[136:139], v[32:35], v[52:55], v[136:139]
    ds_read_b64_tr_b16 v[28:29], v7 offset:8192
    s_waitcnt lgkmcnt(10)
    v_mfma_f32_16x16x32_bf16 v[120:123], v[32:35], v[56:59], v[120:123]
    ds_read_b128 v[52:55], v86 offset:2048
    v_mfma_f32_16x16x32_bf16 v[124:127], v[36:39], v[56:59], v[124:127]
    ds_read_b64_tr_b16 v[30:31], v7 offset:8704
    v_mfma_f32_16x16x32_bf16 v[128:131], v[40:43], v[56:59], v[128:131]
    v_mfma_f32_16x16x32_bf16 v[132:135], v[44:47], v[56:59], v[132:135]
    s_waitcnt lgkmcnt(11)
    v_mfma_f32_16x16x32_bf16 v[116:119], v[44:47], v[60:63], v[116:119]
    ds_read_b128 v[56:59], v86 offset:4096
    v_mfma_f32_16x16x32_bf16 v[112:115], v[40:43], v[60:63], v[112:115]
    v_mfma_f32_16x16x32_bf16 v[108:111], v[36:39], v[60:63], v[108:111]
    v_mfma_f32_16x16x32_bf16 v[104:107], v[32:35], v[60:63], v[104:107]
    s_waitcnt lgkmcnt(11)
    s_barrier
    v_mfma_f32_16x16x32_bf16 v[88:91], v[32:35], v[64:67], v[88:91]
    ds_read_b128 v[60:63], v86 offset:6144
    v_mfma_f32_16x16x32_bf16 v[92:95], v[36:39], v[64:67], v[92:95]
    v_mfma_f32_16x16x32_bf16 v[96:99], v[40:43], v[64:67], v[96:99]
    v_mfma_f32_16x16x32_bf16 v[100:103], v[44:47], v[64:67], v[100:103]
    ds_read_b128 v[64:67], v86 offset:8192
    s_branch L_sk_5092
L_gp_6:
    s_branch L_k1_c_qkv
L_sk_5092:
    s_waitcnt lgkmcnt(8)
    v_mfma_f32_16x16x32_bf16 v[152:155], v[16:19], v[48:51], v[152:155]
    ds_read_b128 v[70:73], v87 offset:0
    ds_read_b64_tr_b16 v[32:33], v6 offset:16384
    v_mfma_f32_16x16x32_bf16 v[156:159], v[20:23], v[48:51], v[156:159]
    ds_read_b64_tr_b16 v[34:35], v6 offset:16896
    ds_read_b64_tr_b16 v[36:37], v7 offset:16384
    s_waitcnt lgkmcnt(10)
    v_mfma_f32_16x16x32_bf16 v[160:163], v[24:27], v[48:51], v[160:163]
    ds_read_b64_tr_b16 v[38:39], v7 offset:16896
    ds_read_b64_tr_b16 v[40:41], v6 offset:24576
    s_waitcnt lgkmcnt(9)
    v_mfma_f32_16x16x32_bf16 v[164:167], v[28:31], v[48:51], v[164:167]
    ds_read_b64_tr_b16 v[42:43], v6 offset:25088
    ds_read_b64_tr_b16 v[44:45], v7 offset:24576
    v_mfma_f32_16x16x32_bf16 v[136:139], v[16:19], v[52:55], v[136:139]
    ds_read_b64_tr_b16 v[46:47], v7 offset:25088
    ds_read_b128 v[74:77], v87 offset:2048
    v_mfma_f32_16x16x32_bf16 v[140:143], v[20:23], v[52:55], v[140:143]
    ds_read_b128 v[78:81], v87 offset:4096
    ds_read_b128 v[82:85], v87 offset:6144
    v_mfma_f32_16x16x32_bf16 v[144:147], v[24:27], v[52:55], v[144:147]
    v_mov_b32 v68, 0xc0135761
    v_mov_b32 v69, 0xc0135761
    s_mov_b32 s60, 0xbdd2d3e8
    s_mov_b32 s61, 0xbdd2d3e8
    s_mov_b32 s62, 1.0
    s_mov_b32 s63, 1.0
    s_cmp_lt_u32 s36, 4
    s_mov_b32 s65, 118848
    s_cselect_b32 s65, 59456, s65
    s_mul_i32 s66, s36, 5120
    s_add_u32 s66, s66, s65
    v_add_u32 v5, s66, v2
    v_mov_b32 v10, 161040
    v_mfma_f32_16x16x32_bf16 v[148:151], v[28:31], v[52:55], v[148:151]
    s_waitcnt lgkmcnt(9)
    v_mfma_f32_16x16x32_bf16 v[152:155], v[32:35], v[70:73], v[152:155]
    s_waitcnt lgkmcnt(7)
    v_mfma_f32_16x16x32_bf16 v[156:159], v[36:39], v[70:73], v[156:159]
    s_waitcnt lgkmcnt(5)
    v_mfma_f32_16x16x32_bf16 v[160:163], v[40:43], v[70:73], v[160:163]
    s_waitcnt lgkmcnt(3)
    v_mfma_f32_16x16x32_bf16 v[164:167], v[44:47], v[70:73], v[164:167]
    s_waitcnt lgkmcnt(2)
    v_mfma_f32_16x16x32_bf16 v[136:139], v[32:35], v[74:77], v[136:139]
    v_mfma_f32_16x16x32_bf16 v[140:143], v[36:39], v[74:77], v[140:143]
    v_pk_mul_f32 v[48:49], v[152:153], v[152:153]
    v_pk_mul_f32 v[50:51], v[154:155], v[154:155]
    v_pk_mul_f32 v[52:53], v[156:157], v[156:157]
    v_pk_mul_f32 v[54:55], v[158:159], v[158:159]
    v_pk_fma_f32 v[48:49], v[48:49], s[60:61], v[68:69]
    v_mfma_f32_16x16x32_bf16 v[144:147], v[40:43], v[74:77], v[144:147]
    v_pk_fma_f32 v[50:51], v[50:51], s[60:61], v[68:69]
    v_pk_fma_f32 v[52:53], v[52:53], s[60:61], v[68:69]
    v_pk_fma_f32 v[54:55], v[54:55], s[60:61], v[68:69]
    v_pk_mul_f32 v[48:49], v[48:49], v[152:153]
    v_pk_mul_f32 v[50:51], v[50:51], v[154:155]
    v_mfma_f32_16x16x32_bf16 v[148:151], v[44:47], v[74:77], v[148:151]
    v_pk_mul_f32 v[52:53], v[52:53], v[156:157]
    v_pk_mul_f32 v[54:55], v[54:55], v[158:159]
    v_exp_f32 v48, v48
    v_exp_f32 v49, v49
    v_exp_f32 v50, v50
    v_mfma_f32_16x16x32_bf16 v[120:123], v[16:19], v[56:59], v[120:123]
    v_exp_f32 v51, v51
    v_exp_f32 v52, v52
    v_exp_f32 v53, v53
    v_exp_f32 v54, v54
    v_exp_f32 v55, v55
    v_mfma_f32_16x16x32_bf16 v[124:127], v[20:23], v[56:59], v[124:127]
    v_pk_mul_f32 v[152:153], v[152:153], v[160:161]
    v_pk_mul_f32 v[154:155], v[154:155], v[162:163]
    v_pk_mul_f32 v[156:157], v[156:157], v[164:165]
    v_pk_mul_f32 v[158:159], v[158:159], v[166:167]
    v_pk_add_f32 v[48:49], v[48:49], s[62:63]
    v_mfma_f32_16x16x32_bf16 v[128:131], v[24:27], v[56:59], v[128:131]
    v_pk_add_f32 v[50:51], v[50:51], s[62:63]
    v_pk_add_f32 v[52:53], v[52:53], s[62:63]
    v_pk_add_f32 v[54:55], v[54:55], s[62:63]
    v_rcp_f32 v48, v48
    v_rcp_f32 v49, v49
    v_mfma_f32_16x16x32_bf16 v[132:135], v[28:31], v[56:59], v[132:135]
    ds_read_b128 v[56:59], v87 offset:8192
    v_rcp_f32 v50, v50
    v_rcp_f32 v51, v51
    v_rcp_f32 v52, v52
    v_rcp_f32 v53, v53
    v_rcp_f32 v54, v54
    s_waitcnt lgkmcnt(2)
    v_mfma_f32_16x16x32_bf16 v[120:123], v[32:35], v[78:81], v[120:123]
    v_rcp_f32 v55, v55
    v_pk_mul_f32 v[152:153], v[152:153], v[48:49]
    v_pk_mul_f32 v[154:155], v[154:155], v[50:51]
    v_pk_mul_f32 v[156:157], v[156:157], v[52:53]
    v_pk_mul_f32 v[158:159], v[158:159], v[54:55]
    v_mfma_f32_16x16x32_bf16 v[124:127], v[36:39], v[78:81], v[124:127]
    v_cvt_pk_bf16_f32 v152, v152, v153
    v_cvt_pk_bf16_f32 v153, v154, v155
    v_cvt_pk_bf16_f32 v154, v156, v157
    v_cvt_pk_bf16_f32 v155, v158, v159
    ds_write_b128 v5, v[152:155] offset:0
    v_mfma_f32_16x16x32_bf16 v[128:131], v[40:43], v[78:81], v[128:131]
    v_pk_mul_f32 v[48:49], v[136:137], v[136:137]
    v_pk_mul_f32 v[50:51], v[138:139], v[138:139]
    v_pk_mul_f32 v[52:53], v[140:141], v[140:141]
    v_pk_mul_f32 v[54:55], v[142:143], v[142:143]
    v_pk_fma_f32 v[48:49], v[48:49], s[60:61], v[68:69]
    v_mfma_f32_16x16x32_bf16 v[132:135], v[44:47], v[78:81], v[132:135]
    v_pk_fma_f32 v[50:51], v[50:51], s[60:61], v[68:69]
    v_pk_fma_f32 v[52:53], v[52:53], s[60:61], v[68:69]
    v_pk_fma_f32 v[54:55], v[54:55], s[60:61], v[68:69]
    v_pk_mul_f32 v[48:49], v[48:49], v[136:137]
    v_pk_mul_f32 v[50:51], v[50:51], v[138:139]
    v_mfma_f32_16x16x32_bf16 v[104:107], v[16:19], v[60:63], v[104:107]
    v_pk_mul_f32 v[52:53], v[52:53], v[140:141]
    v_pk_mul_f32 v[54:55], v[54:55], v[142:143]
    v_exp_f32 v48, v48
    v_exp_f32 v49, v49
    v_exp_f32 v50, v50
    v_mfma_f32_16x16x32_bf16 v[108:111], v[20:23], v[60:63], v[108:111]
    v_exp_f32 v51, v51
    v_exp_f32 v52, v52
    v_exp_f32 v53, v53
    v_exp_f32 v54, v54
    v_exp_f32 v55, v55
    v_mfma_f32_16x16x32_bf16 v[112:115], v[24:27], v[60:63], v[112:115]
    v_pk_mul_f32 v[136:137], v[136:137], v[144:145]
    v_pk_mul_f32 v[138:139], v[138:139], v[146:147]
    v_pk_mul_f32 v[140:141], v[140:141], v[148:149]
    v_pk_mul_f32 v[142:143], v[142:143], v[150:151]
    v_pk_add_f32 v[48:49], v[48:49], s[62:63]
    v_mfma_f32_16x16x32_bf16 v[116:119], v[28:31], v[60:63], v[116:119]
    v_pk_add_f32 v[50:51], v[50:51], s[62:63]
    v_pk_add_f32 v[52:53], v[52:53], s[62:63]
    v_pk_add_f32 v[54:55], v[54:55], s[62:63]
    v_rcp_f32 v48, v48
    v_rcp_f32 v49, v49
    s_waitcnt lgkmcnt(2)
    v_mfma_f32_16x16x32_bf16 v[104:107], v[32:35], v[82:85], v[104:107]
    v_rcp_f32 v50, v50
    v_rcp_f32 v51, v51
    v_rcp_f32 v52, v52
    v_rcp_f32 v53, v53
    v_rcp_f32 v54, v54
    v_mfma_f32_16x16x32_bf16 v[108:111], v[36:39], v[82:85], v[108:111]
    v_rcp_f32 v55, v55
    v_pk_mul_f32 v[136:137], v[136:137], v[48:49]
    v_pk_mul_f32 v[138:139], v[138:139], v[50:51]
    v_pk_mul_f32 v[140:141], v[140:141], v[52:53]
    v_pk_mul_f32 v[142:143], v[142:143], v[54:55]
    v_mfma_f32_16x16x32_bf16 v[112:115], v[40:43], v[82:85], v[112:115]
    v_cvt_pk_bf16_f32 v136, v136, v137
    v_cvt_pk_bf16_f32 v137, v138, v139
    v_cvt_pk_bf16_f32 v138, v140, v141
    s_branch L_sk_5251
L_gp_7:
    s_branch L_k1_c_qkv
L_sk_5251:
    v_cvt_pk_bf16_f32 v139, v142, v143
    ds_write_b128 v5, v[136:139] offset:1024
    v_mfma_f32_16x16x32_bf16 v[116:119], v[44:47], v[82:85], v[116:119]
    v_pk_mul_f32 v[48:49], v[120:121], v[120:121]
    v_pk_mul_f32 v[50:51], v[122:123], v[122:123]
    v_pk_mul_f32 v[52:53], v[124:125], v[124:125]
    v_pk_mul_f32 v[54:55], v[126:127], v[126:127]
    v_pk_fma_f32 v[48:49], v[48:49], s[60:61], v[68:69]
    v_mfma_f32_16x16x32_bf16 v[88:91], v[16:19], v[64:67], v[88:91]
    v_pk_fma_f32 v[50:51], v[50:51], s[60:61], v[68:69]
    v_pk_fma_f32 v[52:53], v[52:53], s[60:61], v[68:69]
    v_pk_fma_f32 v[54:55], v[54:55], s[60:61], v[68:69]
    v_pk_mul_f32 v[48:49], v[48:49], v[120:121]
    v_pk_mul_f32 v[50:51], v[50:51], v[122:123]
    v_mfma_f32_16x16x32_bf16 v[92:95], v[20:23], v[64:67], v[92:95]
    v_pk_mul_f32 v[52:53], v[52:53], v[124:125]
    v_pk_mul_f32 v[54:55], v[54:55], v[126:127]
    v_exp_f32 v48, v48
    v_exp_f32 v49, v49
    v_exp_f32 v50, v50
    v_mfma_f32_16x16x32_bf16 v[96:99], v[24:27], v[64:67], v[96:99]
    v_exp_f32 v51, v51
    v_exp_f32 v52, v52
    v_exp_f32 v53, v53
    v_exp_f32 v54, v54
    v_exp_f32 v55, v55
    v_mfma_f32_16x16x32_bf16 v[100:103], v[28:31], v[64:67], v[100:103]
    v_pk_mul_f32 v[120:121], v[120:121], v[128:129]
    v_pk_mul_f32 v[122:123], v[122:123], v[130:131]
    v_pk_mul_f32 v[124:125], v[124:125], v[132:133]
    v_pk_mul_f32 v[126:127], v[126:127], v[134:135]
    v_pk_add_f32 v[48:49], v[48:49], s[62:63]
    s_waitcnt lgkmcnt(2)
    v_mfma_f32_16x16x32_bf16 v[88:91], v[32:35], v[56:59], v[88:91]
    v_pk_add_f32 v[50:51], v[50:51], s[62:63]
    v_pk_add_f32 v[52:53], v[52:53], s[62:63]
    v_pk_add_f32 v[54:55], v[54:55], s[62:63]
    v_rcp_f32 v48, v48
    v_rcp_f32 v49, v49
    v_mfma_f32_16x16x32_bf16 v[92:95], v[36:39], v[56:59], v[92:95]
    v_rcp_f32 v50, v50
    v_rcp_f32 v51, v51
    v_rcp_f32 v52, v52
    v_rcp_f32 v53, v53
    v_rcp_f32 v54, v54
    v_mfma_f32_16x16x32_bf16 v[96:99], v[40:43], v[56:59], v[96:99]
    v_rcp_f32 v55, v55
    v_pk_mul_f32 v[120:121], v[120:121], v[48:49]
    v_pk_mul_f32 v[122:123], v[122:123], v[50:51]
    v_pk_mul_f32 v[124:125], v[124:125], v[52:53]
    v_pk_mul_f32 v[126:127], v[126:127], v[54:55]
    v_mfma_f32_16x16x32_bf16 v[100:103], v[44:47], v[56:59], v[100:103]
    v_cvt_pk_bf16_f32 v120, v120, v121
    v_cvt_pk_bf16_f32 v121, v122, v123
    v_cvt_pk_bf16_f32 v122, v124, v125
    v_cvt_pk_bf16_f32 v123, v126, v127
    ds_write_b128 v5, v[120:123] offset:2048
    v_pk_mul_f32 v[48:49], v[104:105], v[104:105]
    v_pk_mul_f32 v[50:51], v[106:107], v[106:107]
    v_pk_mul_f32 v[52:53], v[108:109], v[108:109]
    v_pk_mul_f32 v[54:55], v[110:111], v[110:111]
    v_pk_fma_f32 v[48:49], v[48:49], s[60:61], v[68:69]
    v_pk_fma_f32 v[50:51], v[50:51], s[60:61], v[68:69]
    v_pk_fma_f32 v[52:53], v[52:53], s[60:61], v[68:69]
    v_pk_fma_f32 v[54:55], v[54:55], s[60:61], v[68:69]
    v_pk_mul_f32 v[48:49], v[48:49], v[104:105]
    v_pk_mul_f32 v[50:51], v[50:51], v[106:107]
    v_pk_mul_f32 v[52:53], v[52:53], v[108:109]
    v_pk_mul_f32 v[54:55], v[54:55], v[110:111]
    v_exp_f32 v48, v48
    v_exp_f32 v49, v49
    v_exp_f32 v50, v50
    v_exp_f32 v51, v51
    v_exp_f32 v52, v52
    v_exp_f32 v53, v53
    v_exp_f32 v54, v54
    v_exp_f32 v55, v55
    v_pk_mul_f32 v[104:105], v[104:105], v[112:113]
    v_pk_mul_f32 v[106:107], v[106:107], v[114:115]
    v_pk_mul_f32 v[108:109], v[108:109], v[116:117]
    v_pk_mul_f32 v[110:111], v[110:111], v[118:119]
    v_pk_add_f32 v[48:49], v[48:49], s[62:63]
    v_pk_add_f32 v[50:51], v[50:51], s[62:63]
    v_pk_add_f32 v[52:53], v[52:53], s[62:63]
    v_pk_add_f32 v[54:55], v[54:55], s[62:63]
    v_rcp_f32 v48, v48
    v_rcp_f32 v49, v49
    v_rcp_f32 v50, v50
    v_rcp_f32 v51, v51
    v_rcp_f32 v52, v52
    v_rcp_f32 v53, v53
    v_rcp_f32 v54, v54
    v_rcp_f32 v55, v55
    v_pk_mul_f32 v[104:105], v[104:105], v[48:49]
    v_pk_mul_f32 v[106:107], v[106:107], v[50:51]
    v_pk_mul_f32 v[108:109], v[108:109], v[52:53]
    v_pk_mul_f32 v[110:111], v[110:111], v[54:55]
    v_cvt_pk_bf16_f32 v104, v104, v105
    v_cvt_pk_bf16_f32 v105, v106, v107
    v_cvt_pk_bf16_f32 v106, v108, v109
    v_cvt_pk_bf16_f32 v107, v110, v111
    ds_write_b128 v5, v[104:107] offset:3072
    s_nop 7
    v_pk_mul_f32 v[48:49], v[88:89], v[88:89]
    v_pk_mul_f32 v[50:51], v[90:91], v[90:91]
    v_pk_mul_f32 v[52:53], v[92:93], v[92:93]
    v_pk_mul_f32 v[54:55], v[94:95], v[94:95]
    v_pk_fma_f32 v[48:49], v[48:49], s[60:61], v[68:69]
    v_pk_fma_f32 v[50:51], v[50:51], s[60:61], v[68:69]
    v_pk_fma_f32 v[52:53], v[52:53], s[60:61], v[68:69]
    v_pk_fma_f32 v[54:55], v[54:55], s[60:61], v[68:69]
    v_pk_mul_f32 v[48:49], v[48:49], v[88:89]
    v_pk_mul_f32 v[50:51], v[50:51], v[90:91]
    v_pk_mul_f32 v[52:53], v[52:53], v[92:93]
    v_pk_mul_f32 v[54:55], v[54:55], v[94:95]
    v_exp_f32 v48, v48
    v_exp_f32 v49, v49
    v_exp_f32 v50, v50
    v_exp_f32 v51, v51
    v_exp_f32 v52, v52
    v_exp_f32 v53, v53
    v_exp_f32 v54, v54
    v_exp_f32 v55, v55
    v_pk_mul_f32 v[88:89], v[88:89], v[96:97]
    v_pk_mul_f32 v[90:91], v[90:91], v[98:99]
    v_pk_mul_f32 v[92:93], v[92:93], v[100:101]
    v_pk_mul_f32 v[94:95], v[94:95], v[102:103]
    v_pk_add_f32 v[48:49], v[48:49], s[62:63]
    v_pk_add_f32 v[50:51], v[50:51], s[62:63]
    v_pk_add_f32 v[52:53], v[52:53], s[62:63]
    v_pk_add_f32 v[54:55], v[54:55], s[62:63]
    v_rcp_f32 v48, v48
    v_rcp_f32 v49, v49
    v_rcp_f32 v50, v50
    v_rcp_f32 v51, v51
    v_rcp_f32 v52, v52
    v_rcp_f32 v53, v53
    v_rcp_f32 v54, v54
    v_rcp_f32 v55, v55
    v_pk_mul_f32 v[88:89], v[88:89], v[48:49]
    v_pk_mul_f32 v[90:91], v[90:91], v[50:51]
    v_pk_mul_f32 v[92:93], v[92:93], v[52:53]
    v_pk_mul_f32 v[94:95], v[94:95], v[54:55]
    v_cvt_pk_bf16_f32 v88, v88, v89
    v_cvt_pk_bf16_f32 v89, v90, v91
    v_cvt_pk_bf16_f32 v90, v92, v93
    v_cvt_pk_bf16_f32 v91, v94, v95
    ds_write_b128 v5, v[88:91] offset:4096
    s_waitcnt lgkmcnt(0)
    s_branch L_noflag
L_pad_att_0:
    s_branch L_pad_att_4
L_gp_8:
    s_branch L_k1_c_qkv
L_cdone:
    v_mov_b32 v69, 161044
    s_mov_b64 exec, 1
    s_waitcnt vmcnt(0)
    ds_add_u32 v69, v69 offset:4
    s_mov_b64 exec, -1
L_noflag:
    s_cmp_lg_u32 s15, 0
    s_cbranch_scc0 L_led
    v_mov_b32 v48, 0x3f803f80
    v_mov_b32 v49, 0x00003f80
    v_mov_b32 v50, 0x3f803f80
    v_mov_b32 v51, 0x00003f80
    s_mov_b32 vcc_lo, 0x00100000
    s_mov_b32 vcc_hi, 0x00100000
    v_mov_b32 v53, 0x3f803f80
    v_cndmask_b32 v52, 0, v53, vcc
    v_cndmask_b32 v53, 0, v53, vcc
    v_mov_b64 v[54:55], v[52:53]
    v_mov_b64 v[56:57], v[52:53]
    v_mov_b64 v[58:59], v[52:53]
    v_mov_b64 v[60:61], v[52:53]
    v_mov_b64 v[62:63], v[52:53]
    v_mov_b64 v[64:65], v[52:53]
    v_mov_b64 v[66:67], v[52:53]
    v_mov_b32 v5, 0xdddddddd
    v_mov_b64 v[84:85], 0
    v_mov_b64 v[74:75], 0
    v_mov_b64 v[32:33], 0
    v_mov_b64 v[34:35], 0
    v_mov_b64 v[36:37], 0
    v_mov_b64 v[38:39], 0
    v_mov_b32 v0, 0x3f803f80
    v_mov_b32 v1, 0x00003f80
    s_mov_b32 vcc_lo, 0x00100000
    s_mov_b32 vcc_hi, 0x00100000
    v_mov_b32 v7, 0x3f803f80
    v_cndmask_b32 v6, 0, v7, vcc
    v_cndmask_b32 v7, 0, v7, vcc
    v_mov_b64 v[8:9], v[6:7]
    v_mov_b64 v[164:165], v[6:7]
    v_mov_b64 v[166:167], v[6:7]
    s_mov_b32 s51, 0x100000
    v_mov_b32 v11, 161040
L_le:
    ds_read_b32 v10, v11
    s_waitcnt lgkmcnt(0)
    v_readfirstlane_b32 s14, v10
    s_cmp_lg_u32 s14, 0
    s_cbranch_scc1 L_le1
    s_sleep 1
    s_sub_u32 s51, s51, 1
    s_cbranch_scc0 L_le
L_le1:
    buffer_load_dwordx4 v[70:73], v14, s[56:59], s40 offen sc1
    buffer_load_dwordx4 v[16:19], v2, s[28:31], s45 offen sc1
    buffer_load_dwordx4 v[20:23], v2, s[28:31], s46 offen sc1
    buffer_load_dwordx4 v[24:27], v2, s[28:31], s47 offen sc1
    buffer_load_dwordx4 v[28:31], v2, s[28:31], s48 offen sc1
    s_mov_b64 exec, s[20:21]
    buffer_load_dwordx2 v[74:75], v3, s[56:59], s40 offen offset:1024 sc1
    buffer_load_dwordx2 v[32:33], v15, s[28:31], s45 offen offset:1024 sc1
    buffer_load_dwordx2 v[34:35], v15, s[28:31], s46 offen offset:1024 sc1
    buffer_load_dwordx2 v[36:37], v15, s[28:31], s47 offen offset:1024 sc1
    buffer_load_dwordx2 v[38:39], v15, s[28:31], s48 offen offset:1024 sc1
    buffer_load_dwordx2 v[0:1], v3, s[56:59], s41 offen offset:1024 sc1
    s_mov_b64 exec, -1
    buffer_load_dwordx4 v[10:13], v14, s[56:59], s41 offen offset:0 sc1
    s_mov_b64 exec, s[22:23]
    buffer_load_dwordx4 v[6:9], v4, s[56:59], s41 offen offset:1280 sc1
    buffer_load_dwordx4 v[164:167], v4, s[56:59], s41 offen offset:1408 sc1
    s_mov_b64 exec, -1
L_led:
    s_setprio 1
    s_cmp_lt_u32 s36, 4
    s_cbranch_scc1 L_apy
    s_setprio 2
L_apy:
    s_barrier
    s_cmp_lt_u32 s36, 4
    s_cbranch_scc1 L_q2b
    s_mov_b32 m0, s54
    s_nop 0
    buffer_load_dwordx4 v2, s[28:31], s52 offen offset:2048 sc1 lds
    buffer_load_dwordx4 v2, s[28:31], s52 offen offset:3072 sc1 lds
    s_add_u32 m0, s54, 4096
    s_nop 0
    buffer_load_dwordx4 v2, s[28:31], s53 offen sc1 lds
    s_add_u32 m0, s54, 7680
    s_nop 0
    buffer_load_dwordx4 v2, s[28:31], s48 offen sc1 lds
    s_mov_b64 exec, 0xffff
    buffer_load_dwordx4 v2, s[28:31], s48 offen offset:1024 sc1 lds
    s_mov_b64 exec, -1
    s_mov_b32 m0, s54
    s_nop 0
    buffer_load_dwordx4 v2, s[28:31], s52 offen sc1 lds
    buffer_load_dwordx4 v2, s[28:31], s52 offen offset:1024 sc1 lds
    s_setprio 1
    v_mov_b32 v48, 0x3f803f80
    v_mov_b32 v49, 0x00003f80
    v_mov_b32 v50, 0x3f803f80
    v_mov_b32 v51, 0x00003f80
    s_mov_b32 vcc_lo, 0x00100000
    s_mov_b32 vcc_hi, 0x00100000
    v_mov_b32 v53, 0x3f803f80
    v_cndmask_b32 v52, 0, v53, vcc
    v_cndmask_b32 v53, 0, v53, vcc
    v_mov_b64 v[54:55], v[52:53]
    v_mov_b64 v[56:57], v[52:53]
    v_mov_b64 v[58:59], v[52:53]
    v_mov_b64 v[60:61], v[52:53]
    v_mov_b64 v[62:63], v[52:53]
    v_mov_b64 v[64:65], v[52:53]
    v_mov_b64 v[66:67], v[52:53]
    v_mov_b32 v5, 0xdddddddd
    v_mov_b64 v[84:85], 0
    v_mov_b64 v[74:75], 0
    v_mov_b64 v[32:33], 0
    v_mov_b64 v[34:35], 0
    v_mov_b64 v[36:37], 0
    v_mov_b64 v[38:39], 0
    v_mov_b32 v0, 0x3f803f80
    v_mov_b32 v1, 0x00003f80
    s_mov_b32 vcc_lo, 0x00100000
    s_mov_b32 vcc_hi, 0x00100000
    v_mov_b32 v7, 0x3f803f80
    v_cndmask_b32 v6, 0, v7, vcc
    v_cndmask_b32 v7, 0, v7, vcc
    v_mov_b64 v[8:9], v[6:7]
    v_mov_b64 v[164:165], v[6:7]
    v_mov_b64 v[166:167], v[6:7]
    v_add_u32 v88, s16, v2
    v_add_u32 v92, s16, v15
    v_add_u32 v89, s17, v2
    v_add_u32 v93, s17, v15
    v_add_u32 v90, s18, v2
    v_add_u32 v94, s18, v15
    v_add_u32 v91, s19, v2
    v_add_u32 v95, s19, v15
    v_subrev_u32 v96, s19, v14
    v_subrev_u32 v97, s19, v3
    s_waitcnt vmcnt(0)
    s_barrier
    ds_read_b128 v[70:73], v96
    ds_read_b128 v[16:19], v88 offset:7744
    ds_read_b128 v[20:23], v89 offset:7744
    ds_read_b128 v[24:27], v90 offset:7744
    ds_read_b128 v[28:31], v91 offset:7744
    s_mov_b64 exec, s[20:21]
    ds_read_b64 v[74:75], v97 offset:1024
    ds_read_b64 v[32:33], v92 offset:8768
    ds_read_b64 v[34:35], v93 offset:8768
    ds_read_b64 v[36:37], v94 offset:8768
    ds_read_b64 v[38:39], v95 offset:8768
    ds_read_b64 v[0:1], v3 offset:1024
    s_mov_b64 exec, -1
    ds_read_b128 v[10:13], v14 offset:0
    s_mov_b64 exec, s[22:23]
    ds_read_b128 v[6:9], v4 offset:1280
    ds_read_b128 v[164:167], v4 offset:1408
    s_mov_b64 exec, -1
L_q2b:
    s_add_u32 s45, s16, s27
    s_add_u32 s46, s17, s27
    s_add_u32 s47, s18, s27
    s_add_u32 s48, s19, s27
    s_lshl_b32 s52, 1, s37
    s_mov_b32 s53, 0
    s_waitcnt vmcnt(12) lgkmcnt(12)
    v_mfma_f32_32x32x16_bf16 v[100:115], v[70:73], v[16:19], 0
    s_waitcnt vmcnt(11) lgkmcnt(11)
    v_mfma_f32_32x32x16_bf16 v[116:131], v[70:73], v[20:23], 0
    s_waitcnt vmcnt(10) lgkmcnt(10)
    v_mfma_f32_32x32x16_bf16 v[132:147], v[70:73], v[24:27], 0
    s_waitcnt vmcnt(9) lgkmcnt(9)
    v_mfma_f32_32x32x16_bf16 v[148:163], v[70:73], v[28:31], 0
    s_waitcnt vmcnt(7) lgkmcnt(7)
    v_mfma_f32_32x32x8_bf16 v[100:115], v[74:75], v[32:33], v[100:115]
    s_waitcnt vmcnt(6) lgkmcnt(6)
    v_mfma_f32_32x32x8_bf16 v[116:131], v[74:75], v[34:35], v[116:131]
    s_waitcnt vmcnt(5) lgkmcnt(5)
    v_mfma_f32_32x32x8_bf16 v[132:147], v[74:75], v[36:37], v[132:147]
    s_waitcnt vmcnt(4) lgkmcnt(4)
    v_mfma_f32_32x32x8_bf16 v[148:163], v[74:75], v[38:39], v[148:163]
    s_nop 7
    s_mov_b64 exec, s[24:25]
    v_max3_f32 v15, v100, v101, v102
    v_max3_f32 v15, v15, v103, v104
    s_branch L_sk_5598
L_pad_att_1:
    s_branch L_pad_att_5
L_gp_9:
    s_branch L_k1_c_qkv
L_sk_5598:
    v_max3_f32 v15, v15, v105, v106
    v_max3_f32 v15, v15, v107, v108
    v_max3_f32 v15, v15, v109, v110
    v_max3_f32 v15, v15, v111, v112
    v_max3_f32 v15, v15, v113, v114
    v_max_f32 v15, v15, v115
    v_cvt_pk_bf16_f32 v32, -v15, 0
    s_mov_b64 exec, -1
    s_waitcnt vmcnt(2) lgkmcnt(2)
    v_mfma_f32_32x32x16_bf16 v[68:83], v[10:13], v[16:19], 0
    v_mfma_f32_32x32x8_bf16 v[68:83], v[0:1], v[32:33], v[68:83]
    v_mfma_f32_32x32x8_bf16 v[100:115], v[84:85], v[84:85], 0
    s_mov_b64 exec, s[24:25]
    v_max3_f32 v15, v116, v117, v118
    v_max3_f32 v15, v15, v119, v120
    v_max3_f32 v15, v15, v121, v122
    v_max3_f32 v15, v15, v123, v124
    v_max3_f32 v15, v15, v125, v126
    v_max3_f32 v15, v15, v127, v128
    v_max3_f32 v15, v15, v129, v130
    v_max_f32 v15, v15, v131
    v_cvt_pk_bf16_f32 v34, -v15, 0
    s_mov_b64 exec, -1
    v_mfma_f32_32x32x8_bf16 v[116:131], v[84:85], v[84:85], 0
    s_mov_b64 exec, s[24:25]
    v_max3_f32 v15, v132, v133, v134
    v_max3_f32 v15, v15, v135, v136
    v_max3_f32 v15, v15, v137, v138
    v_max3_f32 v15, v15, v139, v140
    v_max3_f32 v15, v15, v141, v142
    v_max3_f32 v15, v15, v143, v144
    v_max3_f32 v15, v15, v145, v146
    v_max_f32 v15, v15, v147
    v_cvt_pk_bf16_f32 v36, -v15, 0
    s_mov_b64 exec, -1
    v_mfma_f32_32x32x8_bf16 v[132:147], v[84:85], v[84:85], 0
    s_mov_b64 exec, s[24:25]
    s_nop 3
    v_max3_f32 v15, v148, v149, v150
    v_max3_f32 v15, v15, v151, v152
    v_max3_f32 v15, v15, v153, v154
    v_max3_f32 v15, v15, v155, v156
    v_max3_f32 v15, v15, v157, v158
    v_max3_f32 v15, v15, v159, v160
    v_max3_f32 v15, v15, v161, v162
    v_max_f32 v15, v15, v163
    v_cvt_pk_bf16_f32 v38, -v15, 0
    s_mov_b64 exec, -1
    v_mfma_f32_32x32x8_bf16 v[148:163], v[84:85], v[84:85], 0
    s_mov_b32 s50, 0
    v_exp_f32 v68, v68
    v_exp_f32 v69, v69
    v_exp_f32 v70, v70
    v_exp_f32 v71, v71
    v_exp_f32 v72, v72
    v_exp_f32 v73, v73
    v_mfma_f32_32x32x16_bf16 v[84:99], v[10:13], v[20:23], 0
    v_exp_f32 v74, v74
    v_exp_f32 v75, v75
    v_exp_f32 v76, v76
    v_exp_f32 v77, v77
    v_mfma_f32_32x32x8_bf16 v[84:99], v[0:1], v[34:35], v[84:99]
    v_exp_f32 v78, v78
    v_exp_f32 v79, v79
    v_exp_f32 v80, v80
    v_exp_f32 v81, v81
    s_waitcnt vmcnt(0) lgkmcnt(0)
    v_smfmac_f32_32x32x32_bf16 v[100:115], v[6:9], v[68:75], v5
    v_exp_f32 v82, v82
    v_exp_f32 v83, v83
    v_exp_f32 v84, v84
    v_exp_f32 v85, v85
    v_smfmac_f32_32x32x32_bf16 v[100:115], v[164:167], v[76:83], v5
    v_exp_f32 v86, v86
    v_exp_f32 v87, v87
    v_exp_f32 v88, v88
    v_exp_f32 v89, v89
    v_mfma_f32_32x32x16_bf16 v[68:83], v[10:13], v[24:27], 0
    v_exp_f32 v90, v90
    v_exp_f32 v91, v91
    v_exp_f32 v92, v92
    v_exp_f32 v93, v93
    v_mfma_f32_32x32x8_bf16 v[68:83], v[0:1], v[36:37], v[68:83]
    v_exp_f32 v94, v94
    v_exp_f32 v95, v95
    v_exp_f32 v96, v96
    v_exp_f32 v97, v97
    v_smfmac_f32_32x32x32_bf16 v[116:131], v[6:9], v[84:91], v5
    v_exp_f32 v98, v98
    v_exp_f32 v99, v99
    v_exp_f32 v68, v68
    v_exp_f32 v69, v69
    v_smfmac_f32_32x32x32_bf16 v[116:131], v[164:167], v[92:99], v5
    s_cmp_lt_u32 s36, 4
    s_cbranch_scc0 L_r2
    s_barrier
    s_branch L_sk_5700
L_pad_att_2:
    s_branch L_pad_att_6
L_gp_10:
    s_branch L_k1_c_qkv
L_sk_5700:
L_r2:
    s_mov_b64 exec, s[22:23]
    ds_read_b128 v[52:55], v4 offset:3840
    ds_read_b128 v[56:59], v4 offset:3968
    s_mov_b64 exec, s[20:21]
    ds_read_b64 v[48:49], v3 offset:3584
    s_mov_b64 exec, -1
    ds_read_b128 v[40:43], v14 offset:2560
    v_exp_f32 v70, v70
    v_exp_f32 v71, v71
    v_exp_f32 v72, v72
    v_exp_f32 v73, v73
    v_mfma_f32_32x32x16_bf16 v[84:99], v[10:13], v[28:31], 0
    v_exp_f32 v74, v74
    v_exp_f32 v75, v75
    v_exp_f32 v76, v76
    v_exp_f32 v77, v77
    v_mfma_f32_32x32x8_bf16 v[84:99], v[0:1], v[38:39], v[84:99]
    s_mov_b64 exec, s[22:23]
    ds_read_b128 v[60:63], v4 offset:6400
    ds_read_b128 v[64:67], v4 offset:6528
    s_mov_b64 exec, s[20:21]
    ds_read_b64 v[50:51], v3 offset:6144
    s_mov_b64 exec, -1
    ds_read_b128 v[44:47], v14 offset:5120
    v_mov_b32 v15, 1
    v_exp_f32 v78, v78
    v_exp_f32 v79, v79
    v_exp_f32 v80, v80
    v_exp_f32 v81, v81
    v_smfmac_f32_32x32x32_bf16 v[132:147], v[6:9], v[68:75], v5
    v_exp_f32 v82, v82
    v_exp_f32 v83, v83
    v_exp_f32 v84, v84
    v_exp_f32 v85, v85
    v_smfmac_f32_32x32x32_bf16 v[132:147], v[164:167], v[76:83], v5
    v_exp_f32 v86, v86
    v_exp_f32 v87, v87
    v_exp_f32 v88, v88
    v_exp_f32 v89, v89
    s_waitcnt lgkmcnt(0)
    v_mfma_f32_32x32x16_bf16 v[68:83], v[40:43], v[16:19], 0
    v_exp_f32 v90, v90
    v_exp_f32 v91, v91
    v_exp_f32 v92, v92
    v_exp_f32 v93, v93
    v_mfma_f32_32x32x8_bf16 v[68:83], v[48:49], v[32:33], v[68:83]
    s_mov_b64 exec, 1
    ds_add_u32 v2, v15 offset:4
    s_mov_b64 exec, -1
    v_exp_f32 v94, v94
    v_exp_f32 v95, v95
    v_exp_f32 v96, v96
    v_exp_f32 v97, v97
    v_smfmac_f32_32x32x32_bf16 v[148:163], v[6:9], v[84:91], v5
    v_exp_f32 v98, v98
    v_exp_f32 v99, v99
    v_exp_f32 v68, v68
    v_exp_f32 v69, v69
    v_smfmac_f32_32x32x32_bf16 v[148:163], v[164:167], v[92:99], v5
    s_mov_b64 exec, s[22:23]
    buffer_load_dwordx4 v[6:9], v4, s[56:59], s42 offen offset:3840 sc1
    buffer_load_dwordx4 v[164:167], v4, s[56:59], s42 offen offset:3968 sc1
    s_mov_b64 exec, s[20:21]
    buffer_load_dwordx2 v[0:1], v3, s[56:59], s42 offen offset:3584 sc1
    s_mov_b64 exec, -1
    buffer_load_dwordx4 v[10:13], v14, s[56:59], s42 offen offset:2560 sc1
    v_exp_f32 v70, v70
    v_exp_f32 v71, v71
    v_exp_f32 v72, v72
    v_exp_f32 v73, v73
    v_mfma_f32_32x32x16_bf16 v[84:99], v[40:43], v[20:23], 0
    v_exp_f32 v74, v74
    v_exp_f32 v75, v75
    v_exp_f32 v76, v76
    v_exp_f32 v77, v77
    v_mfma_f32_32x32x8_bf16 v[84:99], v[48:49], v[34:35], v[84:99]
    v_exp_f32 v78, v78
    v_exp_f32 v79, v79
    v_exp_f32 v80, v80
    v_exp_f32 v81, v81
    v_smfmac_f32_32x32x32_bf16 v[100:115], v[52:55], v[68:75], v5
    v_exp_f32 v82, v82
    v_exp_f32 v83, v83
    v_exp_f32 v84, v84
    v_exp_f32 v85, v85
    v_smfmac_f32_32x32x32_bf16 v[100:115], v[56:59], v[76:83], v5
    v_exp_f32 v86, v86
    v_exp_f32 v87, v87
    v_exp_f32 v88, v88
    v_exp_f32 v89, v89
    v_mfma_f32_32x32x16_bf16 v[68:83], v[40:43], v[24:27], 0
    v_exp_f32 v90, v90
    v_exp_f32 v91, v91
    v_exp_f32 v92, v92
    v_exp_f32 v93, v93
    v_mfma_f32_32x32x8_bf16 v[68:83], v[48:49], v[36:37], v[68:83]
    v_exp_f32 v94, v94
    v_exp_f32 v95, v95
    v_exp_f32 v96, v96
    v_exp_f32 v97, v97
    v_smfmac_f32_32x32x32_bf16 v[116:131], v[52:55], v[84:91], v5
    v_exp_f32 v98, v98
    v_exp_f32 v99, v99
    v_exp_f32 v68, v68
    v_exp_f32 v69, v69
    v_smfmac_f32_32x32x32_bf16 v[116:131], v[56:59], v[92:99], v5
    v_exp_f32 v70, v70
    v_exp_f32 v71, v71
    v_exp_f32 v72, v72
    v_exp_f32 v73, v73
    v_mfma_f32_32x32x16_bf16 v[84:99], v[40:43], v[28:31], 0
    v_exp_f32 v74, v74
    v_exp_f32 v75, v75
    v_exp_f32 v76, v76
    v_exp_f32 v77, v77
    v_mfma_f32_32x32x8_bf16 v[84:99], v[48:49], v[38:39], v[84:99]
    ds_read_b32 v15, v2
    v_exp_f32 v78, v78
    v_exp_f32 v79, v79
    v_exp_f32 v80, v80
    v_exp_f32 v81, v81
    v_smfmac_f32_32x32x32_bf16 v[132:147], v[52:55], v[68:75], v5
    v_exp_f32 v82, v82
    v_exp_f32 v83, v83
    v_exp_f32 v84, v84
    v_exp_f32 v85, v85
    v_smfmac_f32_32x32x32_bf16 v[132:147], v[56:59], v[76:83], v5
    v_exp_f32 v86, v86
    v_exp_f32 v87, v87
    v_exp_f32 v88, v88
    v_exp_f32 v89, v89
    v_mfma_f32_32x32x16_bf16 v[68:83], v[44:47], v[16:19], 0
    v_exp_f32 v90, v90
    v_exp_f32 v91, v91
    v_exp_f32 v92, v92
    v_exp_f32 v93, v93
    v_mfma_f32_32x32x8_bf16 v[68:83], v[50:51], v[32:33], v[68:83]
    v_exp_f32 v94, v94
    v_exp_f32 v95, v95
    v_exp_f32 v96, v96
    v_exp_f32 v97, v97
    s_waitcnt lgkmcnt(0)
    v_smfmac_f32_32x32x32_bf16 v[148:163], v[52:55], v[84:91], v5
    v_exp_f32 v98, v98
    v_exp_f32 v99, v99
L_k2_loop:
    v_exp_f32 v68, v68
    v_exp_f32 v69, v69
    v_readlane_b32 s43, v15, s37
    s_add_u32 s50, s50, 1
    v_smfmac_f32_32x32x32_bf16 v[148:163], v[56:59], v[92:99], v5
    s_cmp_lt_u32 s43, s50
    s_cbranch_scc1 L_kvwb
L_kvdb:
    s_mov_b64 exec, s[52:53]
    ds_inc_u32 v2, v5 offset:8
    s_mov_b64 exec, s[22:23]
    ds_read_b128 v[52:55], v4 offset:10496
    ds_read_b128 v[56:59], v4 offset:10624
    s_mov_b64 exec, s[20:21]
    ds_read_b64 v[48:49], v3 offset:10240
    s_mov_b64 exec, -1
    ds_read_b128 v[40:43], v14 offset:9216
    v_exp_f32 v70, v70
    v_exp_f32 v71, v71
    v_exp_f32 v72, v72
    v_exp_f32 v73, v73
    v_mfma_f32_32x32x16_bf16 v[84:99], v[44:47], v[20:23], 0
    v_exp_f32 v74, v74
    v_exp_f32 v75, v75
    v_exp_f32 v76, v76
    v_exp_f32 v77, v77
    v_mfma_f32_32x32x8_bf16 v[84:99], v[50:51], v[34:35], v[84:99]
    v_exp_f32 v78, v78
    v_exp_f32 v79, v79
    v_exp_f32 v80, v80
    v_exp_f32 v81, v81
    v_smfmac_f32_32x32x32_bf16 v[100:115], v[60:63], v[68:75], v5
    v_exp_f32 v82, v82
    v_exp_f32 v83, v83
    v_exp_f32 v84, v84
    v_exp_f32 v85, v85
    v_smfmac_f32_32x32x32_bf16 v[100:115], v[64:67], v[76:83], v5
    v_exp_f32 v86, v86
    v_exp_f32 v87, v87
    v_exp_f32 v88, v88
    v_exp_f32 v89, v89
    v_mfma_f32_32x32x16_bf16 v[68:83], v[44:47], v[24:27], 0
    v_exp_f32 v90, v90
    v_exp_f32 v91, v91
    v_exp_f32 v92, v92
    v_exp_f32 v93, v93
    v_mfma_f32_32x32x8_bf16 v[68:83], v[50:51], v[36:37], v[68:83]
    v_exp_f32 v94, v94
    v_exp_f32 v95, v95
    v_exp_f32 v96, v96
    v_exp_f32 v97, v97
    v_smfmac_f32_32x32x32_bf16 v[116:131], v[60:63], v[84:91], v5
    v_exp_f32 v98, v98
    v_exp_f32 v99, v99
    v_exp_f32 v68, v68
    v_exp_f32 v69, v69
    v_smfmac_f32_32x32x32_bf16 v[116:131], v[64:67], v[92:99], v5
    v_exp_f32 v70, v70
    v_exp_f32 v71, v71
    v_exp_f32 v72, v72
    v_exp_f32 v73, v73
    v_mfma_f32_32x32x16_bf16 v[84:99], v[44:47], v[28:31], 0
    v_exp_f32 v74, v74
    v_exp_f32 v75, v75
    v_exp_f32 v76, v76
    v_exp_f32 v77, v77
    v_mfma_f32_32x32x8_bf16 v[84:99], v[50:51], v[38:39], v[84:99]
    v_exp_f32 v78, v78
    v_exp_f32 v79, v79
    v_exp_f32 v80, v80
    v_exp_f32 v81, v81
    v_smfmac_f32_32x32x32_bf16 v[132:147], v[60:63], v[68:75], v5
    v_exp_f32 v82, v82
    v_exp_f32 v83, v83
    v_exp_f32 v84, v84
    v_exp_f32 v85, v85
    v_smfmac_f32_32x32x32_bf16 v[132:147], v[64:67], v[76:83], v5
    v_exp_f32 v86, v86
    v_exp_f32 v87, v87
    v_exp_f32 v88, v88
    v_exp_f32 v89, v89
    s_waitcnt lgkmcnt(0)
    v_mfma_f32_32x32x16_bf16 v[68:83], v[40:43], v[16:19], 0
    v_exp_f32 v90, v90
    v_exp_f32 v91, v91
    v_exp_f32 v92, v92
    v_exp_f32 v93, v93
    v_mfma_f32_32x32x8_bf16 v[68:83], v[48:49], v[32:33], v[68:83]
    v_exp_f32 v94, v94
    v_exp_f32 v95, v95
    v_exp_f32 v96, v96
    v_exp_f32 v97, v97
    v_smfmac_f32_32x32x32_bf16 v[148:163], v[60:63], v[84:91], v5
    v_exp_f32 v98, v98
    v_exp_f32 v99, v99
    v_exp_f32 v68, v68
    v_exp_f32 v69, v69
    v_smfmac_f32_32x32x32_bf16 v[148:163], v[64:67], v[92:99], v5
    s_mov_b64 exec, s[22:23]
    ds_read_b128 v[60:63], v4 offset:13056
    ds_read_b128 v[64:67], v4 offset:13184
    s_mov_b64 exec, s[20:21]
    ds_read_b64 v[50:51], v3 offset:12800
    s_mov_b64 exec, -1
    ds_read_b128 v[44:47], v14 offset:11776
    ds_read_b32 v15, v2
    v_exp_f32 v70, v70
    v_exp_f32 v71, v71
    v_exp_f32 v72, v72
    v_exp_f32 v73, v73
    v_mfma_f32_32x32x16_bf16 v[84:99], v[40:43], v[20:23], 0
    v_exp_f32 v74, v74
    v_exp_f32 v75, v75
    v_exp_f32 v76, v76
    v_exp_f32 v77, v77
    v_mfma_f32_32x32x8_bf16 v[84:99], v[48:49], v[34:35], v[84:99]
    v_exp_f32 v78, v78
    v_exp_f32 v79, v79
    v_exp_f32 v80, v80
    v_exp_f32 v81, v81
    v_smfmac_f32_32x32x32_bf16 v[100:115], v[52:55], v[68:75], v5
    v_exp_f32 v82, v82
    v_exp_f32 v83, v83
    v_exp_f32 v84, v84
    v_exp_f32 v85, v85
    v_smfmac_f32_32x32x32_bf16 v[100:115], v[56:59], v[76:83], v5
    v_add_u32 v4, 5120, v4
    v_add_u32 v3, 5120, v3
    v_add_u32 v14, 5120, v14
    v_exp_f32 v86, v86
    v_exp_f32 v87, v87
    v_exp_f32 v88, v88
    v_exp_f32 v89, v89
    v_mfma_f32_32x32x16_bf16 v[68:83], v[40:43], v[24:27], 0
    v_exp_f32 v90, v90
    v_exp_f32 v91, v91
    v_exp_f32 v92, v92
    v_exp_f32 v93, v93
    v_mfma_f32_32x32x8_bf16 v[68:83], v[48:49], v[36:37], v[68:83]
    v_exp_f32 v94, v94
    v_exp_f32 v95, v95
    v_exp_f32 v96, v96
    v_exp_f32 v97, v97
    v_smfmac_f32_32x32x32_bf16 v[116:131], v[52:55], v[84:91], v5
    v_exp_f32 v98, v98
    v_exp_f32 v99, v99
    v_exp_f32 v68, v68
    v_exp_f32 v69, v69
    v_smfmac_f32_32x32x32_bf16 v[116:131], v[56:59], v[92:99], v5
    v_exp_f32 v70, v70
    v_exp_f32 v71, v71
    v_exp_f32 v72, v72
    v_exp_f32 v73, v73
    v_mfma_f32_32x32x16_bf16 v[84:99], v[40:43], v[28:31], 0
    v_exp_f32 v74, v74
    v_exp_f32 v75, v75
    v_exp_f32 v76, v76
    v_exp_f32 v77, v77
    v_mfma_f32_32x32x8_bf16 v[84:99], v[48:49], v[38:39], v[84:99]
    v_exp_f32 v78, v78
    v_exp_f32 v79, v79
    v_exp_f32 v80, v80
    v_exp_f32 v81, v81
    v_smfmac_f32_32x32x32_bf16 v[132:147], v[52:55], v[68:75], v5
    v_exp_f32 v82, v82
    v_exp_f32 v83, v83
    v_exp_f32 v84, v84
    v_exp_f32 v85, v85
    v_smfmac_f32_32x32x32_bf16 v[132:147], v[56:59], v[76:83], v5
    v_exp_f32 v86, v86
    v_exp_f32 v87, v87
    v_exp_f32 v88, v88
    v_exp_f32 v89, v89
    s_waitcnt lgkmcnt(0)
    v_mfma_f32_32x32x16_bf16 v[68:83], v[44:47], v[16:19], 0
    v_exp_f32 v90, v90
    v_exp_f32 v91, v91
    v_exp_f32 v92, v92
    v_exp_f32 v93, v93
    v_mfma_f32_32x32x8_bf16 v[68:83], v[50:51], v[32:33], v[68:83]
    v_exp_f32 v94, v94
    v_exp_f32 v95, v95
    v_exp_f32 v96, v96
    v_exp_f32 v97, v97
    v_smfmac_f32_32x32x32_bf16 v[148:163], v[52:55], v[84:91], v5
    v_exp_f32 v98, v98
    v_exp_f32 v99, v99
    s_cmp_lt_u32 s50, 6
    s_cbranch_scc1 L_k2_loop
    s_branch L_sk_6042
L_pad_att_3:
    s_branch L_pad_att_7
L_gp_11:
    s_branch L_k1_c_qkv
L_sk_6042:
    v_exp_f32 v68, v68
    v_exp_f32 v69, v69
    v_smfmac_f32_32x32x32_bf16 v[148:163], v[56:59], v[92:99], v5
    v_exp_f32 v70, v70
    v_exp_f32 v71, v71
    v_exp_f32 v72, v72
    v_exp_f32 v73, v73
    v_mfma_f32_32x32x16_bf16 v[84:99], v[44:47], v[20:23], 0
    v_exp_f32 v74, v74
    v_exp_f32 v75, v75
    v_exp_f32 v76, v76
    v_exp_f32 v77, v77
    v_mfma_f32_32x32x8_bf16 v[84:99], v[50:51], v[34:35], v[84:99]
    v_exp_f32 v78, v78
    v_exp_f32 v79, v79
    v_exp_f32 v80, v80
    v_exp_f32 v81, v81
    v_smfmac_f32_32x32x32_bf16 v[100:115], v[60:63], v[68:75], v5
    v_exp_f32 v82, v82
    v_exp_f32 v83, v83
    v_exp_f32 v84, v84
    v_exp_f32 v85, v85
    v_smfmac_f32_32x32x32_bf16 v[100:115], v[64:67], v[76:83], v5
    v_exp_f32 v86, v86
    v_exp_f32 v87, v87
    v_exp_f32 v88, v88
    v_exp_f32 v89, v89
    v_mfma_f32_32x32x16_bf16 v[68:83], v[44:47], v[24:27], 0
    v_exp_f32 v90, v90
    v_exp_f32 v91, v91
    v_exp_f32 v92, v92
    v_exp_f32 v93, v93
    v_mfma_f32_32x32x8_bf16 v[68:83], v[50:51], v[36:37], v[68:83]
    v_exp_f32 v94, v94
    v_exp_f32 v95, v95
    v_exp_f32 v96, v96
    v_exp_f32 v97, v97
    v_smfmac_f32_32x32x32_bf16 v[116:131], v[60:63], v[84:91], v5
    v_exp_f32 v98, v98
    v_exp_f32 v99, v99
    v_exp_f32 v68, v68
    v_exp_f32 v69, v69
    v_smfmac_f32_32x32x32_bf16 v[116:131], v[64:67], v[92:99], v5
    v_exp_f32 v70, v70
    v_exp_f32 v71, v71
    v_exp_f32 v72, v72
    v_exp_f32 v73, v73
    v_mfma_f32_32x32x16_bf16 v[84:99], v[44:47], v[28:31], 0
    v_exp_f32 v74, v74
    v_exp_f32 v75, v75
    v_exp_f32 v76, v76
    v_exp_f32 v77, v77
    v_mfma_f32_32x32x8_bf16 v[84:99], v[50:51], v[38:39], v[84:99]
    v_exp_f32 v78, v78
    v_exp_f32 v79, v79
    v_exp_f32 v80, v80
    v_exp_f32 v81, v81
    v_smfmac_f32_32x32x32_bf16 v[132:147], v[60:63], v[68:75], v5
    v_exp_f32 v82, v82
    v_exp_f32 v83, v83
    v_exp_f32 v84, v84
    v_exp_f32 v85, v85
    v_smfmac_f32_32x32x32_bf16 v[132:147], v[64:67], v[76:83], v5
    v_exp_f32 v86, v86
    v_exp_f32 v87, v87
    v_exp_f32 v88, v88
    v_exp_f32 v89, v89
    s_waitcnt vmcnt(0)
    v_mfma_f32_32x32x16_bf16 v[68:83], v[10:13], v[16:19], 0
    v_exp_f32 v90, v90
    v_exp_f32 v91, v91
    v_exp_f32 v92, v92
    v_exp_f32 v93, v93
    v_mfma_f32_32x32x8_bf16 v[68:83], v[0:1], v[32:33], v[68:83]
    v_exp_f32 v94, v94
    v_exp_f32 v95, v95
    v_exp_f32 v96, v96
    v_exp_f32 v97, v97
    v_smfmac_f32_32x32x32_bf16 v[148:163], v[60:63], v[84:91], v5
    v_exp_f32 v98, v98
    v_exp_f32 v99, v99
    v_exp_f32 v68, v68
    v_exp_f32 v69, v69
    v_smfmac_f32_32x32x32_bf16 v[148:163], v[64:67], v[92:99], v5
    s_mov_b64 exec, s[52:53]
    ds_inc_u32 v2, v5 offset:8
    s_mov_b64 exec, -1
    s_setprio 2
    v_mov_b32 v15, s35
    ds_read_b32 v15, v15
    v_exp_f32 v70, v70
    v_exp_f32 v71, v71
    v_exp_f32 v72, v72
    v_exp_f32 v73, v73
    v_mfma_f32_32x32x16_bf16 v[84:99], v[10:13], v[20:23], 0
    v_exp_f32 v74, v74
    v_exp_f32 v75, v75
    v_exp_f32 v76, v76
    v_exp_f32 v77, v77
    v_mfma_f32_32x32x8_bf16 v[84:99], v[0:1], v[34:35], v[84:99]
    v_bfe_u32 v23, v2, 2, 7
    v_add_u32 v17, s48, v2
    v_add_u32 v23, s49, v23
    v_add_u32 v18, s45, v2
    v_add_u32 v19, s46, v2
    v_add_u32 v20, s47, v2
    v_mov_b32 v21, s55
    v_mov_b32 v22, 1
    v_exp_f32 v78, v78
    v_exp_f32 v79, v79
    v_exp_f32 v80, v80
    v_exp_f32 v81, v81
    v_smfmac_f32_32x32x32_bf16 v[100:115], v[6:9], v[68:75], v5
    v_exp_f32 v82, v82
    v_exp_f32 v83, v83
    v_exp_f32 v84, v84
    v_exp_f32 v85, v85
    v_smfmac_f32_32x32x32_bf16 v[100:115], v[164:167], v[76:83], v5
    v_exp_f32 v86, v86
    v_exp_f32 v87, v87
    v_exp_f32 v88, v88
    v_exp_f32 v89, v89
    s_waitcnt lgkmcnt(0)
    v_cmp_gt_u32 vcc, s26, v15
    v_mfma_f32_32x32x16_bf16 v[68:83], v[10:13], v[24:27], 0
    v_exp_f32 v90, v90
    v_exp_f32 v91, v91
    v_exp_f32 v92, v92
    v_exp_f32 v93, v93
    v_mfma_f32_32x32x8_bf16 v[68:83], v[0:1], v[36:37], v[68:83]
    s_cbranch_vccnz L_grd
L_grdd:
    ds_read_b32 v16, v23
    ds_write_b128 v17, v[100:103] offset:0
    ds_write_b128 v17, v[104:107] offset:1024
    ds_write_b128 v17, v[108:111] offset:2048
    v_exp_f32 v94, v94
    v_exp_f32 v95, v95
    v_exp_f32 v96, v96
    v_exp_f32 v97, v97
    v_smfmac_f32_32x32x32_bf16 v[116:131], v[6:9], v[84:91], v5
    v_exp_f32 v98, v98
    v_exp_f32 v99, v99
    v_exp_f32 v68, v68
    v_exp_f32 v69, v69
    v_smfmac_f32_32x32x32_bf16 v[116:131], v[164:167], v[92:99], v5
    v_exp_f32 v70, v70
    v_exp_f32 v71, v71
    v_exp_f32 v72, v72
    v_exp_f32 v73, v73
    v_mfma_f32_32x32x16_bf16 v[84:99], v[10:13], v[28:31], 0
    v_exp_f32 v74, v74
    v_exp_f32 v75, v75
    v_exp_f32 v76, v76
    v_exp_f32 v77, v77
    v_mfma_f32_32x32x8_bf16 v[84:99], v[0:1], v[38:39], v[84:99]
    ds_write_b128 v17, v[116:119] offset:3072
    ds_write_b128 v17, v[120:123] offset:4096
    ds_write_b128 v17, v[124:127] offset:5120
    v_mov_b32 v27, s12
    v_lshlrev_b32 v26, 3, v2
    v_exp_f32 v78, v78
    v_exp_f32 v79, v79
    v_exp_f32 v80, v80
    v_exp_f32 v81, v81
    v_smfmac_f32_32x32x32_bf16 v[132:147], v[6:9], v[68:75], v5
    v_exp_f32 v82, v82
    v_exp_f32 v83, v83
    v_exp_f32 v84, v84
    v_exp_f32 v85, v85
    v_smfmac_f32_32x32x32_bf16 v[132:147], v[164:167], v[76:83], v5
    v_exp_f32 v86, v86
    v_exp_f32 v87, v87
    v_exp_f32 v88, v88
    v_exp_f32 v89, v89
    v_exp_f32 v90, v90
    v_exp_f32 v91, v91
    v_exp_f32 v92, v92
    ds_write_b128 v17, v[132:135] offset:6144
    ds_write_b128 v17, v[136:139] offset:7168
    ds_write_b128 v17, v[140:143] offset:8192
    s_mov_b64 exec, 1
    ds_add_u32 v21, v22
    s_mov_b64 exec, -1
    v_exp_f32 v93, v93
    v_smfmac_f32_32x32x32_bf16 v[148:163], v[6:9], v[84:91], v5
    v_exp_f32 v94, v94
    v_exp_f32 v95, v95
    v_exp_f32 v96, v96
    ds_read_b32 v25, v21
    ds_read_b128 v[100:103], v18 offset:2048
    ds_read_b128 v[104:107], v19 offset:5120
    ds_read_b128 v[108:111], v20 offset:8192
    ds_read_b128 v[112:115], v18 offset:0
    ds_read_b128 v[116:119], v19 offset:3072
    ds_read_b128 v[120:123], v20 offset:6144
    ds_read_b128 v[124:127], v18 offset:1024
    ds_read_b128 v[128:131], v19 offset:4096
    ds_read_b128 v[68:71], v20 offset:7168
    v_exp_f32 v97, v97
    v_exp_f32 v98, v98
    v_exp_f32 v99, v99
    s_mov_b32 s50, 0x100000
    s_mov_b32 s43, 0x30800000
    v_smfmac_f32_32x32x32_bf16 v[148:163], v[164:167], v[92:99], v5
L_xw:
    s_waitcnt lgkmcnt(6)
    v_cmp_gt_u32 vcc, 4, v25
    s_cbranch_vccnz L_xw1
L_xwd:
    s_mov_b64 exec, 15
    buffer_atomic_add v27, v26, s[28:31], s11 offen sc1
    s_branch L_sk_6260
L_pad_att_4:
    s_branch L_pad_att_8
L_gp_12:
    s_branch L_k1_c_qkv
L_sk_6260:
    s_mov_b64 exec, -1
    v_add_f32 v100, v100, v104
    v_add_f32 v101, v101, v105
    v_add_f32 v102, v102, v106
    v_add_f32 v103, v103, v107
    v_add_f32 v100, v100, v108
    v_add_f32 v101, v101, v109
    v_add_f32 v102, v102, v110
    v_add_f32 v103, v103, v111
    s_waitcnt lgkmcnt(3)
    v_add_f32 v112, v112, v116
    v_add_f32 v113, v113, v117
    v_add_f32 v114, v114, v118
    v_add_f32 v115, v115, v119
    v_add_f32 v156, v156, v100
    v_add_f32 v157, v157, v101
    v_add_f32 v158, v158, v102
    v_add_f32 v159, v159, v103
    v_mov_b32 v24, v156
    v_mov_b32 v25, v156
    v_add_f32 v112, v112, v120
    v_add_f32 v113, v113, v121
    v_add_f32 v114, v114, v122
    v_add_f32 v115, v115, v123
    v_permlane32_swap_b32 v24, v25
    v_add_f32 v148, v148, v112
    v_add_f32 v149, v149, v113
    v_add_f32 v150, v150, v114
    v_add_f32 v151, v151, v115
    s_mov_b32 s48, 0x53800000
    v_cmp_lt_f32 vcc, s43, v25
    v_cmp_gt_f32 s[46:47], s48, v25
    v_rcp_f32 v25, v25
    s_waitcnt lgkmcnt(0)
    s_mov_b64 exec, 1
    ds_add_u32 v21, v22
    s_mov_b64 exec, -1
    v_add_f32 v124, v124, v128
    v_add_f32 v125, v125, v129
    v_add_f32 v126, v126, v130
    v_add_f32 v127, v127, v131
    v_add_f32 v152, v152, v68
    v_add_f32 v153, v153, v69
    v_add_f32 v154, v154, v70
    v_add_f32 v155, v155, v71
    v_add_f32 v152, v152, v124
    v_add_f32 v153, v153, v125
    v_add_f32 v154, v154, v126
    v_add_f32 v155, v155, v127
    s_and_b64 s[46:47], s[46:47], vcc
    s_cmp_eq_u64 s[46:47], -1
    s_cbranch_scc0 L_k2_slow
L_k2_fin:
    v_mul_f32 v25, v25, v16
    v_mul_f32 v156, v156, v25
    v_mul_f32 v157, v157, v25
    v_mul_f32 v158, v158, v25
    v_mul_f32 v159, v159, v25
    v_cvt_pk_bf16_f32 v156, v156, v157
    v_cvt_pk_bf16_f32 v157, v158, v159
    v_min_u32 v156, -2, v156
    v_mov_b32 v158, v156
    v_mov_b32 v159, v157
    v_mul_f32 v148, v148, v25
    v_mul_f32 v149, v149, v25
    v_mul_f32 v150, v150, v25
    v_mul_f32 v151, v151, v25
    v_mul_f32 v152, v152, v25
    v_mul_f32 v153, v153, v25
    v_mul_f32 v154, v154, v25
    v_mul_f32 v155, v155, v25
    v_permlane16_swap_b32 v156, v158
    v_permlane16_swap_b32 v157, v159
    v_cvt_pk_bf16_f32 v148, v148, v149
    v_cvt_pk_bf16_f32 v149, v150, v151
    v_cvt_pk_bf16_f32 v150, v152, v153
    v_cvt_pk_bf16_f32 v151, v154, v155
    v_min_u32 v148, -2, v148
    buffer_store_dwordx4 v[148:151], v2, s[28:31], s6 offen sc1
    s_mov_b64 exec, 0xffff
    buffer_store_dwordx4 v[156:159], v2, s[28:31], s7 offen sc1
    s_mov_b64 exec, 1
    ds_add_u32 v21, v22
    s_cmp_lg_u32 s38, 0
    s_cbranch_scc0 L_end3
    s_mov_b64 exec, -1
    s_and_b32 s40, s2, 3
    s_lshl_b32 s40, s40, 1
    s_and_b32 s41, s37, 1
    s_add_u32 s40, s40, s41
    s_lshl_b32 s44, s40, 6
    s_add_u32 s44, s44, 159808
    v_bfe_u32 v26, v2, 2, 6
    v_add_u32 v26, s44, v26
    ds_read_b32 v26, v26
    s_lshl_b32 s41, s34, 4
    s_add_u32 s40, s40, s41
    s_mul_i32 s40, s40, 20480
    s_lshr_b32 s43, s37, 1
    s_mul_i32 s41, s43, 24
    s_add_u32 s40, s40, s41
    s_bfe_u32 s41, s2, 0x20003
    s_and_b32 s42, s2, 4
    s_add_u32 s41, s41, s42
    s_mul_i32 s41, s41, 160
    s_add_u32 s40, s40, s41
    s_lshl_b32 s41, s43, 10
    v_add_u32 v19, s41, v19
    v_add_u32 v20, s41, v20
    v_and_b32 v28, 255, v2
    v_mul_u32_u24 v28, 80, v28
    v_lshrrev_b32 v29, 8, v2
    v_mad_u32_u24 v28, v29, 40, v28
    v_mov_b32 v21, 161036
    s_mov_b32 s50, 0x100000
    s_setprio 0
    s_mov_b32 s72, s74
    s_mov_b32 s73, s75
    s_mov_b32 s74, 2621440
    s_mov_b32 s75, 0x00020000
    s_waitcnt lgkmcnt(0)
    v_add_f32 v26, 1.0, v26
    v_rcp_f32 v26, v26
    s_branch L_yr1
L_yr:
    s_sleep 2
    s_sub_u32 s50, s50, 1
    s_cbranch_scc1 L_yrd
L_yr1:
    ds_read_b32 v25, v21
    s_waitcnt lgkmcnt(0)
    v_cmp_gt_u32 vcc, 4, v25
    s_cbranch_vccnz L_yr
L_yrd:
    ds_read_b128 v[100:103], v17 offset:9216
    ds_read_b128 v[104:107], v18 offset:14336
    ds_read_b128 v[108:111], v19 offset:11264
    ds_read_b128 v[112:115], v20 offset:16384
    ds_read_b128 v[116:119], v17 offset:10240
    ds_read_b128 v[120:123], v18 offset:15360
    ds_read_b128 v[124:127], v19 offset:12288
    ds_read_b128 v[128:131], v20 offset:17408
    s_cmp_lg_u32 s43, 0
    s_cbranch_scc1 L_yr2
    ds_read_b128 v[132:135], v17 offset:11264
    ds_read_b128 v[136:139], v18 offset:16384
    ds_read_b128 v[140:143], v19 offset:13312
    ds_read_b128 v[144:147], v20 offset:18432
    s_waitcnt lgkmcnt(0)
    v_add_f32 v144, v144, v140
    v_add_f32 v132, v132, v136
    v_add_f32 v145, v145, v141
    v_add_f32 v133, v133, v137
    v_add_f32 v146, v146, v142
    v_add_f32 v134, v134, v138
    v_add_f32 v147, v147, v143
    v_add_f32 v135, v135, v139
    v_add_f32 v132, v132, v144
    v_add_f32 v133, v133, v145
    v_add_f32 v134, v134, v146
    v_add_f32 v135, v135, v147
    v_mul_f32 v132, v132, v26
    v_mul_f32 v133, v133, v26
    v_mul_f32 v134, v134, v26
    v_mul_f32 v135, v135, v26
    v_cvt_pk_bf16_f32 v132, v132, v133
    v_cvt_pk_bf16_f32 v133, v134, v135
    buffer_store_dwordx2 v[132:133], v28, s[72:75], s40 offen offset:16
L_yr2:
    s_waitcnt lgkmcnt(0)
    v_add_f32 v112, v112, v108
    v_add_f32 v100, v100, v104
    v_add_f32 v113, v113, v109
    v_add_f32 v101, v101, v105
    v_add_f32 v114, v114, v110
    v_add_f32 v102, v102, v106
    v_add_f32 v115, v115, v111
    v_add_f32 v103, v103, v107
    v_add_f32 v100, v100, v112
    v_add_f32 v101, v101, v113
    v_add_f32 v102, v102, v114
    v_add_f32 v103, v103, v115
    v_mul_f32 v100, v100, v26
    v_mul_f32 v101, v101, v26
    v_mul_f32 v102, v102, v26
    v_mul_f32 v103, v103, v26
    v_cvt_pk_bf16_f32 v100, v100, v101
    v_cvt_pk_bf16_f32 v101, v102, v103
    buffer_store_dwordx2 v[100:101], v28, s[72:75], s40 offen offset:0
    v_add_f32 v128, v128, v124
    v_add_f32 v116, v116, v120
    v_add_f32 v129, v129, v125
    v_add_f32 v117, v117, v121
    v_add_f32 v130, v130, v126
    v_add_f32 v118, v118, v122
    v_add_f32 v131, v131, v127
    v_add_f32 v119, v119, v123
    v_add_f32 v116, v116, v128
    v_add_f32 v117, v117, v129
    v_add_f32 v118, v118, v130
    v_add_f32 v119, v119, v131
    v_mul_f32 v116, v116, v26
    v_mul_f32 v117, v117, v26
    v_mul_f32 v118, v118, v26
    v_mul_f32 v119, v119, v26
    v_cvt_pk_bf16_f32 v116, v116, v117
    v_cvt_pk_bf16_f32 v117, v118, v119
    buffer_store_dwordx2 v[116:117], v28, s[72:75], s40 offen offset:8
L_end3:
    s_endpgm
L_xw1:
    s_waitcnt lgkmcnt(0)
    s_sleep 1
    ds_read_b32 v25, v21
    s_sub_u32 s50, s50, 1
    s_cbranch_scc1 L_xw2
    s_waitcnt lgkmcnt(0)
    v_cmp_gt_u32 vcc, 4, v25
    s_cbranch_vccnz L_xw1
L_xw2:
    ds_read_b128 v[100:103], v18 offset:2048
    ds_read_b128 v[104:107], v19 offset:5120
    ds_read_b128 v[108:111], v20 offset:8192
    ds_read_b128 v[112:115], v18 offset:0
    s_branch L_sk_6490
L_pad_att_5:
    s_branch L_ldone
L_gp_13:
    s_branch L_k1_c_qkv
L_sk_6490:
    ds_read_b128 v[116:119], v19 offset:3072
    ds_read_b128 v[120:123], v20 offset:6144
    ds_read_b128 v[124:127], v18 offset:1024
    ds_read_b128 v[128:131], v19 offset:4096
    ds_read_b128 v[68:71], v20 offset:7168
    s_waitcnt lgkmcnt(6)
    s_branch L_xwd
L_ldone:
    s_sub_u32 s60, s34, 12
    s_and_b32 s68, s2, 1
    s_lshl_b32 s68, s68, 2
    s_add_u32 s68, s68, s37
    s_lshl_b32 s68, s68, 2
    s_bfe_u32 s61, s2, 0x20001
    s_add_u32 s68, s68, s61
    s_lshl_b32 s68, s68, 7
    s_cmp_lt_u32 s60, 12
    s_cselect_b32 s61, 0, 4096
    s_add_u32 s68, s68, s61
    s_add_u32 s68, s68, 16835584
    s_mov_b32 s69, s60
    v_lshlrev_b32 v0, 4, v1
    s_and_b32 s10, s2, 4
    s_lshl_b32 s10, s10, 3
    s_lshr_b32 s11, s2, 3
    s_add_u32 s10, s10, s11
    s_mul_i32 s10, s10, 128
    s_add_u32 s10, s10, 16793600
    s_mov_b32 s51, 0x40000
L_chk:
    v_cmp_ne_u32 vcc, 1, v46
    s_cbranch_vccz L_chkd
    s_sleep 8
    buffer_load_dword v46, off, s[76:79], 0 sc1
    s_waitcnt vmcnt(0)
    s_sub_u32 s51, s51, 1
    s_cbranch_scc0 L_chk
L_chkd:
    s_cmp_lg_u32 s33, 0
    s_cbranch_scc1 L_gdone
    ds_read_b128 v[24:27], v16 offset:0
    ds_read_b128 v[28:31], v18 offset:1152
    s_waitcnt lgkmcnt(0)
    v_mfma_f32_16x16x32_bf16 v[20:23], v[28:31], v[24:27], v[20:23]
    ds_read_b128 v[24:27], v17 offset:0
    ds_read_b128 v[28:31], v18 offset:1216
    s_branch L_sk_6542
L_pad_att_6:
    s_branch L_ldone
L_gp_14:
    s_branch L_k1_c_qkv
L_sk_6542:
    s_waitcnt lgkmcnt(0)
    v_mfma_f32_16x16x32_bf16 v[20:23], v[28:31], v[24:27], v[20:23]
    s_nop 9
    v_mul_f32 v20, 0x3fb8aa3b, v20
    v_min_f32 v20, 0x42800000, v20
    v_exp_f32 v20, v20
    s_lshl_b32 s48, s45, 2
    s_add_u32 s48, s48, s59
    s_add_u32 s48, s48, 16777216
    v_lshlrev_b32 v19, 2, v19
    v_min_u32 v20, -2, v20
    s_mov_b64 exec, 0xffff
    buffer_store_dword v20, v19, s[28:31], s48 offen sc1
    s_mov_b64 exec, -1
L_gdone:
    s_lshr_b32 s48, s40, 1
    s_lshl_b32 s48, s48, 2
    s_lshl_b32 s46, s41, 5
    s_cmp_eq_u32 s33, 0
    s_cselect_b32 s49, s48, 0
    s_cselect_b32 s48, 0xf, -1
    s_add_u32 s46, s46, s49
    s_mov_b32 s49, 0
    s_lshl_b32 s46, s46, 7
    s_add_u32 s46, s46, 16793600
    s_cmp_lt_u32 s33, 3
    s_cselect_b32 s47, s37, 1
    s_and_b32 s56, s2, 7
    s_lshl_b32 s56, s56, 2
    s_bfe_u32 s57, s2, 0x20003
    s_add_u32 s56, s56, s57
    s_mul_i32 s56, s56, 163840
    s_mul_i32 s57, s37, 40960
    s_add_u32 s56, s56, s57
    s_add_u32 s56, s56, 2621440
    s_lshr_b32 s57, s2, 5
    s_and_b32 s57, s57, 5
    s_add_u32 s57, s57, 1
    s_mul_i32 s58, s37, 39936
    s_cmp_lt_u32 s37, 2
    s_mov_b32 s41, 118848
    s_cselect_b32 s41, 59456, s41
    s_mul_i32 s40, s37, 10240
    s_add_u32 s40, s40, s41
    v_add_u32 v8, s40, v0
    s_lshl_b32 s40, s37, 4
    v_mov_b32 v14, s40
    v_mov_b64 v[16:17], 0
    v_mov_b64 v[18:19], 0
    s_mul_i32 s35, s39, 480
    s_lshl_b32 s41, s38, 2
    s_add_u32 s35, s35, s41
    s_add_u32 s35, s35, s37
    s_lshl_b32 s35, s35, 10
    s_add_u32 s35, s35, 7864320
    s_mov_b32 s60, s28
    s_mov_b32 s61, s29
    s_mov_b32 s62, 14155776
    s_mov_b32 s63, 0x00020000
    s_cmp_eq_u32 s39, 12
    s_cselect_b32 s4, 15, 31
    s_mov_b32 s5, 0
    s_mul_i32 s32, s38, 43
    s_lshr_b32 s32, s32, 7
    s_mul_i32 s41, s39, 20
    s_add_u32 s32, s32, s41
    s_lshl_b32 s32, s32, 7
    s_add_u32 s32, s32, 16801792
    v_lshlrev_b32 v13, 9, v1
    v_mov_b32 v6, 161024
    v_mov_b32 v7, 1
    s_mov_b32 s3, s33
    s_lshr_b32 s59, s2, 5
    s_lshl_b32 s38, s59, 4
    s_lshl_b32 s59, s59, 2
    s_and_b32 s39, s2, 3
    s_add_u32 s59, s59, s39
    s_lshl_b32 s39, s39, 1
    s_add_u32 s38, s38, s39
    s_bfe_u32 s39, s2, 0x20003
    s_and_b32 s40, s2, 4
    s_add_u32 s39, s39, s40
    s_and_b32 s33, s37, 1
    s_lshr_b32 s34, s37, 1
    s_mul_i32 s45, s39, 160
    s_lshl_b32 s23, s39, 2
    s_add_u32 s23, s23, s37
    s_mul_i32 s44, s23, 87040
    s_add_u32 s44, s44, 18874368
    s_lshl_b32 s23, s23, 7
    s_add_u32 s23, s23, 16835584
    v_add_u32 v2, 4096, v0
    s_cmp_lg_u32 s47, 0
    s_cbranch_scc1 L_sgd
    s_setprio 3
    v_lshlrev_b32 v45, 7, v1
    v_mov_b32 v46, 161044
    v_mov_b32 v44, 256
    s_mov_b32 s47, 1288352
    s_mov_b32 s51, 0x100000
L_sg:
    ds_read_b32 v43, v46
    s_sub_u32 s51, s51, 1
    s_cbranch_scc1 L_sg1
    s_waitcnt lgkmcnt(0)
    v_cmp_gt_u32 vcc, s47, v43
    s_cbranch_vccz L_sg1
    s_sleep 1
    s_branch L_sg
L_sg1:
    s_mov_b64 exec, s[48:49]
    buffer_atomic_add v44, v45, s[28:31], s46 offen sc1
    s_mov_b64 exec, -1
    s_mov_b32 s51, 0x100000
    s_cmp_eq_u32 s47, 1288352
    s_mov_b32 s47, 1288351
    v_mov_b32 v44, 1
    v_mov_b32 v46, 161048
    s_cbranch_scc1 L_sg
L_sgd:
    s_cmp_lg_u32 s37, 3
    s_cbranch_scc1 L_epd
    s_mov_b32 s51, 0x40000
    s_mov_b64 exec, 1
    v_mov_b32 v45, 161040
L_ep:
    v_mov_b32 v38, 0
    buffer_atomic_add v38, off, s[28:31], s10 sc0 sc1
    s_waitcnt vmcnt(0)
    v_cmp_le_u32 vcc, 8704, v38
    v_cndmask_b32 v43, 0, v7, vcc
L_tst0:
    v_cmp_le_u32 vcc, 8738, v38
    v_addc_co_u32 v43, s[48:49], 0, v43, vcc
    ds_write_b32 v45, v43
    s_cbranch_vccnz L_ep1
    s_sleep 1
    s_sub_u32 s51, s51, 1
    s_cbranch_scc0 L_ep
L_ep1:
    s_mov_b64 exec, -1
L_epd:
    s_cmp_lt_u32 s69, 17
    s_cbranch_scc0 L_nwf
    s_mov_b64 exec, 1
    s_waitcnt vmcnt(0)
    buffer_atomic_add v7, v0, s[28:31], s68 offen sc1
    s_mov_b64 exec, -1
L_nwf:
    s_setprio 3
    s_waitcnt lgkmcnt(0)
    s_barrier
    s_and_b32 s57, s57, 7
    s_mul_i32 s40, s57, 5120
    s_add_u32 s40, s40, s56
    s_add_u32 m0, s58, 5184
    s_add_u32 s57, s57, 1
    buffer_load_dwordx4 v0, s[28:31], s40 offen sc1 lds
    buffer_load_dwordx4 v0, s[28:31], s40 offen offset:1024 sc1 lds
    s_mov_b32 exec_hi, 0
    buffer_load_dwordx4 v0, s[28:31], s40 offen offset:2048 sc1 lds
    s_mov_b32 exec_hi, -1
    ds_write_b128 v14, v[16:19]
    ds_read_b128 v[88:91], v8 offset:0
    ds_read_b128 v[92:95], v8 offset:1024
    ds_read_b128 v[96:99], v8 offset:2048
    ds_read_b128 v[100:103], v8 offset:3072
    ds_read_b128 v[104:107], v8 offset:4096
    ds_read_b128 v[108:111], v8 offset:5120
    ds_read_b128 v[112:115], v8 offset:6144
    ds_read_b128 v[116:119], v8 offset:7168
    ds_read_b128 v[120:123], v8 offset:8192
    ds_read_b128 v[124:127], v8 offset:9216
    s_setprio 2
    s_and_b32 s57, s57, 7
    s_mul_i32 s40, s57, 5120
    s_add_u32 s40, s40, s56
    s_add_u32 m0, s58, 9280
    s_add_u32 s41, s40, 4096
    buffer_load_dwordx4 v0, s[28:31], s40 offen offset:0 sc1 lds
    buffer_load_dwordx4 v0, s[28:31], s40 offen offset:1024 sc1 lds
    buffer_load_dwordx4 v0, s[28:31], s40 offen offset:2048 sc1 lds
    buffer_load_dwordx4 v0, s[28:31], s40 offen offset:3072 sc1 lds
    s_add_u32 m0, s58, 13376
    s_add_u32 s57, s57, 1
    buffer_load_dwordx4 v0, s[28:31], s41 offen sc1 lds
    s_and_b32 s57, s57, 7
    s_mul_i32 s40, s57, 5120
    s_add_u32 s40, s40, s56
    s_add_u32 m0, s58, 14400
    s_add_u32 s41, s40, 4096
    buffer_load_dwordx4 v0, s[28:31], s40 offen offset:0 sc1 lds
    buffer_load_dwordx4 v0, s[28:31], s40 offen offset:1024 sc1 lds
    buffer_load_dwordx4 v0, s[28:31], s40 offen offset:2048 sc1 lds
    buffer_load_dwordx4 v0, s[28:31], s40 offen offset:3072 sc1 lds
    s_add_u32 m0, s58, 18496
    s_add_u32 s57, s57, 1
    buffer_load_dwordx4 v0, s[28:31], s41 offen sc1 lds
L_nkv1:
    s_waitcnt vmcnt(10) lgkmcnt(0)
    s_branch L_sk_6748
L_pad_att_7:
    s_branch L_ldone
L_gp_15:
    s_branch L_k1_c_qkv
L_sk_6748:
    s_barrier
    s_cmp_lg_u32 s3, 3
    s_cbranch_scc1 L_k2_nh
    buffer_store_dwordx4 v[88:91], v0, s[60:63], s35 offen sc1
    s_add_u32 s35, s35, 49152
    buffer_store_dwordx4 v[92:95], v0, s[60:63], s35 offen sc1
    s_add_u32 s35, s35, 49152
    buffer_store_dwordx4 v[96:99], v0, s[60:63], s35 offen sc1
    s_add_u32 s35, s35, 49152
    buffer_store_dwordx4 v[100:103], v0, s[60:63], s35 offen sc1
    s_add_u32 s35, s35, 49152
    buffer_store_dwordx4 v[104:107], v0, s[60:63], s35 offen sc1
    s_add_u32 s35, s35, 49152
    buffer_store_dwordx4 v[108:111], v0, s[60:63], s35 offen sc1
    s_add_u32 s35, s35, 49152
    buffer_store_dwordx4 v[112:115], v0, s[60:63], s35 offen sc1
    s_add_u32 s35, s35, 49152
    buffer_store_dwordx4 v[116:119], v0, s[60:63], s35 offen sc1
    s_add_u32 s35, s35, 49152
    buffer_store_dwordx4 v[120:123], v0, s[60:63], s35 offen sc1
    s_add_u32 s35, s35, 49152
    buffer_store_dwordx4 v[124:127], v0, s[60:63], s35 offen sc1
    s_add_u32 s35, s35, 49152
L_k2_nh:
    s_lshr_b32 s40, s2, 5
    s_lshl_b32 s22, s40, 2
    s_add_u32 s22, s22, s37
    s_lshl_b32 s51, s22, 8
    s_add_u32 s51, s51, 16777216
    s_lshl_b32 s22, s22, 5
    s_add_u32 s22, s22, 16834560
    s_lshl_b32 s21, s38, 1
    s_add_u32 s21, s21, s37
    s_lshl_b32 s21, s21, 7
    s_add_u32 s21, s21, 16801792
    s_mul_i32 s40, s40, 3
    s_lshr_b32 s40, s40, 1
    s_and_b32 s41, s39, 3
    s_mul_i32 s41, s41, 3
    s_add_u32 s40, s40, s41
    s_sub_u32 s41, s40, 12
    s_cselect_b32 s19, s40, s41
    s_sub_u32 s20, 12, s19
    s_mul_i32 s16, s37, 12
    s_add_u32 s16, s16, s19
    s_lshl_b32 s16, s16, 10
    s_add_u32 s16, s16, 7864320
    s_lshl_b32 s17, s37, 13
    s_add_u32 s17, s17, 14155776
    s_lshl_b32 s18, s37, 11
    s_add_u32 s18, s18, 14188544
    s_mul_i32 s42, s19, 5120
    s_add_u32 s42, s42, s44
    v_and_b32 v9, 15, v1
    v_lshrrev_b32 v12, 4, v1
    v_lshlrev_b32 v3, 4, v9
    v_lshl_add_u32 v3, v12, 9, v3
    v_lshlrev_b32 v8, 2, v1
    s_xor_b32 s40, s33, 0
    s_add_u32 s43, s40, s38
    s_add_u32 s43, s43, 0
    s_mul_i32 s41, s43, 49152
    s_add_u32 s46, s41, s16
    s_lshr_b32 s41, s43, 1
    s_mul_i32 s41, s41, 40960
    s_lshl_b32 s40, s40, 8
    s_add_u32 s41, s41, s40
    s_add_u32 s52, s41, s17
    s_add_u32 s6, s52, 4096
    s_add_u32 s10, s41, s18
    s_xor_b32 s40, s33, 1
    s_add_u32 s43, s40, s38
    s_add_u32 s43, s43, 0
    s_mul_i32 s41, s43, 49152
    s_add_u32 s47, s41, s16
    s_lshr_b32 s41, s43, 1
    s_mul_i32 s41, s41, 40960
    s_lshl_b32 s40, s40, 8
    s_add_u32 s41, s41, s40
    s_add_u32 s53, s41, s17
    s_add_u32 s7, s53, 4096
    s_add_u32 s11, s41, s18
    s_xor_b32 s40, s33, 0
    s_add_u32 s43, s40, s38
    s_add_u32 s43, s43, 8
    s_mul_i32 s41, s43, 49152
    s_add_u32 s48, s41, s16
    s_lshr_b32 s41, s43, 1
    s_mul_i32 s41, s41, 40960
    s_lshl_b32 s40, s40, 8
    s_add_u32 s41, s41, s40
    s_add_u32 s54, s41, s17
    s_add_u32 s8, s54, 4096
    s_add_u32 s12, s41, s18
    s_xor_b32 s40, s33, 1
    s_add_u32 s43, s40, s38
    s_add_u32 s43, s43, 8
    s_mul_i32 s41, s43, 49152
    s_add_u32 s49, s41, s16
    s_lshr_b32 s41, s43, 1
    s_mul_i32 s41, s41, 40960
    s_lshl_b32 s40, s40, 8
    s_add_u32 s41, s41, s40
    s_add_u32 s55, s41, s17
    s_add_u32 s9, s55, 4096
    s_add_u32 s13, s41, s18
    v_add_u32 v36, s22, v8
    v_mov_b32 v37, 1
    s_add_u32 s40, s21, 2048
    v_writelane_b32 v36, s23, 8
    v_writelane_b32 v36, s21, 9
    v_writelane_b32 v36, s40, 10
    s_add_u32 s40, s23, 4096
    v_writelane_b32 v37, 12, 8
    v_writelane_b32 v36, s40, 11
    v_writelane_b32 v37, 5, 11
    v_writelane_b32 v37, 3, 9
    v_writelane_b32 v37, 3, 10
    s_cmp_lg_u32 s3, 3
    s_cbranch_scc0 L_k2_w1
    v_mov_b32 v15, 1
    s_waitcnt vmcnt(5)
    ds_write_b32 v14, v15
    s_and_b32 s57, s57, 7
    s_mul_i32 s40, s57, 5120
    s_add_u32 s40, s40, s56
    s_add_u32 m0, s58, 19520
    s_add_u32 s41, s40, 4096
    buffer_load_dwordx4 v0, s[28:31], s40 offen offset:0 sc1 lds
    buffer_load_dwordx4 v0, s[28:31], s40 offen offset:1024 sc1 lds
    buffer_load_dwordx4 v0, s[28:31], s40 offen offset:2048 sc1 lds
    buffer_load_dwordx4 v0, s[28:31], s40 offen offset:3072 sc1 lds
    s_add_u32 m0, s58, 23616
    s_add_u32 s57, s57, 1
    buffer_load_dwordx4 v0, s[28:31], s41 offen sc1 lds
    v_mov_b32 v15, 2
    s_waitcnt vmcnt(5)
    ds_write_b32 v14, v15
    s_and_b32 s57, s57, 7
    s_mul_i32 s40, s57, 5120
    s_add_u32 s40, s40, s56
    s_add_u32 m0, s58, 24640
    s_add_u32 s41, s40, 4096
    buffer_load_dwordx4 v0, s[28:31], s40 offen offset:0 sc1 lds
    buffer_load_dwordx4 v0, s[28:31], s40 offen offset:1024 sc1 lds
    buffer_load_dwordx4 v0, s[28:31], s40 offen offset:2048 sc1 lds
    buffer_load_dwordx4 v0, s[28:31], s40 offen offset:3072 sc1 lds
    s_add_u32 m0, s58, 28736
    s_add_u32 s57, s57, 1
    buffer_load_dwordx4 v0, s[28:31], s41 offen sc1 lds
    v_mov_b32 v15, 3
    s_waitcnt vmcnt(5)
    ds_write_b32 v14, v15
    s_and_b32 s57, s57, 7
    s_mul_i32 s40, s57, 5120
    s_add_u32 s40, s40, s56
    s_add_u32 m0, s58, 29760
    s_add_u32 s41, s40, 4096
    buffer_load_dwordx4 v0, s[28:31], s40 offen offset:0 sc1 lds
    buffer_load_dwordx4 v0, s[28:31], s40 offen offset:1024 sc1 lds
    buffer_load_dwordx4 v0, s[28:31], s40 offen offset:2048 sc1 lds
    buffer_load_dwordx4 v0, s[28:31], s40 offen offset:3072 sc1 lds
    s_add_u32 m0, s58, 33856
    s_add_u32 s57, s57, 1
    buffer_load_dwordx4 v0, s[28:31], s41 offen sc1 lds
    v_mov_b32 v15, 4
    s_waitcnt vmcnt(5)
    ds_write_b32 v14, v15
    s_and_b32 s57, s57, 7
    s_mul_i32 s40, s57, 5120
    s_add_u32 s40, s40, s56
    s_add_u32 m0, s58, 34880
    s_add_u32 s41, s40, 4096
    buffer_load_dwordx4 v0, s[28:31], s40 offen offset:0 sc1 lds
    buffer_load_dwordx4 v0, s[28:31], s40 offen offset:1024 sc1 lds
    buffer_load_dwordx4 v0, s[28:31], s40 offen offset:2048 sc1 lds
    buffer_load_dwordx4 v0, s[28:31], s40 offen offset:3072 sc1 lds
    s_add_u32 m0, s58, 38976
    s_add_u32 s57, s57, 1
    buffer_load_dwordx4 v0, s[28:31], s41 offen sc1 lds
    s_branch L_sk_6934
L_pad_att_8:
    s_branch L_ldone
L_gp_16:
    s_branch L_k1_c_qkv
L_sk_6934:
    buffer_load_dword v12, v8, s[28:31], s51 offen sc1
    v_mov_b32 v15, 5
    s_waitcnt vmcnt(6)
    ds_write_b32 v14, v15
    v_mov_b32 v15, 6
    s_waitcnt vmcnt(1)
    ds_write_b32 v14, v15
    s_branch L_k2_help
L_k2_w1:
    v_mov_b32 v15, 1
    s_waitcnt vmcnt(15)
    ds_write_b32 v14, v15
    s_and_b32 s57, s57, 7
    s_mul_i32 s40, s57, 5120
    s_add_u32 s40, s40, s56
    s_add_u32 m0, s58, 19520
    s_add_u32 s41, s40, 4096
    buffer_load_dwordx4 v0, s[28:31], s40 offen offset:0 sc1 lds
    buffer_load_dwordx4 v0, s[28:31], s40 offen offset:1024 sc1 lds
    buffer_load_dwordx4 v0, s[28:31], s40 offen offset:2048 sc1 lds
    buffer_load_dwordx4 v0, s[28:31], s40 offen offset:3072 sc1 lds
    s_add_u32 m0, s58, 23616
    s_add_u32 s57, s57, 1
    buffer_load_dwordx4 v0, s[28:31], s41 offen sc1 lds
    v_mov_b32 v15, 2
    s_waitcnt vmcnt(15)
    ds_write_b32 v14, v15
    s_and_b32 s57, s57, 7
    s_mul_i32 s40, s57, 5120
    s_add_u32 s40, s40, s56
    s_add_u32 m0, s58, 24640
    s_add_u32 s41, s40, 4096
    buffer_load_dwordx4 v0, s[28:31], s40 offen offset:0 sc1 lds
    buffer_load_dwordx4 v0, s[28:31], s40 offen offset:1024 sc1 lds
    buffer_load_dwordx4 v0, s[28:31], s40 offen offset:2048 sc1 lds
    buffer_load_dwordx4 v0, s[28:31], s40 offen offset:3072 sc1 lds
    s_add_u32 m0, s58, 28736
    s_add_u32 s57, s57, 1
    buffer_load_dwordx4 v0, s[28:31], s41 offen sc1 lds
    s_mov_b64 exec, 1
    s_waitcnt vmcnt(10)
    ds_add_rtn_u32 v5, v6, v7
    s_waitcnt lgkmcnt(0)
    v_readfirstlane_b32 s40, v5
    s_cmp_lg_u32 s40, 3
    s_cbranch_scc1 L_hs_f
    s_mov_b64 exec, s[4:5]
    buffer_atomic_add v7, v13, s[28:31], s32 offen sc1
L_hs_f:
    s_mov_b64 exec, -1
    v_mov_b32 v15, 3
    s_waitcnt vmcnt(5)
    ds_write_b32 v14, v15
    s_and_b32 s57, s57, 7
    s_mul_i32 s40, s57, 5120
    s_add_u32 s40, s40, s56
    s_add_u32 m0, s58, 29760
    s_add_u32 s41, s40, 4096
    buffer_load_dwordx4 v0, s[28:31], s40 offen offset:0 sc1 lds
    buffer_load_dwordx4 v0, s[28:31], s40 offen offset:1024 sc1 lds
    buffer_load_dwordx4 v0, s[28:31], s40 offen offset:2048 sc1 lds
    buffer_load_dwordx4 v0, s[28:31], s40 offen offset:3072 sc1 lds
    s_add_u32 m0, s58, 33856
    s_add_u32 s57, s57, 1
    buffer_load_dwordx4 v0, s[28:31], s41 offen sc1 lds
    v_mov_b32 v15, 4
    s_waitcnt vmcnt(5)
    ds_write_b32 v14, v15
    s_and_b32 s57, s57, 7
    s_mul_i32 s40, s57, 5120
    s_add_u32 s40, s40, s56
    s_add_u32 m0, s58, 34880
    s_add_u32 s41, s40, 4096
    buffer_load_dwordx4 v0, s[28:31], s40 offen offset:0 sc1 lds
    buffer_load_dwordx4 v0, s[28:31], s40 offen offset:1024 sc1 lds
    buffer_load_dwordx4 v0, s[28:31], s40 offen offset:2048 sc1 lds
    buffer_load_dwordx4 v0, s[28:31], s40 offen offset:3072 sc1 lds
    s_add_u32 m0, s58, 38976
    s_add_u32 s57, s57, 1
    buffer_load_dwordx4 v0, s[28:31], s41 offen sc1 lds
    buffer_load_dword v12, v8, s[28:31], s51 offen sc1
    v_mov_b32 v15, 5
    s_waitcnt vmcnt(6)
    ds_write_b32 v14, v15
    v_mov_b32 v15, 6
    s_waitcnt vmcnt(1)
    ds_write_b32 v14, v15
L_k2_help:
    s_mov_b32 s72, s74
    s_mov_b32 s73, s75
    s_mov_b32 s74, 2621440
    s_mov_b32 s75, 0x00020000
    s_mov_b64 exec, 0xf00
    buffer_load_dword v38, v36, s[28:31], 0 offen sc1
    s_mov_b64 exec, -1
    s_waitcnt vmcnt(1)
    v_cmp_eq_u32 vcc, -1, v12
    s_cbranch_vccnz L_hg
L_hgd:
    s_lshl_b32 s40, s37, 8
    s_add_u32 s40, s40, 159808
    v_add_u32 v8, s40, v8
    ds_write_b32 v8, v12
    s_mov_b32 s64, s22
    s_and_b32 s40, s2, 7
    s_lshl_b32 s40, s40, 2
    s_bfe_u32 s41, s2, 0x20003
    s_add_u32 s40, s40, s41
    s_lshr_b32 s61, s2, 5
    s_lshl_b32 s61, s61, 3
    s_add_u32 s61, s61, s37
    s_mul_i32 s61, s61, 40
    s_add_u32 s60, s61, s40
    s_lshl_b32 s60, s60, 10
    s_add_u32 s60, s60, 14155776
    s_lshr_b32 s40, s40, 2
    s_add_u32 s61, s61, s40
    s_lshl_b32 s61, s61, 10
    s_add_u32 s61, s61, 14188544
    s_and_b32 s40, s41, 1
    s_lshl_b32 s40, s40, 9
    s_add_u32 s61, s61, s40
    s_and_b32 s40, s41, 2
    s_lshl_b32 s40, s40, 7
    s_add_u32 s61, s61, s40
    s_add_u32 s62, s60, 163840
    s_add_u32 s63, s61, 163840
    s_and_b32 s40, s2, 7
    s_lshl_b32 s40, s40, 2
    s_bfe_u32 s41, s2, 0x20003
    s_add_u32 s40, s40, s41
    s_and_b32 s65, s2, 0xe0
    s_add_u32 s65, s65, s40
    s_lshl_b32 s65, s65, 2
    s_add_u32 s65, s65, 16834560
    v_mov_b64 v[84:85], -1
    v_mov_b64 v[86:87], -1
    s_lshl_b32 s41, s34, 10
    s_mul_i32 s24, s37, 39936
    s_add_u32 s24, s24, 64
    s_xor_b32 s40, s37, 1
    s_mul_i32 s40, s40, 39936
    s_add_u32 s25, s40, 3136
    s_xor_b32 s40, s37, 2
    s_mul_i32 s40, s40, 39936
    s_add_u32 s26, s40, 64
    s_add_u32 s26, s26, s41
    s_xor_b32 s40, s37, 3
    s_mul_i32 s40, s40, 39936
    s_add_u32 s27, s40, 5184
    s_add_u32 s27, s27, s41
    s_add_u32 s40, s38, s33
    s_mul_i32 s40, s40, 20480
    s_mul_i32 s41, s34, 24
    s_add_u32 s40, s40, s41
    s_add_u32 s21, s40, s45
    s_add_u32 s22, s21, 163840
    s_add_u32 s23, s38, s33
    s_and_b32 s23, s23, 7
    s_lshl_b32 s23, s23, 6
    s_add_u32 s23, s23, 159808
    s_cmp_eq_u32 s37, 0
    s_cbranch_scc1 L_pad_hlp_0
    s_cmp_eq_u32 s37, 1
    s_cbranch_scc1 L_pad_hlp_1
    s_cmp_eq_u32 s37, 2
    s_cbranch_scc1 L_pad_hlp_2
    s_cmp_eq_u32 s37, 3
    s_cbranch_scc1 L_pad_hlp_3
L_hwalked:
    s_mov_b32 s50, 0x40000
    s_mov_b64 exec, 0xf00
L_pl:
    s_waitcnt vmcnt(0)
    v_cmp_gt_u32 vcc, v37, v38
    s_cbranch_vccz L_pld
    s_sleep 2
    buffer_load_dword v38, v36, s[28:31], 0 offen sc1
    s_sub_u32 s50, s50, 1
    s_cbranch_scc0 L_pl
L_pld:
    s_mov_b64 exec, -1
    buffer_load_dwordx4 v[52:55], v0, s[28:31], s42 offen offset:0 sc1
    buffer_load_dwordx4 v[20:23], v0, s[28:31], s46 offen sc1
    buffer_load_dwordx4 v[24:27], v0, s[28:31], s47 offen sc1
    buffer_load_dwordx4 v[28:31], v0, s[28:31], s48 offen sc1
    buffer_load_dwordx4 v[32:35], v0, s[28:31], s49 offen sc1
    buffer_load_dwordx4 v[56:59], v0, s[28:31], s42 offen offset:1024 sc1
    buffer_load_dwordx4 v[60:63], v0, s[28:31], s42 offen offset:2048 sc1
    buffer_load_dwordx4 v[64:67], v0, s[28:31], s42 offen offset:3072 sc1
    buffer_load_dwordx4 v[68:71], v2, s[28:31], s42 offen offset:0 sc1
    s_cmp_eq_u32 s20, 1
    s_cselect_b32 s40, -11, 1
    s_branch L_sk_7133
L_pad_hlp_0:
    s_branch L_pad_hlp_4
L_gp_17:
    s_branch L_k1_c_qkv
L_sk_7133:
    s_mul_i32 s41, s40, 5120
    s_add_u32 s43, s42, s41
    s_cmp_eq_u32 s20, 1
    s_cselect_b32 s40, -11, 1
    s_lshl_b32 s40, s40, 10
    s_add_u32 s46, s46, s40
    s_add_u32 s47, s47, s40
    s_add_u32 s48, s48, s40
    s_add_u32 s49, s49, s40
    buffer_load_dwordx4 v[72:75], v0, s[28:31], s43 offen offset:0 sc1
    buffer_load_dwordx4 v[36:39], v0, s[28:31], s46 offen sc1
    buffer_load_dwordx4 v[40:43], v0, s[28:31], s47 offen sc1
    buffer_load_dwordx4 v[44:47], v0, s[28:31], s48 offen sc1
    buffer_load_dwordx4 v[48:51], v0, s[28:31], s49 offen sc1
    buffer_load_dwordx4 v[76:79], v0, s[28:31], s43 offen offset:1024 sc1
    buffer_load_dwordx4 v[80:83], v0, s[28:31], s43 offen offset:2048 sc1
    v_mov_b32 v1, v3
    s_setprio 0
    s_waitcnt vmcnt(14)
    v_mfma_f32_16x16x32_bf16 v[88:91], v[52:55], v[20:23], 0
    s_cmp_eq_u32 s20, 2
    s_cselect_b32 s40, -11, 1
    s_mul_i32 s41, s40, 5120
    s_add_u32 s42, s43, s41
    s_cmp_eq_u32 s20, 2
    s_cselect_b32 s40, -11, 1
    s_lshl_b32 s40, s40, 10
    s_add_u32 s46, s46, s40
    s_add_u32 s47, s47, s40
    s_add_u32 s48, s48, s40
    s_add_u32 s49, s49, s40
    s_waitcnt vmcnt(13)
    v_mfma_f32_16x16x32_bf16 v[108:111], v[52:55], v[24:27], 0
    s_waitcnt vmcnt(12)
    v_mfma_f32_16x16x32_bf16 v[128:131], v[52:55], v[28:31], 0
    s_waitcnt vmcnt(11)
    v_mfma_f32_16x16x32_bf16 v[148:151], v[52:55], v[32:35], 0
    buffer_load_dwordx4 v[52:55], v0, s[28:31], s43 offen offset:3072 sc1
    s_waitcnt vmcnt(11)
    v_mfma_f32_16x16x32_bf16 v[92:95], v[56:59], v[20:23], 0
    v_mfma_f32_16x16x32_bf16 v[112:115], v[56:59], v[24:27], 0
    buffer_load_dwordx4 v[4:7], v0, s[28:31], s46 offen sc1
    v_mfma_f32_16x16x32_bf16 v[132:135], v[56:59], v[28:31], 0
    v_mfma_f32_16x16x32_bf16 v[152:155], v[56:59], v[32:35], 0
    buffer_load_dwordx4 v[56:59], v2, s[28:31], s43 offen offset:0 sc1
    s_waitcnt vmcnt(12)
    v_mfma_f32_16x16x32_bf16 v[96:99], v[60:63], v[20:23], 0
    v_mfma_f32_16x16x32_bf16 v[116:119], v[60:63], v[24:27], 0
    buffer_load_dwordx4 v[8:11], v0, s[28:31], s47 offen sc1
    v_mfma_f32_16x16x32_bf16 v[136:139], v[60:63], v[28:31], 0
    v_mfma_f32_16x16x32_bf16 v[156:159], v[60:63], v[32:35], 0
    buffer_load_dwordx4 v[60:63], v0, s[28:31], s42 offen offset:0 sc1
    s_waitcnt vmcnt(13)
    v_mfma_f32_16x16x32_bf16 v[100:103], v[64:67], v[20:23], 0
    v_mfma_f32_16x16x32_bf16 v[120:123], v[64:67], v[24:27], 0
    buffer_load_dwordx4 v[12:15], v0, s[28:31], s48 offen sc1
    v_mfma_f32_16x16x32_bf16 v[140:143], v[64:67], v[28:31], 0
    v_mfma_f32_16x16x32_bf16 v[160:163], v[64:67], v[32:35], 0
    buffer_load_dwordx4 v[64:67], v0, s[28:31], s42 offen offset:1024 sc1
    s_waitcnt vmcnt(14)
    v_mfma_f32_16x16x32_bf16 v[104:107], v[68:71], v[20:23], 0
    v_mfma_f32_16x16x32_bf16 v[124:127], v[68:71], v[24:27], 0
    buffer_load_dwordx4 v[16:19], v0, s[28:31], s49 offen sc1
    v_mfma_f32_16x16x32_bf16 v[144:147], v[68:71], v[28:31], 0
    v_mfma_f32_16x16x32_bf16 v[164:167], v[68:71], v[32:35], 0
    buffer_load_dwordx4 v[68:71], v0, s[28:31], s42 offen offset:2048 sc1
    buffer_store_dwordx4 v[84:87], v0, s[28:31], s60 offen sc1
    buffer_store_dwordx4 v[84:87], v0, s[28:31], s62 offen sc1
    s_mov_b64 exec, 0xffff
    buffer_store_dwordx4 v[84:87], v0, s[28:31], s61 offen sc1
    buffer_store_dwordx4 v[84:87], v0, s[28:31], s63 offen sc1
    s_mov_b64 exec, -1
    s_waitcnt vmcnt(18)
    v_mfma_f32_16x16x32_bf16 v[88:91], v[72:75], v[36:39], v[88:91]
    s_cmp_eq_u32 s20, 3
    s_cselect_b32 s40, -11, 1
    s_mul_i32 s41, s40, 5120
    s_add_u32 s43, s42, s41
    s_cmp_eq_u32 s20, 3
    s_cselect_b32 s40, -11, 1
    s_lshl_b32 s40, s40, 10
    s_add_u32 s46, s46, s40
    s_add_u32 s47, s47, s40
    s_add_u32 s48, s48, s40
    s_add_u32 s49, s49, s40
    s_waitcnt vmcnt(17)
    v_mfma_f32_16x16x32_bf16 v[108:111], v[72:75], v[40:43], v[108:111]
    s_waitcnt vmcnt(16)
    v_mfma_f32_16x16x32_bf16 v[128:131], v[72:75], v[44:47], v[128:131]
    s_waitcnt vmcnt(15)
    v_mfma_f32_16x16x32_bf16 v[148:151], v[72:75], v[48:51], v[148:151]
    buffer_load_dwordx4 v[72:75], v0, s[28:31], s42 offen offset:3072 sc1
    s_waitcnt vmcnt(15)
    v_mfma_f32_16x16x32_bf16 v[92:95], v[76:79], v[36:39], v[92:95]
    v_mfma_f32_16x16x32_bf16 v[112:115], v[76:79], v[40:43], v[112:115]
    buffer_load_dwordx4 v[20:23], v0, s[28:31], s46 offen sc1
    v_mfma_f32_16x16x32_bf16 v[132:135], v[76:79], v[44:47], v[132:135]
    v_mfma_f32_16x16x32_bf16 v[152:155], v[76:79], v[48:51], v[152:155]
    buffer_load_dwordx4 v[76:79], v2, s[28:31], s42 offen offset:0 sc1
    s_waitcnt vmcnt(16)
    v_mfma_f32_16x16x32_bf16 v[96:99], v[80:83], v[36:39], v[96:99]
    v_mfma_f32_16x16x32_bf16 v[116:119], v[80:83], v[40:43], v[116:119]
    buffer_load_dwordx4 v[24:27], v0, s[28:31], s47 offen sc1
    v_mfma_f32_16x16x32_bf16 v[136:139], v[80:83], v[44:47], v[136:139]
    v_mfma_f32_16x16x32_bf16 v[156:159], v[80:83], v[48:51], v[156:159]
    buffer_load_dwordx4 v[80:83], v0, s[28:31], s43 offen offset:0 sc1
    s_waitcnt vmcnt(17)
    v_mfma_f32_16x16x32_bf16 v[100:103], v[52:55], v[36:39], v[100:103]
    v_mfma_f32_16x16x32_bf16 v[120:123], v[52:55], v[40:43], v[120:123]
    buffer_load_dwordx4 v[28:31], v0, s[28:31], s48 offen sc1
    v_mfma_f32_16x16x32_bf16 v[140:143], v[52:55], v[44:47], v[140:143]
    v_mfma_f32_16x16x32_bf16 v[160:163], v[52:55], v[48:51], v[160:163]
    buffer_load_dwordx4 v[52:55], v0, s[28:31], s43 offen offset:1024 sc1
    s_waitcnt vmcnt(17)
    v_mfma_f32_16x16x32_bf16 v[104:107], v[56:59], v[36:39], v[104:107]
    v_mfma_f32_16x16x32_bf16 v[124:127], v[56:59], v[40:43], v[124:127]
    buffer_load_dwordx4 v[32:35], v0, s[28:31], s49 offen sc1
    v_mfma_f32_16x16x32_bf16 v[144:147], v[56:59], v[44:47], v[144:147]
    v_mfma_f32_16x16x32_bf16 v[164:167], v[56:59], v[48:51], v[164:167]
    buffer_load_dwordx4 v[56:59], v0, s[28:31], s43 offen offset:2048 sc1
    s_waitcnt vmcnt(17)
    v_mfma_f32_16x16x32_bf16 v[88:91], v[60:63], v[4:7], v[88:91]
    s_cmp_eq_u32 s20, 4
    s_cselect_b32 s40, -11, 1
    s_mul_i32 s41, s40, 5120
    s_add_u32 s42, s43, s41
    s_cmp_eq_u32 s20, 4
    s_cselect_b32 s40, -11, 1
    s_lshl_b32 s40, s40, 10
    s_add_u32 s46, s46, s40
    s_branch L_sk_7269
L_pad_hlp_1:
    s_branch L_pad_hlp_5
L_gp_18:
    s_branch L_k1_c_qkv
L_sk_7269:
    s_add_u32 s47, s47, s40
    s_add_u32 s48, s48, s40
    s_add_u32 s49, s49, s40
    v_mfma_f32_16x16x32_bf16 v[108:111], v[60:63], v[8:11], v[108:111]
    s_waitcnt vmcnt(16)
    v_mfma_f32_16x16x32_bf16 v[128:131], v[60:63], v[12:15], v[128:131]
    s_waitcnt vmcnt(14)
    v_mfma_f32_16x16x32_bf16 v[148:151], v[60:63], v[16:19], v[148:151]
    buffer_load_dwordx4 v[60:63], v0, s[28:31], s43 offen offset:3072 sc1
    v_mfma_f32_16x16x32_bf16 v[92:95], v[64:67], v[4:7], v[92:95]
    v_mfma_f32_16x16x32_bf16 v[112:115], v[64:67], v[8:11], v[112:115]
    buffer_load_dwordx4 v[36:39], v0, s[28:31], s46 offen sc1
    v_mfma_f32_16x16x32_bf16 v[132:135], v[64:67], v[12:15], v[132:135]
    v_mfma_f32_16x16x32_bf16 v[152:155], v[64:67], v[16:19], v[152:155]
    buffer_load_dwordx4 v[64:67], v2, s[28:31], s43 offen offset:0 sc1
    s_waitcnt vmcnt(16)
    v_mfma_f32_16x16x32_bf16 v[96:99], v[68:71], v[4:7], v[96:99]
    v_mfma_f32_16x16x32_bf16 v[116:119], v[68:71], v[8:11], v[116:119]
    buffer_load_dwordx4 v[40:43], v0, s[28:31], s47 offen sc1
    v_mfma_f32_16x16x32_bf16 v[136:139], v[68:71], v[12:15], v[136:139]
    v_mfma_f32_16x16x32_bf16 v[156:159], v[68:71], v[16:19], v[156:159]
    buffer_load_dwordx4 v[68:71], v0, s[28:31], s42 offen offset:0 sc1
    s_waitcnt vmcnt(13)
    v_mfma_f32_16x16x32_bf16 v[100:103], v[72:75], v[4:7], v[100:103]
    v_mfma_f32_16x16x32_bf16 v[120:123], v[72:75], v[8:11], v[120:123]
    buffer_load_dwordx4 v[44:47], v0, s[28:31], s48 offen sc1
    v_mfma_f32_16x16x32_bf16 v[140:143], v[72:75], v[12:15], v[140:143]
    v_mfma_f32_16x16x32_bf16 v[160:163], v[72:75], v[16:19], v[160:163]
    buffer_load_dwordx4 v[72:75], v0, s[28:31], s42 offen offset:1024 sc1
    s_waitcnt vmcnt(13)
    v_mfma_f32_16x16x32_bf16 v[104:107], v[76:79], v[4:7], v[104:107]
    v_mfma_f32_16x16x32_bf16 v[124:127], v[76:79], v[8:11], v[124:127]
    buffer_load_dwordx4 v[48:51], v0, s[28:31], s49 offen sc1
    v_mfma_f32_16x16x32_bf16 v[144:147], v[76:79], v[12:15], v[144:147]
    v_mfma_f32_16x16x32_bf16 v[164:167], v[76:79], v[16:19], v[164:167]
    buffer_load_dwordx4 v[76:79], v0, s[28:31], s42 offen offset:2048 sc1
    v_mov_b32 v84, 1
    s_waitcnt lgkmcnt(0)
    s_mov_b64 exec, 1
    ds_add_u32 v0, v84 offset:4
    buffer_atomic_add v84, off, s[28:31], s65 sc1
    s_mov_b64 exec, -1
    v_lshrrev_b32 v85, 2, v0
    s_waitcnt vmcnt(14)
    v_mfma_f32_16x16x32_bf16 v[88:91], v[80:83], v[20:23], v[88:91]
    s_cmp_eq_u32 s20, 5
    s_cselect_b32 s40, -11, 1
    s_mul_i32 s41, s40, 5120
    s_add_u32 s43, s42, s41
    s_cmp_eq_u32 s20, 5
    s_cselect_b32 s40, -11, 1
    s_lshl_b32 s40, s40, 10
    s_add_u32 s46, s46, s40
    s_add_u32 s47, s47, s40
    s_add_u32 s48, s48, s40
    s_add_u32 s49, s49, s40
    v_mfma_f32_16x16x32_bf16 v[108:111], v[80:83], v[24:27], v[108:111]
    s_waitcnt vmcnt(13)
    v_mfma_f32_16x16x32_bf16 v[128:131], v[80:83], v[28:31], v[128:131]
    s_waitcnt vmcnt(11)
    v_mfma_f32_16x16x32_bf16 v[148:151], v[80:83], v[32:35], v[148:151]
    buffer_load_dwordx4 v[80:83], v0, s[28:31], s42 offen offset:3072 sc1
    v_mfma_f32_16x16x32_bf16 v[92:95], v[52:55], v[20:23], v[92:95]
    v_mfma_f32_16x16x32_bf16 v[112:115], v[52:55], v[24:27], v[112:115]
    buffer_load_dwordx4 v[4:7], v0, s[28:31], s46 offen sc1
    v_mfma_f32_16x16x32_bf16 v[132:135], v[52:55], v[28:31], v[132:135]
    v_mfma_f32_16x16x32_bf16 v[152:155], v[52:55], v[32:35], v[152:155]
    buffer_load_dwordx4 v[52:55], v2, s[28:31], s42 offen offset:0 sc1
    s_waitcnt vmcnt(13)
    v_mfma_f32_16x16x32_bf16 v[96:99], v[56:59], v[20:23], v[96:99]
    v_mfma_f32_16x16x32_bf16 v[116:119], v[56:59], v[24:27], v[116:119]
    buffer_load_dwordx4 v[8:11], v0, s[28:31], s47 offen sc1
    v_mfma_f32_16x16x32_bf16 v[136:139], v[56:59], v[28:31], v[136:139]
    v_mfma_f32_16x16x32_bf16 v[156:159], v[56:59], v[32:35], v[156:159]
    buffer_load_dwordx4 v[56:59], v0, s[28:31], s43 offen offset:0 sc1
    s_waitcnt vmcnt(14)
    v_mfma_f32_16x16x32_bf16 v[100:103], v[60:63], v[20:23], v[100:103]
    v_mfma_f32_16x16x32_bf16 v[120:123], v[60:63], v[24:27], v[120:123]
    buffer_load_dwordx4 v[12:15], v0, s[28:31], s48 offen sc1
    v_mfma_f32_16x16x32_bf16 v[140:143], v[60:63], v[28:31], v[140:143]
    v_mfma_f32_16x16x32_bf16 v[160:163], v[60:63], v[32:35], v[160:163]
    buffer_load_dwordx4 v[60:63], v0, s[28:31], s43 offen offset:1024 sc1
    s_waitcnt vmcnt(14)
    v_mfma_f32_16x16x32_bf16 v[104:107], v[64:67], v[20:23], v[104:107]
    v_mfma_f32_16x16x32_bf16 v[124:127], v[64:67], v[24:27], v[124:127]
    buffer_load_dwordx4 v[16:19], v0, s[28:31], s49 offen sc1
    v_mfma_f32_16x16x32_bf16 v[144:147], v[64:67], v[28:31], v[144:147]
    v_mfma_f32_16x16x32_bf16 v[164:167], v[64:67], v[32:35], v[164:167]
    buffer_load_dwordx4 v[64:67], v0, s[28:31], s43 offen offset:2048 sc1
    s_waitcnt vmcnt(14)
    v_mfma_f32_16x16x32_bf16 v[88:91], v[68:71], v[36:39], v[88:91]
    s_cmp_eq_u32 s20, 6
    s_cselect_b32 s40, -11, 1
    s_mul_i32 s41, s40, 5120
    s_add_u32 s42, s43, s41
    s_cmp_eq_u32 s20, 6
    s_cselect_b32 s40, -11, 1
    s_lshl_b32 s40, s40, 10
    s_add_u32 s46, s46, s40
    s_add_u32 s47, s47, s40
    s_add_u32 s48, s48, s40
    s_add_u32 s49, s49, s40
    v_mfma_f32_16x16x32_bf16 v[108:111], v[68:71], v[40:43], v[108:111]
    s_waitcnt vmcnt(13)
    v_mfma_f32_16x16x32_bf16 v[128:131], v[68:71], v[44:47], v[128:131]
    s_waitcnt vmcnt(11)
    v_mfma_f32_16x16x32_bf16 v[148:151], v[68:71], v[48:51], v[148:151]
    buffer_load_dwordx4 v[68:71], v0, s[28:31], s43 offen offset:3072 sc1
    v_mfma_f32_16x16x32_bf16 v[92:95], v[72:75], v[36:39], v[92:95]
    v_mfma_f32_16x16x32_bf16 v[112:115], v[72:75], v[40:43], v[112:115]
    buffer_load_dwordx4 v[20:23], v0, s[28:31], s46 offen sc1
    v_mfma_f32_16x16x32_bf16 v[132:135], v[72:75], v[44:47], v[132:135]
    v_mfma_f32_16x16x32_bf16 v[152:155], v[72:75], v[48:51], v[152:155]
    buffer_load_dwordx4 v[72:75], v2, s[28:31], s43 offen offset:0 sc1
    s_waitcnt vmcnt(13)
    v_mfma_f32_16x16x32_bf16 v[96:99], v[76:79], v[36:39], v[96:99]
    v_mfma_f32_16x16x32_bf16 v[116:119], v[76:79], v[40:43], v[116:119]
    buffer_load_dwordx4 v[24:27], v0, s[28:31], s47 offen sc1
    v_mfma_f32_16x16x32_bf16 v[136:139], v[76:79], v[44:47], v[136:139]
    v_mfma_f32_16x16x32_bf16 v[156:159], v[76:79], v[48:51], v[156:159]
    buffer_load_dwordx4 v[76:79], v0, s[28:31], s42 offen offset:0 sc1
    s_waitcnt vmcnt(13)
    v_mfma_f32_16x16x32_bf16 v[100:103], v[80:83], v[36:39], v[100:103]
    v_mfma_f32_16x16x32_bf16 v[120:123], v[80:83], v[40:43], v[120:123]
    buffer_load_dwordx4 v[28:31], v0, s[28:31], s48 offen sc1
    v_mfma_f32_16x16x32_bf16 v[140:143], v[80:83], v[44:47], v[140:143]
    v_mfma_f32_16x16x32_bf16 v[160:163], v[80:83], v[48:51], v[160:163]
    buffer_load_dwordx4 v[80:83], v0, s[28:31], s42 offen offset:1024 sc1
    s_waitcnt vmcnt(13)
    v_mfma_f32_16x16x32_bf16 v[104:107], v[52:55], v[36:39], v[104:107]
    v_mfma_f32_16x16x32_bf16 v[124:127], v[52:55], v[40:43], v[124:127]
    buffer_load_dwordx4 v[32:35], v0, s[28:31], s49 offen sc1
    v_mfma_f32_16x16x32_bf16 v[144:147], v[52:55], v[44:47], v[144:147]
    v_mfma_f32_16x16x32_bf16 v[164:167], v[52:55], v[48:51], v[164:167]
    buffer_load_dwordx4 v[52:55], v0, s[28:31], s42 offen offset:2048 sc1
    s_waitcnt vmcnt(13)
    v_mfma_f32_16x16x32_bf16 v[88:91], v[56:59], v[4:7], v[88:91]
    s_cmp_eq_u32 s20, 7
    s_cselect_b32 s40, -11, 1
    s_mul_i32 s41, s40, 5120
    s_add_u32 s43, s42, s41
    s_cmp_eq_u32 s20, 7
    s_cselect_b32 s40, -11, 1
    s_lshl_b32 s40, s40, 10
    s_add_u32 s46, s46, s40
    s_add_u32 s47, s47, s40
    s_add_u32 s48, s48, s40
    s_add_u32 s49, s49, s40
    v_mfma_f32_16x16x32_bf16 v[108:111], v[56:59], v[8:11], v[108:111]
    s_waitcnt vmcnt(12)
    v_mfma_f32_16x16x32_bf16 v[128:131], v[56:59], v[12:15], v[128:131]
    s_waitcnt vmcnt(10)
    v_mfma_f32_16x16x32_bf16 v[148:151], v[56:59], v[16:19], v[148:151]
    buffer_load_dwordx4 v[56:59], v0, s[28:31], s42 offen offset:3072 sc1
    v_mfma_f32_16x16x32_bf16 v[92:95], v[60:63], v[4:7], v[92:95]
    v_mfma_f32_16x16x32_bf16 v[112:115], v[60:63], v[8:11], v[112:115]
    buffer_load_dwordx4 v[36:39], v0, s[28:31], s46 offen sc1
    v_mfma_f32_16x16x32_bf16 v[132:135], v[60:63], v[12:15], v[132:135]
    v_mfma_f32_16x16x32_bf16 v[152:155], v[60:63], v[16:19], v[152:155]
    buffer_load_dwordx4 v[60:63], v2, s[28:31], s42 offen offset:0 sc1
    s_waitcnt vmcnt(12)
    v_mfma_f32_16x16x32_bf16 v[96:99], v[64:67], v[4:7], v[96:99]
    v_mfma_f32_16x16x32_bf16 v[116:119], v[64:67], v[8:11], v[116:119]
    buffer_load_dwordx4 v[40:43], v0, s[28:31], s47 offen sc1
    s_branch L_sk_7439
L_pad_hlp_2:
    s_branch L_pad_hlp_6
L_gp_19:
    s_branch L_k1_c_qkv
L_sk_7439:
    v_mfma_f32_16x16x32_bf16 v[136:139], v[64:67], v[12:15], v[136:139]
    v_mfma_f32_16x16x32_bf16 v[156:159], v[64:67], v[16:19], v[156:159]
    buffer_load_dwordx4 v[64:67], v0, s[28:31], s43 offen offset:0 sc1
    s_waitcnt vmcnt(13)
    v_mfma_f32_16x16x32_bf16 v[100:103], v[68:71], v[4:7], v[100:103]
    v_mfma_f32_16x16x32_bf16 v[120:123], v[68:71], v[8:11], v[120:123]
    buffer_load_dwordx4 v[44:47], v0, s[28:31], s48 offen sc1
    v_mfma_f32_16x16x32_bf16 v[140:143], v[68:71], v[12:15], v[140:143]
    v_mfma_f32_16x16x32_bf16 v[160:163], v[68:71], v[16:19], v[160:163]
    buffer_load_dwordx4 v[68:71], v0, s[28:31], s43 offen offset:1024 sc1
    s_waitcnt vmcnt(13)
    v_mfma_f32_16x16x32_bf16 v[104:107], v[72:75], v[4:7], v[104:107]
    v_mfma_f32_16x16x32_bf16 v[124:127], v[72:75], v[8:11], v[124:127]
    buffer_load_dwordx4 v[48:51], v0, s[28:31], s49 offen sc1
    v_mfma_f32_16x16x32_bf16 v[144:147], v[72:75], v[12:15], v[144:147]
    v_mfma_f32_16x16x32_bf16 v[164:167], v[72:75], v[16:19], v[164:167]
    buffer_load_dwordx4 v[72:75], v0, s[28:31], s43 offen offset:2048 sc1
    s_waitcnt vmcnt(13)
    v_mfma_f32_16x16x32_bf16 v[88:91], v[76:79], v[20:23], v[88:91]
    s_cmp_eq_u32 s20, 8
    s_cselect_b32 s40, -11, 1
    s_mul_i32 s41, s40, 5120
    s_add_u32 s42, s43, s41
    s_cmp_eq_u32 s20, 8
    s_cselect_b32 s40, -11, 1
    s_lshl_b32 s40, s40, 10
    s_add_u32 s46, s46, s40
    s_add_u32 s47, s47, s40
    s_add_u32 s48, s48, s40
    s_add_u32 s49, s49, s40
    v_mfma_f32_16x16x32_bf16 v[108:111], v[76:79], v[24:27], v[108:111]
    s_waitcnt vmcnt(12)
    v_mfma_f32_16x16x32_bf16 v[128:131], v[76:79], v[28:31], v[128:131]
    s_waitcnt vmcnt(10)
    v_mfma_f32_16x16x32_bf16 v[148:151], v[76:79], v[32:35], v[148:151]
    buffer_load_dwordx4 v[76:79], v0, s[28:31], s43 offen offset:3072 sc1
    v_mfma_f32_16x16x32_bf16 v[92:95], v[80:83], v[20:23], v[92:95]
    v_mfma_f32_16x16x32_bf16 v[112:115], v[80:83], v[24:27], v[112:115]
    buffer_load_dwordx4 v[4:7], v0, s[28:31], s46 offen sc1
    v_mfma_f32_16x16x32_bf16 v[132:135], v[80:83], v[28:31], v[132:135]
    v_mfma_f32_16x16x32_bf16 v[152:155], v[80:83], v[32:35], v[152:155]
    buffer_load_dwordx4 v[80:83], v2, s[28:31], s43 offen offset:0 sc1
    s_waitcnt vmcnt(12)
    v_mfma_f32_16x16x32_bf16 v[96:99], v[52:55], v[20:23], v[96:99]
    v_mfma_f32_16x16x32_bf16 v[116:119], v[52:55], v[24:27], v[116:119]
    buffer_load_dwordx4 v[8:11], v0, s[28:31], s47 offen sc1
    v_mfma_f32_16x16x32_bf16 v[136:139], v[52:55], v[28:31], v[136:139]
    v_mfma_f32_16x16x32_bf16 v[156:159], v[52:55], v[32:35], v[156:159]
    buffer_load_dwordx4 v[52:55], v0, s[28:31], s42 offen offset:0 sc1
    s_waitcnt vmcnt(13)
    v_mfma_f32_16x16x32_bf16 v[100:103], v[56:59], v[20:23], v[100:103]
    v_mfma_f32_16x16x32_bf16 v[120:123], v[56:59], v[24:27], v[120:123]
    buffer_load_dwordx4 v[12:15], v0, s[28:31], s48 offen sc1
    v_mfma_f32_16x16x32_bf16 v[140:143], v[56:59], v[28:31], v[140:143]
    v_mfma_f32_16x16x32_bf16 v[160:163], v[56:59], v[32:35], v[160:163]
    buffer_load_dwordx4 v[56:59], v0, s[28:31], s42 offen offset:1024 sc1
    s_waitcnt vmcnt(13)
    v_mfma_f32_16x16x32_bf16 v[104:107], v[60:63], v[20:23], v[104:107]
    v_mfma_f32_16x16x32_bf16 v[124:127], v[60:63], v[24:27], v[124:127]
    buffer_load_dwordx4 v[16:19], v0, s[28:31], s49 offen sc1
    v_mfma_f32_16x16x32_bf16 v[144:147], v[60:63], v[28:31], v[144:147]
    v_mfma_f32_16x16x32_bf16 v[164:167], v[60:63], v[32:35], v[164:167]
    buffer_load_dwordx4 v[60:63], v0, s[28:31], s42 offen offset:2048 sc1
    s_waitcnt vmcnt(13)
    v_mfma_f32_16x16x32_bf16 v[88:91], v[64:67], v[36:39], v[88:91]
    s_cmp_eq_u32 s20, 9
    s_cselect_b32 s40, -11, 1
    s_mul_i32 s41, s40, 5120
    s_add_u32 s43, s42, s41
    s_cmp_eq_u32 s20, 9
    s_cselect_b32 s40, -11, 1
    s_lshl_b32 s40, s40, 10
    s_add_u32 s46, s46, s40
    s_add_u32 s47, s47, s40
    s_add_u32 s48, s48, s40
    s_add_u32 s49, s49, s40
    v_mfma_f32_16x16x32_bf16 v[108:111], v[64:67], v[40:43], v[108:111]
    s_waitcnt vmcnt(12)
    v_mfma_f32_16x16x32_bf16 v[128:131], v[64:67], v[44:47], v[128:131]
    s_waitcnt vmcnt(10)
    v_mfma_f32_16x16x32_bf16 v[148:151], v[64:67], v[48:51], v[148:151]
    buffer_load_dwordx4 v[64:67], v0, s[28:31], s42 offen offset:3072 sc1
    v_mfma_f32_16x16x32_bf16 v[92:95], v[68:71], v[36:39], v[92:95]
    v_mfma_f32_16x16x32_bf16 v[112:115], v[68:71], v[40:43], v[112:115]
    buffer_load_dwordx4 v[20:23], v0, s[28:31], s46 offen sc1
    v_mfma_f32_16x16x32_bf16 v[132:135], v[68:71], v[44:47], v[132:135]
    v_mfma_f32_16x16x32_bf16 v[152:155], v[68:71], v[48:51], v[152:155]
    buffer_load_dwordx4 v[68:71], v2, s[28:31], s42 offen offset:0 sc1
    s_waitcnt vmcnt(12)
    v_mfma_f32_16x16x32_bf16 v[96:99], v[72:75], v[36:39], v[96:99]
    v_mfma_f32_16x16x32_bf16 v[116:119], v[72:75], v[40:43], v[116:119]
    buffer_load_dwordx4 v[24:27], v0, s[28:31], s47 offen sc1
    v_mfma_f32_16x16x32_bf16 v[136:139], v[72:75], v[44:47], v[136:139]
    v_mfma_f32_16x16x32_bf16 v[156:159], v[72:75], v[48:51], v[156:159]
    buffer_load_dwordx4 v[72:75], v0, s[28:31], s43 offen offset:0 sc1
    s_waitcnt vmcnt(13)
    v_mfma_f32_16x16x32_bf16 v[100:103], v[76:79], v[36:39], v[100:103]
    v_mfma_f32_16x16x32_bf16 v[120:123], v[76:79], v[40:43], v[120:123]
    buffer_load_dwordx4 v[28:31], v0, s[28:31], s48 offen sc1
    v_mfma_f32_16x16x32_bf16 v[140:143], v[76:79], v[44:47], v[140:143]
    v_mfma_f32_16x16x32_bf16 v[160:163], v[76:79], v[48:51], v[160:163]
    buffer_load_dwordx4 v[76:79], v0, s[28:31], s43 offen offset:1024 sc1
    s_waitcnt vmcnt(13)
    v_mfma_f32_16x16x32_bf16 v[104:107], v[80:83], v[36:39], v[104:107]
    v_mfma_f32_16x16x32_bf16 v[124:127], v[80:83], v[40:43], v[124:127]
    buffer_load_dwordx4 v[32:35], v0, s[28:31], s49 offen sc1
    v_mfma_f32_16x16x32_bf16 v[144:147], v[80:83], v[44:47], v[144:147]
    v_mfma_f32_16x16x32_bf16 v[164:167], v[80:83], v[48:51], v[164:167]
    buffer_load_dwordx4 v[80:83], v0, s[28:31], s43 offen offset:2048 sc1
    s_mov_b64 exec, 0xff
    buffer_load_dword v86, v85, s[28:31], s64 offen sc1
    s_mov_b64 exec, -1
    s_waitcnt vmcnt(14)
    v_mfma_f32_16x16x32_bf16 v[88:91], v[52:55], v[4:7], v[88:91]
    s_cmp_eq_u32 s20, 10
    s_cselect_b32 s40, -11, 1
    s_mul_i32 s41, s40, 5120
    s_add_u32 s42, s43, s41
    s_cmp_eq_u32 s20, 10
    s_cselect_b32 s40, -11, 1
    s_lshl_b32 s40, s40, 10
    s_add_u32 s46, s46, s40
    s_add_u32 s47, s47, s40
    s_add_u32 s48, s48, s40
    s_add_u32 s49, s49, s40
    v_mfma_f32_16x16x32_bf16 v[108:111], v[52:55], v[8:11], v[108:111]
    s_waitcnt vmcnt(13)
    v_mfma_f32_16x16x32_bf16 v[128:131], v[52:55], v[12:15], v[128:131]
    s_waitcnt vmcnt(11)
    v_mfma_f32_16x16x32_bf16 v[148:151], v[52:55], v[16:19], v[148:151]
    buffer_load_dwordx4 v[52:55], v0, s[28:31], s43 offen offset:3072 sc1
    v_mfma_f32_16x16x32_bf16 v[92:95], v[56:59], v[4:7], v[92:95]
    v_mfma_f32_16x16x32_bf16 v[112:115], v[56:59], v[8:11], v[112:115]
    buffer_load_dwordx4 v[36:39], v0, s[28:31], s46 offen sc1
    v_mfma_f32_16x16x32_bf16 v[132:135], v[56:59], v[12:15], v[132:135]
    v_mfma_f32_16x16x32_bf16 v[152:155], v[56:59], v[16:19], v[152:155]
    buffer_load_dwordx4 v[56:59], v2, s[28:31], s43 offen offset:0 sc1
    s_waitcnt vmcnt(13)
    v_mfma_f32_16x16x32_bf16 v[96:99], v[60:63], v[4:7], v[96:99]
    v_mfma_f32_16x16x32_bf16 v[116:119], v[60:63], v[8:11], v[116:119]
    buffer_load_dwordx4 v[40:43], v0, s[28:31], s47 offen sc1
    v_mfma_f32_16x16x32_bf16 v[136:139], v[60:63], v[12:15], v[136:139]
    v_mfma_f32_16x16x32_bf16 v[156:159], v[60:63], v[16:19], v[156:159]
    buffer_load_dwordx4 v[60:63], v0, s[28:31], s42 offen offset:0 sc1
    s_waitcnt vmcnt(14)
    v_mfma_f32_16x16x32_bf16 v[100:103], v[64:67], v[4:7], v[100:103]
    v_mfma_f32_16x16x32_bf16 v[120:123], v[64:67], v[8:11], v[120:123]
    buffer_load_dwordx4 v[44:47], v0, s[28:31], s48 offen sc1
    v_mfma_f32_16x16x32_bf16 v[140:143], v[64:67], v[12:15], v[140:143]
    v_mfma_f32_16x16x32_bf16 v[160:163], v[64:67], v[16:19], v[160:163]
    buffer_load_dwordx4 v[64:67], v0, s[28:31], s42 offen offset:1024 sc1
    s_waitcnt vmcnt(14)
    v_mfma_f32_16x16x32_bf16 v[104:107], v[68:71], v[4:7], v[104:107]
    v_mfma_f32_16x16x32_bf16 v[124:127], v[68:71], v[8:11], v[124:127]
    buffer_load_dwordx4 v[48:51], v0, s[28:31], s49 offen sc1
    v_mfma_f32_16x16x32_bf16 v[144:147], v[68:71], v[12:15], v[144:147]
    v_mfma_f32_16x16x32_bf16 v[164:167], v[68:71], v[16:19], v[164:167]
    buffer_load_dwordx4 v[68:71], v0, s[28:31], s42 offen offset:2048 sc1
    s_waitcnt vmcnt(14)
    v_mfma_f32_16x16x32_bf16 v[88:91], v[72:75], v[20:23], v[88:91]
    s_cmp_eq_u32 s20, 11
    s_branch L_sk_7606
L_pad_hlp_3:
    s_branch L_pad_hlp_7
L_gp_20:
    s_branch L_k1_c_qkv
L_sk_7606:
    s_cselect_b32 s40, -11, 1
    s_mul_i32 s41, s40, 5120
    s_add_u32 s43, s42, s41
    s_cmp_eq_u32 s20, 11
    s_cselect_b32 s40, -11, 1
    s_lshl_b32 s40, s40, 10
    s_add_u32 s46, s46, s40
    s_add_u32 s47, s47, s40
    s_add_u32 s48, s48, s40
    s_add_u32 s49, s49, s40
    v_mfma_f32_16x16x32_bf16 v[108:111], v[72:75], v[24:27], v[108:111]
    s_waitcnt vmcnt(13)
    v_mfma_f32_16x16x32_bf16 v[128:131], v[72:75], v[28:31], v[128:131]
    s_waitcnt vmcnt(11)
    v_mfma_f32_16x16x32_bf16 v[148:151], v[72:75], v[32:35], v[148:151]
    buffer_load_dwordx4 v[72:75], v0, s[28:31], s42 offen offset:3072 sc1
    v_mfma_f32_16x16x32_bf16 v[92:95], v[76:79], v[20:23], v[92:95]
    v_mfma_f32_16x16x32_bf16 v[112:115], v[76:79], v[24:27], v[112:115]
    buffer_load_dwordx4 v[4:7], v0, s[28:31], s46 offen sc1
    v_mfma_f32_16x16x32_bf16 v[132:135], v[76:79], v[28:31], v[132:135]
    v_mfma_f32_16x16x32_bf16 v[152:155], v[76:79], v[32:35], v[152:155]
    buffer_load_dwordx4 v[76:79], v2, s[28:31], s42 offen offset:0 sc1
    s_waitcnt vmcnt(13)
    v_mfma_f32_16x16x32_bf16 v[96:99], v[80:83], v[20:23], v[96:99]
    v_mfma_f32_16x16x32_bf16 v[116:119], v[80:83], v[24:27], v[116:119]
    buffer_load_dwordx4 v[8:11], v0, s[28:31], s47 offen sc1
    v_mfma_f32_16x16x32_bf16 v[136:139], v[80:83], v[28:31], v[136:139]
    v_mfma_f32_16x16x32_bf16 v[156:159], v[80:83], v[32:35], v[156:159]
    buffer_load_dwordx4 v[80:83], v0, s[28:31], s43 offen offset:0 sc1
    s_waitcnt vmcnt(13)
    v_mfma_f32_16x16x32_bf16 v[100:103], v[52:55], v[20:23], v[100:103]
    v_mfma_f32_16x16x32_bf16 v[120:123], v[52:55], v[24:27], v[120:123]
    buffer_load_dwordx4 v[12:15], v0, s[28:31], s48 offen sc1
    v_mfma_f32_16x16x32_bf16 v[140:143], v[52:55], v[28:31], v[140:143]
    v_mfma_f32_16x16x32_bf16 v[160:163], v[52:55], v[32:35], v[160:163]
    buffer_load_dwordx4 v[52:55], v0, s[28:31], s43 offen offset:1024 sc1
    s_waitcnt vmcnt(13)
    v_mfma_f32_16x16x32_bf16 v[104:107], v[56:59], v[20:23], v[104:107]
    v_mfma_f32_16x16x32_bf16 v[124:127], v[56:59], v[24:27], v[124:127]
    buffer_load_dwordx4 v[16:19], v0, s[28:31], s49 offen sc1
    v_mfma_f32_16x16x32_bf16 v[144:147], v[56:59], v[28:31], v[144:147]
    v_mfma_f32_16x16x32_bf16 v[164:167], v[56:59], v[32:35], v[164:167]
    buffer_load_dwordx4 v[56:59], v0, s[28:31], s43 offen offset:2048 sc1
    v_cmp_gt_u32 vcc, 4, v86
    s_cbranch_vccnz L_cf
L_cfd:
    s_waitcnt vmcnt(13)
    v_mfma_f32_16x16x32_bf16 v[88:91], v[60:63], v[36:39], v[88:91]
    v_mfma_f32_16x16x32_bf16 v[108:111], v[60:63], v[40:43], v[108:111]
    s_waitcnt vmcnt(12)
    v_mfma_f32_16x16x32_bf16 v[128:131], v[60:63], v[44:47], v[128:131]
    s_waitcnt vmcnt(10)
    v_mfma_f32_16x16x32_bf16 v[148:151], v[60:63], v[48:51], v[148:151]
    buffer_load_dwordx4 v[60:63], v0, s[28:31], s43 offen offset:3072 sc1
    v_mfma_f32_16x16x32_bf16 v[92:95], v[64:67], v[36:39], v[92:95]
    v_mfma_f32_16x16x32_bf16 v[112:115], v[64:67], v[40:43], v[112:115]
    buffer_load_dwordx4 v[20:23], v1, s[28:31], s52 offen offset:0 sc1
    v_mfma_f32_16x16x32_bf16 v[132:135], v[64:67], v[44:47], v[132:135]
    v_mfma_f32_16x16x32_bf16 v[152:155], v[64:67], v[48:51], v[152:155]
    buffer_load_dwordx4 v[64:67], v2, s[28:31], s43 offen offset:0 sc1
    s_waitcnt vmcnt(12)
    v_mfma_f32_16x16x32_bf16 v[96:99], v[68:71], v[36:39], v[96:99]
    v_mfma_f32_16x16x32_bf16 v[116:119], v[68:71], v[40:43], v[116:119]
    buffer_load_dwordx4 v[24:27], v1, s[28:31], s53 offen offset:0 sc1
    v_mfma_f32_16x16x32_bf16 v[136:139], v[68:71], v[44:47], v[136:139]
    v_mfma_f32_16x16x32_bf16 v[156:159], v[68:71], v[48:51], v[156:159]
    s_add_u32 s42, s44, 71680
    buffer_load_dwordx4 v[68:71], v0, s[28:31], s42 offen offset:0 sc1
    s_waitcnt vmcnt(13)
    v_mfma_f32_16x16x32_bf16 v[100:103], v[72:75], v[36:39], v[100:103]
    v_mfma_f32_16x16x32_bf16 v[120:123], v[72:75], v[40:43], v[120:123]
    buffer_load_dwordx4 v[28:31], v1, s[28:31], s52 offen offset:2048 sc1
    v_mfma_f32_16x16x32_bf16 v[140:143], v[72:75], v[44:47], v[140:143]
    v_mfma_f32_16x16x32_bf16 v[160:163], v[72:75], v[48:51], v[160:163]
    buffer_load_dwordx4 v[72:75], v0, s[28:31], s42 offen offset:1024 sc1
    s_waitcnt vmcnt(13)
    v_mfma_f32_16x16x32_bf16 v[104:107], v[76:79], v[36:39], v[104:107]
    v_mfma_f32_16x16x32_bf16 v[124:127], v[76:79], v[40:43], v[124:127]
    buffer_load_dwordx4 v[32:35], v1, s[28:31], s53 offen offset:2048 sc1
    v_mfma_f32_16x16x32_bf16 v[144:147], v[76:79], v[44:47], v[144:147]
    v_mfma_f32_16x16x32_bf16 v[164:167], v[76:79], v[48:51], v[164:167]
    buffer_load_dwordx4 v[76:79], v0, s[28:31], s42 offen offset:2048 sc1
    s_waitcnt vmcnt(13)
    v_mfma_f32_16x16x32_bf16 v[88:91], v[80:83], v[4:7], v[88:91]
    v_mfma_f32_16x16x32_bf16 v[108:111], v[80:83], v[8:11], v[108:111]
    buffer_load_dwordx4 v[44:47], v0, s[28:31], s42 offen offset:3072 sc1
    s_waitcnt vmcnt(13)
    v_mfma_f32_16x16x32_bf16 v[128:131], v[80:83], v[12:15], v[128:131]
    s_waitcnt vmcnt(11)
    v_mfma_f32_16x16x32_bf16 v[148:151], v[80:83], v[16:19], v[148:151]
    buffer_load_dwordx4 v[48:51], v2, s[28:31], s42 offen offset:0 sc1
    v_mfma_f32_16x16x32_bf16 v[92:95], v[52:55], v[4:7], v[92:95]
    v_mfma_f32_16x16x32_bf16 v[112:115], v[52:55], v[8:11], v[112:115]
    s_add_u32 s43, s44, 76800
    buffer_load_dwordx4 v[80:83], v0, s[28:31], s43 offen offset:0 sc1
    v_mfma_f32_16x16x32_bf16 v[132:135], v[52:55], v[12:15], v[132:135]
    v_mfma_f32_16x16x32_bf16 v[152:155], v[52:55], v[16:19], v[152:155]
    buffer_load_dwordx4 v[36:39], v1, s[28:31], s10 offen offset:0 sc1
    buffer_load_dwordx4 v[52:55], v0, s[28:31], s43 offen offset:1024 sc1
    s_waitcnt vmcnt(14)
    v_mfma_f32_16x16x32_bf16 v[96:99], v[56:59], v[4:7], v[96:99]
    v_mfma_f32_16x16x32_bf16 v[116:119], v[56:59], v[8:11], v[116:119]
    v_mfma_f32_16x16x32_bf16 v[136:139], v[56:59], v[12:15], v[136:139]
    v_mfma_f32_16x16x32_bf16 v[156:159], v[56:59], v[16:19], v[156:159]
    buffer_load_dwordx4 v[40:43], v1, s[28:31], s11 offen offset:0 sc1
    buffer_load_dwordx4 v[56:59], v0, s[28:31], s43 offen offset:2048 sc1
    s_waitcnt vmcnt(15)
    v_mfma_f32_16x16x32_bf16 v[100:103], v[60:63], v[4:7], v[100:103]
    v_mfma_f32_16x16x32_bf16 v[120:123], v[60:63], v[8:11], v[120:123]
    v_mfma_f32_16x16x32_bf16 v[140:143], v[60:63], v[12:15], v[140:143]
    v_mfma_f32_16x16x32_bf16 v[160:163], v[60:63], v[16:19], v[160:163]
    buffer_load_dwordx4 v[60:63], v0, s[28:31], s43 offen offset:3072 sc1
    s_waitcnt vmcnt(14)
    v_mfma_f32_16x16x32_bf16 v[104:107], v[64:67], v[4:7], v[104:107]
    v_mfma_f32_16x16x32_bf16 v[124:127], v[64:67], v[8:11], v[124:127]
    v_mfma_f32_16x16x32_bf16 v[144:147], v[64:67], v[12:15], v[144:147]
    v_mfma_f32_16x16x32_bf16 v[164:167], v[64:67], v[16:19], v[164:167]
    buffer_load_dwordx4 v[64:67], v2, s[28:31], s43 offen offset:0 sc1
    buffer_load_dwordx4 v[4:7], v1, s[28:31], s6 offen offset:0 sc1
    buffer_load_dwordx4 v[8:11], v1, s[28:31], s7 offen offset:0 sc1
    buffer_load_dwordx4 v[12:15], v1, s[28:31], s6 offen offset:2048 sc1
    buffer_load_dwordx4 v[16:19], v1, s[28:31], s7 offen offset:2048 sc1
    s_lshl_b32 s42, s37, 4
    s_add_u32 s42, s42, 8
    s_mov_b32 s50, 0x100000
    s_branch L_lw1_xa
L_lw_xa:
    s_sleep 4
    s_sub_u32 s50, s50, 1
    s_cbranch_scc1 L_lwd_xa
L_lw1_xa:
    v_mov_b32 v3, 161028
    ds_read_b32 v3, v3
    s_waitcnt lgkmcnt(0)
    v_cmp_gt_u32 vcc, 12, v3
    s_cbranch_vccnz L_lw_xa
L_lwd_xa:
    s_mov_b32 s50, 0x100000
    s_branch L_lw1_x2
L_lw_x2:
    s_sleep 4
    s_sub_u32 s50, s50, 1
    s_cbranch_scc1 L_lwd_x2
L_lw1_x2:
    v_mov_b32 v3, s42
    ds_read_b32 v3, v3
    s_waitcnt lgkmcnt(0)
    v_cmp_gt_u32 vcc, 10, v3
    s_cbranch_vccnz L_lw_x2
L_lwd_x2:
    s_add_u32 m0, s24, 0
    s_add_u32 s41, s44, 61440
    buffer_load_dwordx4 v0, s[28:31], s41 offen offset:0 sc1 lds
    buffer_load_dwordx4 v0, s[28:31], s41 offen offset:1024 sc1 lds
    buffer_load_dwordx4 v0, s[28:31], s41 offen offset:2048 sc1 lds
    buffer_load_dwordx4 v0, s[28:31], s41 offen offset:3072 sc1 lds
    s_add_u32 m0, s24, 4096
    s_add_u32 s41, s44, 65536
    buffer_load_dwordx4 v0, s[28:31], s41 offen offset:0 sc1 lds
    buffer_load_dwordx4 v0, s[28:31], s41 offen offset:1024 sc1 lds
    buffer_load_dwordx4 v0, s[28:31], s41 offen offset:2048 sc1 lds
    buffer_load_dwordx4 v0, s[28:31], s41 offen offset:3072 sc1 lds
    s_add_u32 m0, s24, 8192
    s_add_u32 s41, s44, 69632
    buffer_load_dwordx4 v0, s[28:31], s41 offen offset:0 sc1 lds
    s_branch L_sk_7777
L_pad_hlp_4:
    s_branch L_hwalked
L_gp_21:
    s_branch L_k1_c_qkv
L_sk_7777:
    buffer_load_dwordx4 v0, s[28:31], s41 offen offset:1024 sc1 lds
    s_add_u32 m0, s24, 10240
    s_add_u32 s41, s44, 81920
    buffer_load_dwordx4 v0, s[28:31], s41 offen offset:0 sc1 lds
    buffer_load_dwordx4 v0, s[28:31], s41 offen offset:1024 sc1 lds
    s_add_u32 m0, s24, 12288
    s_add_u32 s41, s44, 83968
    buffer_load_dwordx4 v0, s[28:31], s41 offen offset:0 sc1 lds
    buffer_load_dwordx4 v0, s[28:31], s41 offen offset:1024 sc1 lds
    buffer_load_dwordx4 v0, s[28:31], s41 offen offset:2048 sc1 lds
    s_waitcnt vmcnt(33)
    v_max_u32 v3, v20, v24
    v_cmp_eq_u32 vcc, -1, v3
    s_cbranch_vccnz L_oar0
L_oad0:
    s_waitcnt vmcnt(29)
    v_max_u32 v3, v28, v32
    v_cmp_eq_u32 vcc, -1, v3
    s_cbranch_vccnz L_oar1
L_oad1:
    s_waitcnt vmcnt(22)
    v_max_u32 v3, v36, v40
    v_cmp_eq_u32 vcc, -1, v3
    s_cbranch_vccnz L_oar4
L_oad4:
    s_bitcmp1_b32 s33, 0
    s_cbranch_scc1 L_rs1_a
    v_swap_b32 v38, v40
    v_swap_b32 v39, v41
    s_branch L_rs2_a
L_rs1_a:
    v_swap_b32 v36, v42
    v_swap_b32 v37, v43
    s_nop 0
L_rs2_a:
    s_nop 0
    s_waitcnt vmcnt(17)
    v_max_u32 v3, v4, v8
    v_cmp_eq_u32 vcc, -1, v3
    s_cbranch_vccnz L_oar2
L_oad2:
    s_waitcnt vmcnt(15)
    v_max_u32 v3, v12, v16
    v_cmp_eq_u32 vcc, -1, v3
    s_cbranch_vccnz L_oar3
L_oad3:
    v_bfe_u32 v2, v0, 2, 6
    v_add_u32 v2, s23, v2
    ds_read_b32 v2, v2 offset:512
    s_lshl_b32 s42, s37, 4
    s_add_u32 s42, s42, 8
    s_lshl_b32 s16, s59, 2
    s_add_u32 s16, s16, s37
    s_lshl_b32 s16, s16, 2
    s_bfe_u32 s17, s2, 131075
    s_add_u32 s16, s16, s17
    s_and_b32 s17, s2, 0
    s_add_u32 s16, s16, s17
    s_lshl_b32 s16, s16, 7
    s_add_u32 s16, s16, 17825792
    s_mov_b32 s17, 0
    s_mov_b32 s46, 0
    s_mov_b32 s60, 0
    s_movk_i32 s51, 2218
    s_movk_i32 s20, 2218
    v_add_u32 v84, s25, v0
    v_add_u32 v85, s26, v0
    v_add_u32 v86, s27, v0
    v_and_b32 v3, 255, v0
    v_mul_u32_u24 v3, 80, v3
    v_lshrrev_b32 v87, 8, v0
    v_mad_u32_u24 v87, v87, 40, v3
    v_add_u32 v0, s24, v0
    s_waitcnt lgkmcnt(0)
    v_add_f32 v2, 1.0, v2
    v_rcp_f32 v2, v2
    s_waitcnt vmcnt(0)
    s_mov_b32 s50, 0x100000
    s_branch L_lw1_tg
L_lw_tg:
    s_sleep 2
    s_sub_u32 s50, s50, 1
    s_cbranch_scc1 L_lwd_tg
L_lw1_tg:
    v_mov_b32 v3, s42
    ds_read_b32 v3, v3
    s_waitcnt lgkmcnt(0)
    v_cmp_gt_u32 vcc, 14, v3
    s_cbranch_vccnz L_lw_tg
L_lwd_tg:
    v_mov_b32 v3, 161036
    s_setprio 1
    s_mov_b32 s17, 1
    s_lshl_b32 exec_lo, 1, s17
    s_mov_b32 exec_hi, 0
    v_mov_b32 v3, 0
    s_add_u32 s61, s61, 1
    buffer_atomic_add v3, off, s[28:31], s16 sc0 sc1
    s_mov_b64 exec, -1
L_hp_a:
    s_mov_b32 s17, 0
    v_mfma_f32_16x16x32_bf16 v[88:91], v[68:71], v[4:7], v[88:91]
    v_mfma_f32_16x16x32_bf16 v[92:95], v[72:75], v[4:7], v[92:95]
    v_mfma_f32_16x16x32_bf16 v[96:99], v[76:79], v[4:7], v[96:99]
    v_mfma_f32_16x16x32_bf16 v[100:103], v[44:47], v[4:7], v[100:103]
    v_mfma_f32_16x16x32_bf16 v[104:107], v[48:51], v[4:7], v[104:107]
    ds_read_b128 v[4:7], v0 offset:10240
    v_mfma_f32_16x16x32_bf16 v[108:111], v[68:71], v[8:11], v[108:111]
    v_mfma_f32_16x16x32_bf16 v[112:115], v[72:75], v[8:11], v[112:115]
    v_mfma_f32_16x16x32_bf16 v[116:119], v[76:79], v[8:11], v[116:119]
    v_mfma_f32_16x16x32_bf16 v[120:123], v[44:47], v[8:11], v[120:123]
    v_mfma_f32_16x16x32_bf16 v[124:127], v[48:51], v[8:11], v[124:127]
    ds_read_b128 v[8:11], v0 offset:11264
    v_mfma_f32_16x16x32_bf16 v[88:91], v[80:83], v[12:15], v[88:91]
    v_mfma_f32_16x16x32_bf16 v[92:95], v[52:55], v[12:15], v[92:95]
    v_mfma_f32_16x16x32_bf16 v[96:99], v[56:59], v[12:15], v[96:99]
    v_mfma_f32_16x16x32_bf16 v[100:103], v[60:63], v[12:15], v[100:103]
    v_mfma_f32_16x16x32_bf16 v[104:107], v[64:67], v[12:15], v[104:107]
    ds_read_b128 v[12:15], v0 offset:12288
    v_mfma_f32_16x16x32_bf16 v[108:111], v[80:83], v[16:19], v[108:111]
    v_mfma_f32_16x16x32_bf16 v[112:115], v[52:55], v[16:19], v[112:115]
    v_mfma_f32_16x16x32_bf16 v[116:119], v[56:59], v[16:19], v[116:119]
    v_mfma_f32_16x16x32_bf16 v[120:123], v[60:63], v[16:19], v[120:123]
    v_mfma_f32_16x16x32_bf16 v[124:127], v[64:67], v[16:19], v[124:127]
    ds_read_b128 v[16:19], v0 offset:13312
    s_waitcnt lgkmcnt(3)
    v_mfma_f32_16x16x32_bf16 v[88:91], v[4:7], v[36:39], v[88:91]
    v_mfma_f32_16x16x32_bf16 v[108:111], v[4:7], v[40:43], v[108:111]
    ds_read_b128 v[4:7], v0 offset:14336
    s_waitcnt lgkmcnt(3)
    v_mfma_f32_16x16x32_bf16 v[92:95], v[8:11], v[36:39], v[92:95]
    v_mfma_f32_16x16x32_bf16 v[112:115], v[8:11], v[40:43], v[112:115]
    ds_read_b128 v[8:11], v0 offset:0
    s_waitcnt lgkmcnt(3)
    v_mfma_f32_16x16x32_bf16 v[96:99], v[12:15], v[36:39], v[96:99]
    v_mfma_f32_16x16x32_bf16 v[116:119], v[12:15], v[40:43], v[116:119]
    ds_read_b128 v[12:15], v0 offset:1024
    s_waitcnt lgkmcnt(3)
    v_mfma_f32_16x16x32_bf16 v[100:103], v[16:19], v[36:39], v[100:103]
    v_mfma_f32_16x16x32_bf16 v[120:123], v[16:19], v[40:43], v[120:123]
    ds_read_b128 v[16:19], v0 offset:2048
    s_waitcnt lgkmcnt(3)
    v_mfma_f32_16x16x32_bf16 v[104:107], v[4:7], v[36:39], v[104:107]
    v_mfma_f32_16x16x32_bf16 v[124:127], v[4:7], v[40:43], v[124:127]
    ds_read_b128 v[4:7], v0 offset:3072
    ds_read_b128 v[40:43], v0 offset:4096
    s_waitcnt lgkmcnt(4)
    v_mfma_f32_16x16x32_bf16 v[88:91], v[8:11], v[20:23], v[88:91]
    v_mfma_f32_16x16x32_bf16 v[108:111], v[8:11], v[24:27], v[108:111]
    ds_read_b128 v[8:11], v0 offset:5120
    s_waitcnt lgkmcnt(4)
    s_branch L_sk_7934
L_pad_hlp_5:
    s_branch L_hwalked
L_gp_22:
    s_branch L_k1_c_qkv
L_sk_7934:
    v_mfma_f32_16x16x32_bf16 v[92:95], v[12:15], v[20:23], v[92:95]
    v_mfma_f32_16x16x32_bf16 v[112:115], v[12:15], v[24:27], v[112:115]
    ds_read_b128 v[12:15], v0 offset:6144
    s_waitcnt lgkmcnt(4)
    v_mfma_f32_16x16x32_bf16 v[96:99], v[16:19], v[20:23], v[96:99]
    v_mfma_f32_16x16x32_bf16 v[116:119], v[16:19], v[24:27], v[116:119]
    s_lshl_b32 exec_lo, 1, s17
    s_mov_b32 exec_hi, 0
    v_mov_b32 v36, 0
    s_add_u32 s61, s61, 1
    buffer_atomic_add v36, off, s[28:31], s16 sc0 sc1
    s_mov_b64 exec, -1
L_hp_b:
    ds_read_b128 v[16:19], v0 offset:7168
    s_waitcnt lgkmcnt(4)
    v_mfma_f32_16x16x32_bf16 v[100:103], v[4:7], v[20:23], v[100:103]
    v_mfma_f32_16x16x32_bf16 v[120:123], v[4:7], v[24:27], v[120:123]
    ds_read_b128 v[4:7], v0 offset:8192
    s_waitcnt lgkmcnt(4)
    v_mfma_f32_16x16x32_bf16 v[104:107], v[40:43], v[20:23], v[104:107]
    v_mfma_f32_16x16x32_bf16 v[124:127], v[40:43], v[24:27], v[124:127]
    ds_read_b128 v[40:43], v0 offset:9216
    s_waitcnt lgkmcnt(4)
    v_mfma_f32_16x16x32_bf16 v[88:91], v[8:11], v[28:31], v[88:91]
    v_mfma_f32_16x16x32_bf16 v[108:111], v[8:11], v[32:35], v[108:111]
    s_waitcnt lgkmcnt(3)
    v_mfma_f32_16x16x32_bf16 v[92:95], v[12:15], v[28:31], v[92:95]
    v_mfma_f32_16x16x32_bf16 v[112:115], v[12:15], v[32:35], v[112:115]
    ds_write_b128 v0, v[88:91] offset:29696
    s_waitcnt lgkmcnt(3)
    v_mfma_f32_16x16x32_bf16 v[96:99], v[16:19], v[28:31], v[96:99]
    ds_write_b128 v0, v[108:111] offset:34816
    v_mfma_f32_16x16x32_bf16 v[116:119], v[16:19], v[32:35], v[116:119]
    ds_write_b128 v0, v[92:95] offset:30720
    s_waitcnt lgkmcnt(4)
    v_mfma_f32_16x16x32_bf16 v[100:103], v[4:7], v[28:31], v[100:103]
    ds_write_b128 v0, v[112:115] offset:35840
    v_mfma_f32_16x16x32_bf16 v[120:123], v[4:7], v[32:35], v[120:123]
    ds_write_b128 v0, v[96:99] offset:31744
    s_waitcnt lgkmcnt(5)
    v_mfma_f32_16x16x32_bf16 v[104:107], v[40:43], v[28:31], v[104:107]
    ds_write_b128 v0, v[116:119] offset:36864
    v_mfma_f32_16x16x32_bf16 v[124:127], v[40:43], v[32:35], v[124:127]
    ds_write_b128 v0, v[100:103] offset:32768
    s_waitcnt vmcnt(1)
    s_mov_b32 s17, 1
    v_readlane_b32 s40, v3, s17
    s_or_b32 s46, s46, s40
    s_and_b32 s48, s46, s51
    s_cbranch_scc0 L_hn_a
    s_andn2_b32 s51, s51, s48
    s_bitcmp1_b32 s48, 7
    s_cbranch_scc0 L_hn3_a
    buffer_load_dwordx4 v[12:15], v1, s[28:31], s8 offen offset:2048 sc1
    buffer_load_dwordx4 v[16:19], v1, s[28:31], s9 offen offset:2048 sc1
L_hn3_a:
    s_bitcmp1_b32 s48, 1
    s_cbranch_scc0 L_hn0_a
    buffer_load_dwordx4 v[20:23], v1, s[28:31], s54 offen offset:0 sc1
    buffer_load_dwordx4 v[24:27], v1, s[28:31], s55 offen offset:0 sc1
L_hn0_a:
    s_bitcmp1_b32 s48, 3
    s_cbranch_scc0 L_hn1_a
    buffer_load_dwordx4 v[28:31], v1, s[28:31], s54 offen offset:2048 sc1
    buffer_load_dwordx4 v[32:35], v1, s[28:31], s55 offen offset:2048 sc1
L_hn1_a:
    s_bitcmp1_b32 s48, 5
    s_cbranch_scc0 L_hn2_a
    buffer_load_dwordx4 v[4:7], v1, s[28:31], s8 offen offset:0 sc1
    buffer_load_dwordx4 v[8:11], v1, s[28:31], s9 offen offset:0 sc1
L_hn2_a:
    s_bitcmp1_b32 s48, 11
    s_cbranch_scc0 L_hn4_a
    buffer_load_dwordx4 v[36:39], v1, s[28:31], s12 offen offset:0 sc1
    buffer_load_dwordx4 v[40:43], v1, s[28:31], s13 offen offset:0 sc1
L_hn4_a:
L_hn_a:
    s_bcnt1_i32_b32 s61, s48
    s_lshl_b32 s61, s61, 1
    s_bitcmp1_b32 s46, 11
    s_cbranch_scc1 L_hp_c
    s_lshl_b32 exec_lo, 1, s17
    s_mov_b32 exec_hi, 0
    v_mov_b32 v36, 0
    s_add_u32 s61, s61, 1
    buffer_atomic_add v36, off, s[28:31], s16 sc0 sc1
    s_mov_b64 exec, -1
L_hp_c:
    s_mov_b32 s17, 0
    s_nop 7
    ds_write_b128 v0, v[120:123] offset:37888
    ds_write_b128 v0, v[104:107] offset:33792
    ds_write_b128 v0, v[124:127] offset:38912
    s_mov_b64 exec, 1
    ds_inc_u32 v3, v84
    s_mov_b64 exec, -1
    ds_read_b128 v[88:91], v0 offset:0
    ds_read_b128 v[92:95], v0 offset:1024
    ds_read_b128 v[96:99], v0 offset:2048
    ds_read_b128 v[100:103], v0 offset:3072
    ds_read_b128 v[104:107], v0 offset:4096
    ds_read_b128 v[108:111], v0 offset:5120
    ds_read_b128 v[112:115], v0 offset:6144
    ds_read_b128 v[116:119], v0 offset:7168
    ds_read_b128 v[120:123], v0 offset:8192
    ds_read_b128 v[124:127], v0 offset:9216
    s_mov_b32 s47, 0
    s_mov_b32 s50, 0x40000
    s_branch L_ob
L_obn:
L_obm4:
    s_sub_u32 s50, s50, 1
    s_cbranch_scc1 L_obx
    s_cmp_lg_u32 s51, 0
    s_cbranch_scc1 L_ob
    s_min_u32 s40, s47, s48
    s_cmp_lg_u32 s40, 0
    s_cbranch_scc1 L_ob
    s_or_b32 s49, s47, s48
    s_bitcmp1_b32 s49, 11
    s_cbranch_scc0 L_ob
    s_mov_b32 s47, 0
    s_mov_b32 s48, 0
    s_mov_b32 s61, 0
    s_mov_b32 s19, 1
    s_branch L_obp
L_ob:
    s_cmp_gt_u32 s61, 1
    s_cbranch_scc1 L_w2
    s_waitcnt vmcnt(1)
    s_cmp_eq_u32 s61, 1
    s_cbranch_scc1 L_wd
    s_waitcnt vmcnt(0)
    s_branch L_wd
L_w3:
    s_waitcnt vmcnt(14)
    s_cmp_gt_u32 s61, 13
    s_cbranch_scc1 L_wd
    s_waitcnt vmcnt(13)
    s_cmp_gt_u32 s61, 12
    s_cbranch_scc1 L_wd
    s_waitcnt vmcnt(12)
    s_cmp_gt_u32 s61, 11
    s_cbranch_scc1 L_wd
    s_waitcnt vmcnt(11)
    s_cmp_gt_u32 s61, 10
    s_cbranch_scc1 L_wd
    s_waitcnt vmcnt(10)
    s_cmp_gt_u32 s61, 9
    s_cbranch_scc1 L_wd
    s_waitcnt vmcnt(9)
    s_cmp_gt_u32 s61, 8
    s_cbranch_scc1 L_wd
    s_waitcnt vmcnt(8)
    s_branch L_wd
L_w2:
    s_cmp_gt_u32 s61, 7
    s_cbranch_scc1 L_w3
    s_waitcnt vmcnt(7)
    s_cmp_gt_u32 s61, 6
    s_cbranch_scc1 L_wd
    s_waitcnt vmcnt(6)
    s_cmp_gt_u32 s61, 5
    s_cbranch_scc1 L_wd
    s_waitcnt vmcnt(5)
    s_cmp_gt_u32 s61, 4
    s_cbranch_scc1 L_wd
    s_waitcnt vmcnt(4)
    s_cmp_gt_u32 s61, 3
    s_cbranch_scc1 L_wd
    s_waitcnt vmcnt(3)
    s_cmp_gt_u32 s61, 2
    s_cbranch_scc1 L_wd
    s_waitcnt vmcnt(2)
L_wd:
    s_or_b32 s49, s47, s60
    s_mov_b32 s47, s48
    v_readlane_b32 s40, v36, s17
    s_or_b32 s46, s46, s40
    s_and_b32 s48, s46, s51
    s_cbranch_scc0 L_hn_l
    s_andn2_b32 s51, s51, s48
    s_bitcmp1_b32 s48, 7
    s_cbranch_scc0 L_hn3_l
    buffer_load_dwordx4 v[12:15], v1, s[28:31], s8 offen offset:2048 sc1
    buffer_load_dwordx4 v[16:19], v1, s[28:31], s9 offen offset:2048 sc1
L_hn3_l:
    s_bitcmp1_b32 s48, 1
    s_cbranch_scc0 L_hn0_l
    buffer_load_dwordx4 v[20:23], v1, s[28:31], s54 offen offset:0 sc1
    buffer_load_dwordx4 v[24:27], v1, s[28:31], s55 offen offset:0 sc1
L_hn0_l:
    s_bitcmp1_b32 s48, 3
    s_cbranch_scc0 L_hn1_l
    buffer_load_dwordx4 v[28:31], v1, s[28:31], s54 offen offset:2048 sc1
    buffer_load_dwordx4 v[32:35], v1, s[28:31], s55 offen offset:2048 sc1
L_hn1_l:
    s_bitcmp1_b32 s48, 5
    s_cbranch_scc0 L_hn2_l
    buffer_load_dwordx4 v[4:7], v1, s[28:31], s8 offen offset:0 sc1
    buffer_load_dwordx4 v[8:11], v1, s[28:31], s9 offen offset:0 sc1
L_hn2_l:
    s_bitcmp1_b32 s48, 11
    s_cbranch_scc0 L_hn4_l
    buffer_load_dwordx4 v[36:39], v1, s[28:31], s12 offen offset:0 sc1
    buffer_load_dwordx4 v[40:43], v1, s[28:31], s13 offen offset:0 sc1
L_hn4_l:
L_hn_l:
    s_bcnt1_i32_b32 s61, s48
    s_lshl_b32 s61, s61, 1
    s_bitcmp1_b32 s46, 11
    s_cbranch_scc1 L_hp_l
    s_lshl_b32 exec_lo, 1, s17
    s_mov_b32 exec_hi, 0
    v_mov_b32 v36, 0
    s_add_u32 s61, s61, 1
    buffer_atomic_add v36, off, s[28:31], s16 sc0 sc1
    s_mov_b64 exec, -1
L_hp_l:
    s_xor_b32 s17, s17, 1
    s_mov_b32 s19, 0
    s_branch L_sk_8161
L_pad_hlp_6:
    s_branch L_hwalked
L_gp_23:
    s_branch L_k1_c_qkv
L_sk_8161:
    s_cmp_eq_u32 s49, 0
    s_cbranch_scc1 L_obn
L_obp:
    s_waitcnt lgkmcnt(0)
    s_bitcmp1_b32 s49, 7
    s_cbranch_scc0 L_obm3
    s_cmp_eq_u32 s19, 0
    s_cbranch_scc1 L_obw3
    s_waitcnt vmcnt(2)
L_obw3:
    v_max_u32 v3, v12, v16
    v_cmp_eq_u32 vcc, -1, v3
    s_cbranch_vccnz L_obf3
    s_bitset0_b32 s20, 7
    v_mfma_f32_16x16x32_bf16 v[128:131], v[80:83], v[12:15], v[128:131]
    v_mfma_f32_16x16x32_bf16 v[148:151], v[80:83], v[16:19], v[148:151]
    ds_read_b128 v[80:83], v0 offset:10240
    v_mfma_f32_16x16x32_bf16 v[132:135], v[52:55], v[12:15], v[132:135]
    v_mfma_f32_16x16x32_bf16 v[152:155], v[52:55], v[16:19], v[152:155]
    ds_read_b128 v[52:55], v0 offset:11264
    v_mfma_f32_16x16x32_bf16 v[136:139], v[56:59], v[12:15], v[136:139]
    v_mfma_f32_16x16x32_bf16 v[156:159], v[56:59], v[16:19], v[156:159]
    ds_read_b128 v[56:59], v0 offset:12288
    v_mfma_f32_16x16x32_bf16 v[140:143], v[60:63], v[12:15], v[140:143]
    v_mfma_f32_16x16x32_bf16 v[160:163], v[60:63], v[16:19], v[160:163]
    ds_read_b128 v[60:63], v0 offset:13312
    v_mfma_f32_16x16x32_bf16 v[144:147], v[64:67], v[12:15], v[144:147]
    v_mfma_f32_16x16x32_bf16 v[164:167], v[64:67], v[16:19], v[164:167]
    ds_read_b128 v[64:67], v0 offset:14336
L_obm3:
    s_bitcmp1_b32 s49, 1
    s_cbranch_scc0 L_obm0
    s_cmp_eq_u32 s19, 0
    s_cbranch_scc1 L_obw0
    s_waitcnt vmcnt(2)
L_obw0:
    v_max_u32 v3, v20, v24
    v_cmp_eq_u32 vcc, -1, v3
    s_cbranch_vccnz L_obf0
    s_bitset0_b32 s20, 1
    v_mfma_f32_16x16x32_bf16 v[128:131], v[88:91], v[20:23], v[128:131]
    v_mfma_f32_16x16x32_bf16 v[148:151], v[88:91], v[24:27], v[148:151]
    v_mfma_f32_16x16x32_bf16 v[132:135], v[92:95], v[20:23], v[132:135]
    v_mfma_f32_16x16x32_bf16 v[152:155], v[92:95], v[24:27], v[152:155]
    v_mfma_f32_16x16x32_bf16 v[136:139], v[96:99], v[20:23], v[136:139]
    v_mfma_f32_16x16x32_bf16 v[156:159], v[96:99], v[24:27], v[156:159]
    v_mfma_f32_16x16x32_bf16 v[140:143], v[100:103], v[20:23], v[140:143]
    v_mfma_f32_16x16x32_bf16 v[160:163], v[100:103], v[24:27], v[160:163]
    v_mfma_f32_16x16x32_bf16 v[144:147], v[104:107], v[20:23], v[144:147]
    v_mfma_f32_16x16x32_bf16 v[164:167], v[104:107], v[24:27], v[164:167]
L_obm0:
    s_bitcmp1_b32 s49, 3
    s_cbranch_scc0 L_obm1
    s_cmp_eq_u32 s19, 0
    s_cbranch_scc1 L_obw1
    s_waitcnt vmcnt(2)
L_obw1:
    v_max_u32 v3, v28, v32
    v_cmp_eq_u32 vcc, -1, v3
    s_cbranch_vccnz L_obf1
    s_bitset0_b32 s20, 3
    v_mfma_f32_16x16x32_bf16 v[128:131], v[108:111], v[28:31], v[128:131]
    v_mfma_f32_16x16x32_bf16 v[148:151], v[108:111], v[32:35], v[148:151]
    v_mfma_f32_16x16x32_bf16 v[132:135], v[112:115], v[28:31], v[132:135]
    v_mfma_f32_16x16x32_bf16 v[152:155], v[112:115], v[32:35], v[152:155]
    v_mfma_f32_16x16x32_bf16 v[136:139], v[116:119], v[28:31], v[136:139]
    v_mfma_f32_16x16x32_bf16 v[156:159], v[116:119], v[32:35], v[156:159]
    v_mfma_f32_16x16x32_bf16 v[140:143], v[120:123], v[28:31], v[140:143]
    v_mfma_f32_16x16x32_bf16 v[160:163], v[120:123], v[32:35], v[160:163]
    v_mfma_f32_16x16x32_bf16 v[144:147], v[124:127], v[28:31], v[144:147]
    v_mfma_f32_16x16x32_bf16 v[164:167], v[124:127], v[32:35], v[164:167]
L_obm1:
    s_bitcmp1_b32 s49, 5
    s_cbranch_scc0 L_obm2
    s_cmp_eq_u32 s19, 0
    s_cbranch_scc1 L_obw2
    s_waitcnt vmcnt(2)
L_obw2:
    v_max_u32 v3, v4, v8
    v_cmp_eq_u32 vcc, -1, v3
    s_cbranch_vccnz L_obf2
    s_bitset0_b32 s20, 5
    v_mfma_f32_16x16x32_bf16 v[128:131], v[68:71], v[4:7], v[128:131]
    v_mfma_f32_16x16x32_bf16 v[148:151], v[68:71], v[8:11], v[148:151]
    v_mfma_f32_16x16x32_bf16 v[132:135], v[72:75], v[4:7], v[132:135]
    v_mfma_f32_16x16x32_bf16 v[152:155], v[72:75], v[8:11], v[152:155]
    v_mfma_f32_16x16x32_bf16 v[136:139], v[76:79], v[4:7], v[136:139]
    v_mfma_f32_16x16x32_bf16 v[156:159], v[76:79], v[8:11], v[156:159]
    v_mfma_f32_16x16x32_bf16 v[140:143], v[44:47], v[4:7], v[140:143]
    v_mfma_f32_16x16x32_bf16 v[160:163], v[44:47], v[8:11], v[160:163]
    v_mfma_f32_16x16x32_bf16 v[144:147], v[48:51], v[4:7], v[144:147]
    v_mfma_f32_16x16x32_bf16 v[164:167], v[48:51], v[8:11], v[164:167]
L_obm2:
    s_bitcmp1_b32 s49, 11
    s_cbranch_scc0 L_obm4
    s_cmpk_eq_u32 s20, 2048
    s_cselect_b32 s60, 0, 2048
    s_cbranch_scc0 L_obm4
    s_cmp_eq_u32 s19, 0
    s_cbranch_scc1 L_obw4
    s_waitcnt vmcnt(0)
L_obw4:
    v_max_u32 v3, v36, v40
    v_cmp_eq_u32 vcc, -1, v3
    s_cbranch_vccnz L_obf4
L_obx:
    s_bitcmp1_b32 s33, 0
    s_cbranch_scc1 L_rs1_b
    v_swap_b32 v38, v40
    v_swap_b32 v39, v41
    s_branch L_rs2_b
L_rs1_b:
    v_swap_b32 v36, v42
    v_swap_b32 v37, v43
    s_nop 0
L_rs2_b:
    s_nop 0
    s_waitcnt lgkmcnt(0)
    v_mfma_f32_16x16x32_bf16 v[136:139], v[56:59], v[36:39], v[136:139]
    v_mfma_f32_16x16x32_bf16 v[140:143], v[60:63], v[36:39], v[140:143]
    v_mfma_f32_16x16x32_bf16 v[144:147], v[64:67], v[36:39], v[144:147]
    v_mfma_f32_16x16x32_bf16 v[148:151], v[80:83], v[40:43], v[148:151]
    ds_write_b128 v0, v[136:139] offset:0
    v_mfma_f32_16x16x32_bf16 v[152:155], v[52:55], v[40:43], v[152:155]
    ds_write_b128 v0, v[140:143] offset:1024
    v_mfma_f32_16x16x32_bf16 v[156:159], v[56:59], v[40:43], v[156:159]
    ds_write_b128 v0, v[144:147] offset:2048
    v_mfma_f32_16x16x32_bf16 v[160:163], v[60:63], v[40:43], v[160:163]
    ds_write_b128 v0, v[148:151] offset:3072
    v_mfma_f32_16x16x32_bf16 v[164:167], v[64:67], v[40:43], v[164:167]
    ds_write_b128 v0, v[152:155] offset:4096
    v_mfma_f32_16x16x32_bf16 v[128:131], v[80:83], v[36:39], v[128:131]
    ds_write_b128 v0, v[156:159] offset:5120
    v_mfma_f32_16x16x32_bf16 v[132:135], v[52:55], v[36:39], v[132:135]
    ds_write_b128 v0, v[160:163] offset:6144
    s_nop 3
    ds_write_b128 v0, v[164:167] offset:7168
    s_waitcnt lgkmcnt(0)
    s_barrier
    ds_read_b128 v[4:7], v84 offset:0
    ds_read_b128 v[8:11], v85 offset:0
    ds_read_b128 v[12:15], v86 offset:0
    ds_read_b128 v[16:19], v84 offset:1024
    ds_read_b128 v[20:23], v85 offset:1024
    ds_read_b128 v[24:27], v86 offset:1024
    ds_read_b128 v[28:31], v84 offset:2048
    ds_read_b128 v[32:35], v85 offset:2048
    ds_read_b128 v[36:39], v86 offset:2048
    s_waitcnt lgkmcnt(6)
    v_pk_add_f32 v[12:13], v[12:13], v[8:9]
    v_pk_add_f32 v[128:129], v[128:129], v[4:5]
    v_pk_add_f32 v[14:15], v[14:15], v[10:11]
    v_pk_add_f32 v[130:131], v[130:131], v[6:7]
    v_pk_add_f32 v[128:129], v[128:129], v[12:13]
    v_pk_add_f32 v[130:131], v[130:131], v[14:15]
    v_pk_mul_f32 v[128:129], v[128:129], v[2:3] op_sel_hi:[1,0]
    v_pk_mul_f32 v[130:131], v[130:131], v[2:3] op_sel_hi:[1,0]
    v_cvt_pk_bf16_f32 v128, v128, v129
    v_cvt_pk_bf16_f32 v129, v130, v131
    buffer_store_dwordx2 v[128:129], v87, s[72:75], s22 offen offset:0
    s_waitcnt lgkmcnt(3)
    v_pk_add_f32 v[24:25], v[24:25], v[20:21]
    v_pk_add_f32 v[132:133], v[132:133], v[16:17]
    v_pk_add_f32 v[26:27], v[26:27], v[22:23]
    v_pk_add_f32 v[134:135], v[134:135], v[18:19]
    v_pk_add_f32 v[132:133], v[132:133], v[24:25]
    v_pk_add_f32 v[134:135], v[134:135], v[26:27]
    v_pk_mul_f32 v[132:133], v[132:133], v[2:3] op_sel_hi:[1,0]
    v_pk_mul_f32 v[134:135], v[134:135], v[2:3] op_sel_hi:[1,0]
    v_cvt_pk_bf16_f32 v132, v132, v133
    v_cvt_pk_bf16_f32 v133, v134, v135
    buffer_store_dwordx2 v[132:133], v87, s[72:75], s22 offen offset:8
    s_cmp_lg_u32 s34, 0
    s_cbranch_scc1 L_rf_b
    s_waitcnt lgkmcnt(0)
    v_pk_add_f32 v[36:37], v[36:37], v[32:33]
    v_pk_add_f32 v[136:137], v[136:137], v[28:29]
    v_pk_add_f32 v[38:39], v[38:39], v[34:35]
    v_pk_add_f32 v[138:139], v[138:139], v[30:31]
    v_pk_add_f32 v[136:137], v[136:137], v[36:37]
    v_pk_add_f32 v[138:139], v[138:139], v[38:39]
    s_branch L_sk_8348
L_pad_hlp_7:
    s_branch L_hwalked
L_gp_24:
    s_branch L_k1_c_qkv
L_sk_8348:
    v_pk_mul_f32 v[136:137], v[136:137], v[2:3] op_sel_hi:[1,0]
    v_pk_mul_f32 v[138:139], v[138:139], v[2:3] op_sel_hi:[1,0]
    v_cvt_pk_bf16_f32 v136, v136, v137
    v_cvt_pk_bf16_f32 v137, v138, v139
    buffer_store_dwordx2 v[136:137], v87, s[72:75], s22 offen offset:16
L_rf_b:
L_k2_end:
L_end2:
    s_endpgm
L_spare:
    s_mov_b32 s18, 2621440
    s_mov_b32 s19, 0x00020000
    s_mov_b32 s22, 1966080
    s_mov_b32 s23, 0x00020000
    s_mov_b32 s26, 1966080
    s_mov_b32 s27, 0x00020000
    s_waitcnt lgkmcnt(0)
    s_mov_b64 s[16:17], s[4:5]
    s_mov_b64 s[20:21], s[8:9]
    s_mov_b64 s[24:25], s[10:11]
    s_mov_b32 s28, s14
    s_mov_b32 s29, s15
    s_mov_b32 s30, 22020096
    s_mov_b32 s31, 0x00020000
    s_mov_b32 s74, s76
    s_mov_b32 s75, s77
    s_mov_b32 s76, s78
    s_mov_b32 s77, s79
    s_mov_b32 s78, 256
    s_mov_b32 s79, 0x00020000
    v_mov_b32 v46, 0
    s_cmp_lt_u32 s36, 8
    s_cbranch_scc1 L_spare1
    v_mov_b32 v24, 0
    v_mov_b32 v25, 0
    v_mov_b32 v26, 0
    v_mov_b32 v27, 0
    v_mov_b32 v28, 161024
    ds_write_b128 v28, v[24:27]
    ds_write_b128 v28, v[24:27] offset:16
    s_waitcnt lgkmcnt(0)
    s_barrier
    s_cmp_eq_u32 s37, 0
    s_cbranch_scc1 L_pad_att_0
    s_cmp_eq_u32 s37, 1
    s_cbranch_scc1 L_pad_att_1
    s_cmp_eq_u32 s37, 2
    s_cbranch_scc1 L_pad_att_2
    s_cmp_eq_u32 s37, 3
    s_cbranch_scc1 L_pad_att_3
    s_branch L_ldone
L_spare1:
    s_add_u32 s44, s35, s36
    s_cmp_lg_u32 s44, 0
    s_cbranch_scc1 L_spare2
    v_mov_b32 v4, 0
    v_mov_b32 v5, 0
    v_mov_b32 v6, 0
    v_mov_b32 v7, 0
    v_lshlrev_b32 v2, 7, v1
    v_lshlrev_b32 v8, 4, v1
    v_mov_b32 v3, 1
    s_mov_b32 s44, 16834560
    buffer_store_dwordx4 v[4:7], v8, s[28:31], s44 offen sc1
    v_mov_b32 v10, -1
    v_mov_b32 v11, -1
    v_mov_b32 v12, -1
    v_mov_b32 v13, -1
    s_mov_b32 s45, 16777216
    s_mov_b32 s46, 16781312
    buffer_store_dwordx4 v[10:13], v8, s[28:31], s45 offen offset:0 sc1
    buffer_store_dwordx4 v[10:13], v8, s[28:31], s45 offen offset:1024 sc1
    buffer_store_dwordx4 v[10:13], v8, s[28:31], s45 offen offset:2048 sc1
    buffer_store_dwordx4 v[10:13], v8, s[28:31], s45 offen offset:3072 sc1
    buffer_store_dwordx4 v[10:13], v8, s[28:31], s46 offen offset:0 sc1
    buffer_store_dwordx4 v[10:13], v8, s[28:31], s46 offen offset:1024 sc1
    buffer_store_dwordx4 v[10:13], v8, s[28:31], s46 offen offset:2048 sc1
    buffer_store_dwordx4 v[10:13], v8, s[28:31], s46 offen offset:3072 sc1
    s_mov_b32 s44, 16793600
    buffer_store_dword v4, v2, s[28:31], s44 offen sc1
    s_mov_b32 s44, 16801792
    buffer_store_dword v4, v2, s[28:31], s44 offen sc1
    s_mov_b32 s44, 16809984
    buffer_store_dword v4, v2, s[28:31], s44 offen sc1
    s_mov_b32 s44, 16818176
    buffer_store_dword v4, v2, s[28:31], s44 offen sc1
    s_mov_b32 s44, 16826368
    buffer_store_dword v4, v2, s[28:31], s44 offen sc1
    s_mov_b32 s44, 16835584
    buffer_store_dword v4, v2, s[28:31], s44 offen sc1
    s_mov_b32 s44, 17825792
    buffer_store_dword v4, v2, s[28:31], s44 offen sc1
    s_mov_b32 s44, 17833984
    buffer_store_dword v4, v2, s[28:31], s44 offen sc1
    s_mov_b32 s44, 17842176
    buffer_store_dword v4, v2, s[28:31], s44 offen sc1
    s_mov_b32 s44, 17850368
    buffer_store_dword v4, v2, s[28:31], s44 offen sc1
    s_mov_b32 s44, 17858560
    buffer_store_dword v4, v2, s[28:31], s44 offen sc1
    s_mov_b32 s44, 17866752
    buffer_store_dword v4, v2, s[28:31], s44 offen sc1
    s_mov_b32 s44, 17874944
    buffer_store_dword v4, v2, s[28:31], s44 offen sc1
    s_mov_b32 s44, 17883136
    buffer_store_dword v4, v2, s[28:31], s44 offen sc1
    s_waitcnt vmcnt(0)
    s_mov_b64 exec, 1
    buffer_store_dword v3, v4, s[76:79], 0 offen sc1
    s_mov_b64 exec, -1
L_spare2:
    s_barrier
    s_lshr_b32 s34, s2, 3
    s_and_b32 s58, s2, 7
    s_lshl_b32 s58, s58, 2
    s_bfe_u32 s59, s2, 0x20003
    s_add_u32 s58, s58, s59
    s_lshr_b32 s7, s2, 5
    s_lshl_b32 s7, s7, 3
    s_add_u32 s7, s7, s36
    s_mul_i32 s7, s7, 40
    s_add_u32 s6, s7, s58
    s_lshl_b32 s6, s6, 10
    s_add_u32 s6, s6, 14155776
    s_lshr_b32 s58, s58, 2
    s_add_u32 s7, s7, s58
    s_lshl_b32 s7, s7, 10
    s_add_u32 s7, s7, 14188544
    s_and_b32 s58, s59, 1
    s_lshl_b32 s58, s58, 9
    s_add_u32 s7, s7, s58
    s_and_b32 s58, s59, 2
    s_lshl_b32 s58, s58, 7
    s_add_u32 s7, s7, s58
    s_and_b32 s13, s2, 7
    s_lshl_b32 s13, s13, 2
    s_and_b32 s34, s34, 3
    s_add_u32 s13, s13, s34
    s_lshr_b32 s34, s2, 5
    s_lshr_b32 s38, s36, 2
    s_mov_b64 s[20:21], 0xffffffff
    s_mov_b32 s22, 0x000fffff
    s_mov_b32 s23, 0x000fffff
    s_not_b64 s[24:25], s[20:21]
    s_mov_b32 s14, 0
    s_xor_b32 s15, s38, 1
    s_mul_i32 s54, s37, 39936
    s_add_u32 s54, s54, 64
    s_mul_i32 s39, s13, 163840
    s_add_u32 s39, s39, 2621440
    s_sub_u32 s41, s39, s54
    s_add_u32 s56, s28, s41
    s_addc_u32 s57, s29, 0
    s_add_u32 s58, s54, 163840
    s_mov_b32 s59, 0x00020000
    s_mul_i32 s52, s37, 40960
    s_add_u32 s53, s52, 40960
    s_and_b32 s40, s34, 5
    s_mul_i32 s40, s40, 5120
    s_add_u32 s41, s40, s52
    s_add_u32 s42, s41, 5120
    s_cmp_eq_u32 s42, s53
    s_cselect_b32 s42, s52, s42
    s_add_u32 s52, s41, s39
    s_add_u32 s53, s52, 4096
    s_mul_i32 s44, s13, 81920
    s_lshl_b32 s43, s34, 1
    s_add_u32 s43, s43, s38
    s_mul_i32 s43, s43, 5120
    s_add_u32 s44, s44, s43
    s_lshl_b32 s49, s36, 7
    s_add_u32 s49, s49, 159808
    s_cmp_eq_u32 s38, 0
    s_mov_b32 s35, 161028
    s_cselect_b32 s35, 4, s35
    s_cselect_b32 s26, 12, 4
    s_mul_i32 s27, s38, 20480
    s_add_u32 s27, s27, 64
    s_lshl_b32 s55, s38, 2
    s_add_u32 s55, s55, 161028
    s_lshl_b32 s11, s34, 2
    s_add_u32 s11, s11, s37
    s_lshl_b32 s11, s11, 2
    s_lshr_b32 s12, s13, 3
    s_add_u32 s11, s11, s12
    s_lshl_b32 s11, s11, 9
    s_lshl_b32 s12, s38, 16
    s_sub_u32 s11, s11, s12
    s_add_u32 s11, s11, 17891328
    s_and_b32 s12, s13, 6
    s_lshl_b32 s12, 1, s12
    s_add_u32 s12, s12, 256
    s_xor_b32 s43, s37, 1
    s_mul_i32 s39, s43, 1280
    s_add_u32 s45, s39, s44
    s_mul_i32 s16, s43, 39936
    s_xor_b32 s43, s37, 2
    s_mul_i32 s39, s43, 1280
    s_add_u32 s46, s39, s44
    s_mul_i32 s17, s43, 39936
    s_xor_b32 s43, s37, 3
    s_mul_i32 s39, s43, 1280
    s_add_u32 s47, s39, s44
    s_mul_i32 s18, s43, 39936
    s_xor_b32 s43, s37, 0
    s_mul_i32 s39, s43, 1280
    s_add_u32 s48, s39, s44
    s_mul_i32 s19, s43, 39936
    s_waitcnt vmcnt(0)
    v_lshlrev_b32 v2, 4, v1
    v_and_b32 v70, 31, v1
    v_lshrrev_b32 v71, 5, v1
    v_lshrrev_b32 v4, 2, v70
    v_lshl_add_u32 v4, v4, 8, s54
    v_lshl_add_u32 v4, v71, 6, v4
    v_and_b32 v72, 3, v70
    v_lshl_add_u32 v4, v72, 4, v4
    v_lshrrev_b32 v73, 3, v70
    v_lshl_add_u32 v72, v73, 2, v72
    v_lshl_add_u32 v72, v72, 4, s54
    v_lshrrev_b32 v73, 4, v70
    v_bfe_u32 v74, v70, 2, 1
    v_lshl_add_u32 v3, v74, 3, v72
    v_lshl_add_u32 v14, v74, 8, v72
    v_lshl_add_u32 v14, v71, 9, v14
    v_and_b32 v15, 15, v70
    v_lshlrev_b32 v15, 4, v15
    v_lshl_add_u32 v15, v73, 3, v15
    s_branch L_cdone
L_kvwb:
    s_mov_b32 s44, 0x100000
L_kvw1b:
    s_sleep 2
    ds_read_b32 v15, v2
    s_waitcnt lgkmcnt(0)
    v_readlane_b32 s43, v15, s37
    s_cmp_ge_u32 s43, s50
    s_cbranch_scc1 L_kvdb
    s_sub_u32 s44, s44, 1
    s_cbranch_scc0 L_kvw1b
    s_branch L_kvdb
L_grd:
    s_mov_b32 s44, 0x100000
L_grd1:
    s_sleep 2
    v_mov_b32 v15, s35
    ds_read_b32 v15, v15
    s_waitcnt lgkmcnt(0)
    v_cmp_gt_u32 vcc, s26, v15
    s_cbranch_vccz L_grdd
    s_sub_u32 s44, s44, 1
    s_cbranch_scc0 L_grd1
    s_branch L_grdd
L_k2_slow:
    s_movk_i32 s54, 30720
    v_subrev_u32 v4, s54, v4
    v_subrev_u32 v3, s54, v3
    v_subrev_u32 v14, s54, v14
    s_waitcnt vmcnt(0)
    s_mov_b64 exec, s[24:25]
    v_mov_b32 v38, 0
    s_mov_b64 exec, -1
    v_mov_b32 v24, 0xff800000
    s_mov_b32 s42, 0
    s_mov_b32 s50, 64
L_k2_slow1:
    buffer_load_dwordx4 v[40:43], v14, s[56:59], s42 offen offset:0 sc1
    s_mov_b64 exec, s[20:21]
    buffer_load_dwordx2 v[48:49], v3, s[56:59], s42 offen offset:1024 sc1
    s_mov_b64 exec, -1
    s_add_u32 s42, s42, 2560
    s_waitcnt vmcnt(0)
    v_mfma_f32_32x32x16_bf16 v[68:83], v[40:43], v[28:31], 0
    v_mfma_f32_32x32x8_bf16 v[68:83], v[48:49], v[38:39], v[68:83]
    s_nop 15
    v_max3_f32 v24, v24, v68, v69
    v_max3_f32 v24, v24, v70, v71
    v_max3_f32 v24, v24, v72, v73
    v_max3_f32 v24, v24, v74, v75
    v_max3_f32 v24, v24, v76, v77
    v_max3_f32 v24, v24, v78, v79
    v_max3_f32 v24, v24, v80, v81
    v_max3_f32 v24, v24, v82, v83
    s_sub_u32 s50, s50, 1
    s_cmp_lg_u32 s50, 0
    s_cbranch_scc1 L_k2_slow1
    v_mov_b32 v25, v24
    s_nop 1
    v_permlane32_swap_b32 v24, v25
    s_nop 1
    v_max_f32 v24, v24, v25
    v_sub_f32 v24, 0, v24
    v_and_b32 v25, 0xffff0000, v24
    v_sub_f32 v24, v24, v25
    v_and_b32 v26, 0xffff0000, v24
    v_sub_f32 v24, v24, v26
    v_lshrrev_b32 v25, 16, v25
    v_or_b32 v25, v25, v26
    v_lshrrev_b32 v24, 16, v24
    s_mov_b64 exec, s[24:25]
    v_mov_b32 v38, v25
    v_mov_b32 v39, v24
    s_mov_b64 exec, -1
    s_mov_b32 s42, 0
    s_mov_b32 s50, 64
    v_mov_b32 v148, 0
    v_mov_b32 v149, 0
    v_mov_b32 v150, 0
    v_mov_b32 v151, 0
    v_mov_b32 v152, 0
    v_mov_b32 v153, 0
    v_mov_b32 v154, 0
    v_mov_b32 v155, 0
    v_mov_b32 v156, 0
    v_mov_b32 v157, 0
    v_mov_b32 v158, 0
    v_mov_b32 v159, 0
    v_mov_b32 v160, 0
    v_mov_b32 v161, 0
    v_mov_b32 v162, 0
    v_mov_b32 v163, 0
L_k2_slow2:
    buffer_load_dwordx4 v[40:43], v14, s[56:59], s42 offen offset:0 sc1
    s_mov_b64 exec, s[20:21]
    buffer_load_dwordx2 v[48:49], v3, s[56:59], s42 offen offset:1024 sc1
    s_mov_b64 exec, -1
    s_mov_b64 exec, s[22:23]
    buffer_load_dwordx4 v[52:55], v4, s[56:59], s42 offen offset:1280 sc1
    buffer_load_dwordx4 v[56:59], v4, s[56:59], s42 offen offset:1408 sc1
    s_mov_b64 exec, -1
    s_add_u32 s42, s42, 2560
    s_waitcnt vmcnt(0)
    v_mfma_f32_32x32x16_bf16 v[68:83], v[40:43], v[28:31], 0
    v_mfma_f32_32x32x8_bf16 v[68:83], v[48:49], v[38:39], v[68:83]
    s_nop 15
    v_exp_f32 v68, v68
    v_exp_f32 v69, v69
    v_exp_f32 v70, v70
    v_exp_f32 v71, v71
    v_exp_f32 v72, v72
    v_exp_f32 v73, v73
    v_exp_f32 v74, v74
    v_exp_f32 v75, v75
    v_exp_f32 v76, v76
    v_exp_f32 v77, v77
    v_exp_f32 v78, v78
    v_exp_f32 v79, v79
    v_exp_f32 v80, v80
    v_exp_f32 v81, v81
    v_exp_f32 v82, v82
    v_exp_f32 v83, v83
    s_nop 2
    v_smfmac_f32_32x32x32_bf16 v[148:163], v[52:55], v[68:75], v5
    v_smfmac_f32_32x32x32_bf16 v[148:163], v[56:59], v[76:83], v5
    s_sub_u32 s50, s50, 1
    s_cmp_lg_u32 s50, 0
    s_cbranch_scc1 L_k2_slow2
    s_nop 15
    v_mov_b32 v24, v156
    v_mov_b32 v25, v156
    s_nop 1
    v_permlane32_swap_b32 v24, v25
    s_nop 1
    v_rcp_f32 v25, v25
    s_branch L_k2_fin
L_hg:
    s_mov_b32 s50, 0x40000
L_hg1:
    s_sleep 8
    buffer_load_dword v12, v8, s[28:31], s51 offen sc1
    s_waitcnt vmcnt(0)
    v_cmp_eq_u32 vcc, -1, v12
    s_cbranch_vccz L_hgd
    s_sub_u32 s50, s50, 1
    s_cbranch_scc0 L_hg1
    s_branch L_hgd
L_cf:
    s_mov_b32 s50, 0x40000
L_cf1:
    s_sleep 4
    s_mov_b64 exec, 0xff
    buffer_load_dword v86, v85, s[28:31], s64 offen sc1
    s_mov_b64 exec, -1
    s_waitcnt vmcnt(0)
    v_cmp_gt_u32 vcc, 4, v86
    s_cbranch_vccz L_cfd
    s_sub_u32 s50, s50, 1
    s_cbranch_scc0 L_cf1
    s_branch L_cfd
L_oar0:
    s_mov_b32 s50, 0x40000
L_oar10:
    s_sleep 4
    buffer_load_dwordx4 v[20:23], v1, s[28:31], s52 offen offset:0 sc1
    buffer_load_dwordx4 v[24:27], v1, s[28:31], s53 offen offset:0 sc1
    s_waitcnt vmcnt(0)
    v_max_u32 v3, v20, v24
    v_cmp_eq_u32 vcc, -1, v3
    s_cbranch_vccz L_oad0
    s_sub_u32 s50, s50, 1
    s_cbranch_scc0 L_oar10
    s_branch L_oad0
L_oar1:
    s_mov_b32 s50, 0x40000
L_oar11:
    s_sleep 4
    buffer_load_dwordx4 v[28:31], v1, s[28:31], s52 offen offset:2048 sc1
    buffer_load_dwordx4 v[32:35], v1, s[28:31], s53 offen offset:2048 sc1
    s_waitcnt vmcnt(0)
    v_max_u32 v3, v28, v32
    v_cmp_eq_u32 vcc, -1, v3
    s_cbranch_vccz L_oad1
    s_sub_u32 s50, s50, 1
    s_cbranch_scc0 L_oar11
    s_branch L_oad1
L_oar4:
    s_mov_b32 s50, 0x40000
L_oar14:
    s_sleep 4
    buffer_load_dwordx4 v[36:39], v1, s[28:31], s10 offen offset:0 sc1
    buffer_load_dwordx4 v[40:43], v1, s[28:31], s11 offen offset:0 sc1
    s_waitcnt vmcnt(0)
    v_max_u32 v3, v36, v40
    v_cmp_eq_u32 vcc, -1, v3
    s_cbranch_vccz L_oad4
    s_sub_u32 s50, s50, 1
    s_cbranch_scc0 L_oar14
    s_branch L_oad4
L_oar2:
    s_mov_b32 s50, 0x40000
L_oar12:
    s_sleep 4
    buffer_load_dwordx4 v[4:7], v1, s[28:31], s6 offen offset:0 sc1
    buffer_load_dwordx4 v[8:11], v1, s[28:31], s7 offen offset:0 sc1
    s_waitcnt vmcnt(0)
    v_max_u32 v3, v4, v8
    v_cmp_eq_u32 vcc, -1, v3
    s_cbranch_vccz L_oad2
    s_sub_u32 s50, s50, 1
    s_cbranch_scc0 L_oar12
    s_branch L_oad2
L_oar3:
    s_mov_b32 s50, 0x40000
L_oar13:
    s_sleep 4
    buffer_load_dwordx4 v[12:15], v1, s[28:31], s6 offen offset:2048 sc1
    buffer_load_dwordx4 v[16:19], v1, s[28:31], s7 offen offset:2048 sc1
    s_waitcnt vmcnt(0)
    v_max_u32 v3, v12, v16
    v_cmp_eq_u32 vcc, -1, v3
    s_cbranch_vccz L_oad3
    s_sub_u32 s50, s50, 1
    s_cbranch_scc0 L_oar13
    s_branch L_oad3
L_obf3:
    s_bitset1_b32 s51, 7
    s_branch L_obm3
L_obf0:
    s_bitset1_b32 s51, 1
    s_branch L_obm0
L_obf1:
    s_bitset1_b32 s51, 3
    s_branch L_obm1
L_obf2:
    s_bitset1_b32 s51, 5
    s_branch L_obm2
L_obf4:
    s_bitset1_b32 s51, 11
    s_branch L_obm4
.section .rodata,"a"
.p2align 6
.amdhsa_kernel gated_mix__mha_block__geglu_ffn__prompt_kernel
  .amdhsa_next_free_vgpr 168
  .amdhsa_next_free_sgpr 102
  .amdhsa_accum_offset 168
  .amdhsa_group_segment_fixed_size 0
  .amdhsa_kernarg_size 88
  .amdhsa_user_sgpr_count 2
  .amdhsa_user_sgpr_kernarg_segment_ptr 1
  .amdhsa_system_sgpr_workgroup_id_x 1
.end_amdhsa_kernel
```
